```python
import torch

def _softmax(x, axis=-1):
    return torch.softmax(x, dim=axis)
def _gelu(x):
    return torch.nn.functional.gelu(x, approximate="tanh")
def _silu(x):
    return torch.nn.functional.silu(x)
def _sigmoid(x):
    return torch.sigmoid(x)
def _layernorm(x, axis=-1, eps=1e-5):
    m = x.mean(dim=axis, keepdim=True)
    v = x.var(dim=axis, keepdim=True, unbiased=False)
    return (x - m) / torch.sqrt(v + eps)
def _scatter_add(tgt, idx, src, axis=0):
    return tgt.clone().index_add_(axis, idx, src)
def _segment_sum(src, seg, n):
    out = torch.zeros((n,) + src.shape[1:], dtype=src.dtype)
    return out.index_add_(0, seg, src)
def _pad(x, pw):
    flat = tuple(v for pair in reversed(pw) for v in pair)
    return torch.nn.functional.pad(x, flat)

kernel_name = 'gated_mix__linear_kernel_hedgehog__glu_gated_swiglu__prompt'

def setup_inputs():

    _w = (lambda a: (lambda t: t.to(torch.bfloat16) if t.is_floating_point() else t)(torch.as_tensor(a)))
    def _A_setup():
        B, S, D, H = 1, 2048, 512, 32
        Dh = D // H
        return {
            "x": _w((lambda *s: torch.randn(*s, dtype=torch.bfloat16) * 0.05)(B, S, D)),
            "wqkv": _w((lambda *s: torch.randn(*s, dtype=torch.bfloat16) * 0.8)(D, 3 * D)),
            "w_phi": _w((lambda *s: torch.randn(*s, dtype=torch.bfloat16) * 0.8)(H, Dh, Dh) * (Dh ** -0.5)),
            "wo": _w((lambda *s: torch.randn(*s, dtype=torch.bfloat16) * 0.05)(D, D)),
        }
    _A_in = _A_setup()

    def _B_setup():
        B, S, D, F = 1, 2048, 512, 1792
        return {
            "x": _w((lambda *s: torch.randn(*s, dtype=torch.bfloat16) * 0.05)(B, S, D)),
            "w1": _w((lambda *s: torch.randn(*s, dtype=torch.bfloat16) * 1.6)(D, F) * (2.0 / D) ** 0.5),
            "w3": _w((lambda *s: torch.randn(*s, dtype=torch.bfloat16) * 1.6)(D, F) * (2.0 / D) ** 0.5),
            "w2": _w((lambda *s: torch.randn(*s, dtype=torch.bfloat16) * 1.6)(F, D) * (2.0 / F) ** 0.5),
        }
    _B_in = _B_setup()

    return {
        "A_x": _A_in["x"],
        "A_wqkv": _A_in["wqkv"],
        "A_w_phi": _A_in["w_phi"],
        "A_wo": _A_in["wo"],
        "B_x": _B_in["x"],
        "B_w1": _B_in["w1"],
        "B_w3": _B_in["w3"],
        "B_w2": _B_in["w2"],
        "gate_w": _w((lambda *s: torch.randn(*s, dtype=torch.bfloat16) * 0.05)(512) * 16.0),
    }

def reference(A_x, A_wqkv, A_w_phi, A_wo, B_x, B_w1, B_w3, B_w2, gate_w):
    def _A_ref(x, wqkv, w_phi, wo):
        B, S, D = x.shape
        H = 32; Dh = D // H
        qkv = (lambda x, *d: x.permute(*d))((x @ wqkv).reshape(B, S, 3, H, Dh), 2, 0, 3, 1, 4)
        q, k, v = qkv[0], qkv[1], qkv[2]
        pq = torch.einsum("bhsd,hdf->bhsf", q, w_phi)
        pk = torch.einsum("bhsd,hdf->bhsf", k, w_phi)
        phi_q = torch.concatenate([_softmax(pq, axis=-1), _softmax(-pq, axis=-1)], axis=-1)
        phi_k = torch.concatenate([_softmax(pk, axis=-1), _softmax(-pk, axis=-1)], axis=-1)
        kv = torch.einsum("bhsf,bhsd->bhfd", phi_k, v)
        z  = torch.einsum("bhsf->bhf", phi_k)
        num = torch.einsum("bhqf,bhfd->bhqd", phi_q, kv)
        den = torch.einsum("bhqf,bhf->bhq", phi_q, z)[..., None] + 1e-6
        o = num / den
        return (lambda x, *d: x.permute(*d))(o, 0, 2, 1, 3).reshape(B, S, D) @ wo

    def _B_ref(x, w1, w3, w2):
        gate = torch.einsum("bsd,df->bsf", x, w1)
        up = torch.einsum("bsd,df->bsf", x, w3)
        h = _silu(gate) * up
        out = torch.einsum("bsf,fd->bsd", h, w2)
        return out

    x = A_x
    g = _sigmoid((x * gate_w).sum(-1, keepdims=True))
    a = _A_ref(x, A_wqkv, A_w_phi, A_wo)
    b = _B_ref(x, B_w1, B_w3, B_w2)
    return g * a + (1 - g) * b
```

```asm
; @launch grid=(256,1,1) block=(256,1,1) lds=163840
.amdgcn_target "amdgcn-amd-amdhsa--gfx950"
.text
.globl gated_mix__linear_kernel_hedgehog__glu_gated_swiglu__prompt_kernel
.p2align 8
.type gated_mix__linear_kernel_hedgehog__glu_gated_swiglu__prompt_kernel,@function
gated_mix__linear_kernel_hedgehog__glu_gated_swiglu__prompt_kernel:
    s_cmp_ge_u32 s2, 256
    s_cbranch_scc1 L_end
    s_getpc_b64 s[4:5]
    s_load_dwordx16 s[40:55], s[0:1], 0
    s_lshr_b32 s6, s2, 3
    s_mul_i32 s6, s6, 1664
    v_lshl_add_u32 v2, v0, 7, s6
    v_cmp_gt_u32 vcc, 13, v0
    s_nop 0
    s_and_saveexec_b64 s[6:7], vcc
    s_cbranch_execz L_cpf_1
    global_load_dword v239, v2, s[4:5]
L_cpf_1:
    s_mov_b64 exec, s[6:7]
    s_load_dwordx8 s[56:63], s[0:1], 64
    v_and_b32 v254, 63, v0
    v_lshrrev_b32 v1, 6, v0
    s_nop 0
    v_readfirstlane_b32 s64, v1
    s_and_b32 s73, s2, 7
    s_lshr_b32 s76, s2, 3
    s_lshl_b32 s67, s73, 2
    s_lshr_b32 s74, s76, 3
    s_add_u32 s67, s67, s74
    s_and_b32 s68, s76, 7
    s_xor_b32 s68, s68, 4
    s_lshl_b32 s74, s73, 2
    s_lshr_b32 s39, 0x17425630, s74
    s_and_b32 s39, s39, 7
    s_cmp_ge_u32 s73, 5
    s_cbranch_scc1 L_qkv_a
    s_lshl_b32 s74, s73, 5
    s_add_u32 s74, s74, s76
    s_cmp_ge_u32 s73, 3
    s_cselect_b32 s66, 7, 0
    s_cselect_b32 s75, 96, 0
    s_sub_u32 s74, s74, s75
    s_cmp_ge_u32 s74, 90
    s_cbranch_scc1 L_qkv_b
    s_cmp_ge_u32 s74, 77
    s_cselect_b32 s75, 13, 0
    s_cselect_b32 s66, 7, s66
    s_sub_u32 s74, s74, s75
    s_mul_hi_u32 s65, s74, 0x24924925
    s_mul_i32 s75, s65, 7
    s_sub_u32 s74, s74, s75
    s_add_u32 s66, s66, s74
    s_mul_i32 s74, s65, 192
    s_mul_i32 s75, s64, 48
    s_add_u32 s74, s74, s75
    v_lshrrev_b32 v212, 3, v254
    v_lshrrev_b32 v213, 4, v254
    v_and_b32 v214, 7, v254
    v_xor_b32 v213, v213, v214
    v_add_u32 v212, s74, v212
    v_lshlrev_b32 v212, 10, v212
    v_xor_b32 v214, 4, v213
    v_lshl_add_u32 v192, v213, 4, v212
    v_lshl_add_u32 v193, v214, 4, v212
    v_add_u32 v193, 7168, v193
    v_lshl_add_u32 v194, v213, 4, v212
    v_add_u32 v194, 14336, v194
    v_lshl_add_u32 v195, v214, 4, v212
    v_add_u32 v195, 21504, v195
    v_lshl_add_u32 v196, v213, 4, v212
    v_add_u32 v196, 32768, v196
    v_lshl_add_u32 v197, v214, 4, v212
    v_add_u32 v197, 39936, v197
    s_mul_i32 s69, s64, 6144
    s_and_b32 s74, s64, 1
    s_lshl_b32 s74, s74, 4
    s_lshl_b32 s75, s66, 8
    s_mov_b32 s73, 3584
    v_lshrrev_b32 v212, 4, v254
    v_bfe_u32 v213, v254, 1, 3
    v_xor_b32 v213, v213, v212
    v_and_b32 v214, 1, v254
    v_lshlrev_b32 v214, 4, v214
    v_add_u32 v214, s75, v214
    v_add_u32 v212, s74, v212
    v_mul_lo_u32 v212, v212, s73
    v_add_u32 v212, v212, v214
    v_xor_b32 v215, 4, v213
    v_lshl_add_u32 v198, v213, 5, v212
    v_lshl_add_u32 v199, v213, 5, v212
    v_add_u32 v199, 13312, v199
    v_lshl_add_u32 v200, v215, 5, v212
    v_add_u32 v200, 26624, v200
    v_lshl_add_u32 v201, v215, 5, v212
    v_add_u32 v201, 39936, v201
    s_lshl_b32 s70, s64, 12
    s_add_u32 s70, s70, 73728
    s_waitcnt lgkmcnt(0)
    s_cmp_ge_u32 s64, 2
    s_cselect_b32 s12, s52, s50
    s_cselect_b32 s13, s53, s51
    s_mov_b32 s14, 1835008
    s_mov_b32 s15, 0x20000
    s_mov_b32 s8, s40
    s_mov_b32 s9, s41
    s_mov_b32 s10, 2097152
    s_mov_b32 s11, 0x20000
    s_lshl_b32 s77, s65, 7
    s_lshl_b32 s74, s66, 2
    s_add_u32 s77, s77, s74
    s_add_u32 s77, s77, 13631488
    s_add_u32 s74, s39, 0
    s_and_b32 s74, s74, 7
    s_mul_i32 s40, s74, 128
    s_lshl_b32 s74, s39, 1
    s_add_u32 s74, s74, 0
    s_and_b32 s74, s74, 15
    s_mul_i32 s48, s74, 114688
    s_lshl_b32 s74, s39, 1
    s_add_u32 s74, s74, 1
    s_and_b32 s74, s74, 15
    s_mul_i32 s49, s74, 114688
    s_add_u32 m0, s69, 0
    s_nop 0
    buffer_load_dwordx4 v192, s[8:11], s40 offen lds
    buffer_load_dwordx4 v193, s[8:11], s40 offen offset:1024 lds
    buffer_load_dwordx4 v194, s[8:11], s40 offen offset:2048 lds
    buffer_load_dwordx4 v195, s[8:11], s40 offen offset:3072 lds
    s_add_u32 m0, s69, 4096
    s_nop 0
    buffer_load_dwordx4 v196, s[8:11], s40 offen lds
    buffer_load_dwordx4 v197, s[8:11], s40 offen offset:1024 lds
    s_add_u32 m0, s70, 0
    s_nop 0
    buffer_load_dwordx4 v198, s[12:15], s48 offen lds
    buffer_load_dwordx4 v199, s[12:15], s48 offen offset:1024 lds
    buffer_load_dwordx4 v200, s[12:15], s48 offen offset:2048 lds
    buffer_load_dwordx4 v201, s[12:15], s48 offen offset:3072 lds
    s_add_u32 m0, s70, 16384
    s_nop 0
    buffer_load_dwordx4 v198, s[12:15], s49 offen lds
    buffer_load_dwordx4 v199, s[12:15], s49 offen offset:1024 lds
    buffer_load_dwordx4 v200, s[12:15], s49 offen offset:2048 lds
    buffer_load_dwordx4 v201, s[12:15], s49 offen offset:3072 lds
    s_mov_b32 s16, s62
    s_mov_b32 s17, s63
    s_mov_b32 s18, 14680064
    s_mov_b32 s19, 0x20000
    s_mov_b32 s20, s54
    s_mov_b32 s21, s55
    s_mov_b32 s22, 1835008
    s_mov_b32 s23, 0x20000
    s_mov_b32 s24, s46
    s_mov_b32 s25, s47
    s_mov_b32 s26, 524288
    s_mov_b32 s27, 0x20000
    s_mov_b32 s28, s58
    s_mov_b32 s29, s59
    s_mov_b32 s30, 2097152
    s_mov_b32 s31, 0x20000
    s_add_u32 s74, s39, 1
    s_and_b32 s74, s74, 7
    s_mul_i32 s41, s74, 128
    s_add_u32 s74, s39, 2
    s_and_b32 s74, s74, 7
    s_mul_i32 s42, s74, 128
    s_add_u32 s74, s39, 3
    s_and_b32 s74, s74, 7
    s_mul_i32 s43, s74, 128
    s_add_u32 s74, s39, 4
    s_and_b32 s74, s74, 7
    s_mul_i32 s44, s74, 128
    s_add_u32 s74, s39, 5
    s_and_b32 s74, s74, 7
    s_mul_i32 s45, s74, 128
    s_add_u32 s74, s39, 6
    s_and_b32 s74, s74, 7
    s_mul_i32 s46, s74, 128
    s_add_u32 s74, s39, 7
    s_and_b32 s74, s74, 7
    s_mul_i32 s47, s74, 128
    s_lshl_b32 s74, s39, 1
    s_add_u32 s74, s74, 2
    s_and_b32 s74, s74, 15
    s_mul_i32 s50, s74, 114688
    s_lshl_b32 s74, s39, 1
    s_add_u32 s74, s74, 3
    s_and_b32 s74, s74, 15
    s_mul_i32 s51, s74, 114688
    s_lshl_b32 s74, s39, 1
    s_add_u32 s74, s74, 4
    s_and_b32 s74, s74, 15
    s_mul_i32 s52, s74, 114688
    s_lshl_b32 s74, s39, 1
    s_add_u32 s74, s74, 5
    s_and_b32 s74, s74, 15
    s_mul_i32 s53, s74, 114688
    s_lshl_b32 s74, s39, 1
    s_add_u32 s74, s74, 6
    s_and_b32 s74, s74, 15
    s_mul_i32 s54, s74, 114688
    s_lshl_b32 s74, s39, 1
    s_add_u32 s74, s74, 7
    s_and_b32 s74, s74, 15
    s_mul_i32 s55, s74, 114688
    s_lshl_b32 s74, s39, 1
    s_add_u32 s74, s74, 8
    s_and_b32 s74, s74, 15
    s_mul_i32 s56, s74, 114688
    s_lshl_b32 s74, s39, 1
    s_add_u32 s74, s74, 9
    s_and_b32 s74, s74, 15
    s_mul_i32 s57, s74, 114688
    s_lshl_b32 s74, s39, 1
    s_add_u32 s74, s74, 10
    s_and_b32 s74, s74, 15
    s_mul_i32 s58, s74, 114688
    s_lshl_b32 s74, s39, 1
    s_add_u32 s74, s74, 11
    s_and_b32 s74, s74, 15
    s_mul_i32 s59, s74, 114688
    s_lshl_b32 s74, s39, 1
    s_add_u32 s74, s74, 12
    s_and_b32 s74, s74, 15
    s_mul_i32 s60, s74, 114688
    s_lshl_b32 s74, s39, 1
    s_add_u32 s74, s74, 13
    s_and_b32 s74, s74, 15
    s_mul_i32 s61, s74, 114688
    s_lshl_b32 s74, s39, 1
    s_add_u32 s74, s74, 14
    s_and_b32 s74, s74, 15
    s_mul_i32 s62, s74, 114688
    s_lshl_b32 s74, s39, 1
    s_add_u32 s74, s74, 15
    s_and_b32 s74, s74, 15
    s_mul_i32 s63, s74, 114688
    v_and_b32 v212, 15, v254
    v_lshrrev_b32 v213, 4, v254
    v_lshrrev_b32 v214, 1, v212
    v_add_u32 v215, 0, v213
    v_xor_b32 v215, v215, v214
    v_lshlrev_b32 v215, 4, v215
    v_lshl_add_u32 v202, v212, 7, v215
    v_add_u32 v203, 65536, v202
    v_add_u32 v215, 4, v213
    v_xor_b32 v215, v215, v214
    v_lshlrev_b32 v215, 4, v215
    v_lshl_add_u32 v204, v212, 7, v215
    v_add_u32 v205, 65536, v204
    v_bfe_u32 v212, v254, 2, 2
    v_lshl_add_u32 v214, v213, 3, v212
    v_lshlrev_b32 v214, 8, v214
    v_and_b32 v215, 3, v254
    v_lshl_add_u32 v214, v215, 3, v214
    v_and_b32 v213, 1, v213
    v_lshl_or_b32 v212, v213, 2, v212
    s_lshl_b32 s74, s64, 1
    s_add_u32 s75, s74, 0
    v_xor_b32 v215, s75, v212
    v_lshl_add_u32 v215, v215, 5, v214
    v_add_u32 v206, 73728, v215
    v_add_u32 v207, 139264, v215
    s_add_u32 s75, s74, 1
    v_xor_b32 v215, s75, v212
    v_lshl_add_u32 v215, v215, 5, v214
    v_add_u32 v208, 73728, v215
    v_add_u32 v209, 139264, v215
    s_mul_i32 s74, s65, 672
    s_lshl_b32 s75, s66, 2
    s_add_u32 s74, s74, s75
    s_add_u32 s74, s74, s64
    s_lshl_b32 s74, s74, 10
    v_lshlrev_b32 v215, 4, v254
    v_add_u32 v210, s74, v215
    s_mov_b32 s78, 0xbfb8aa3b
    s_lshl_b32 s4, s64, 12
    v_bfe_u32 v251, v254, 1, 2
    v_lshrrev_b32 v252, 4, v254
    v_xor_b32 v251, v251, v252
    v_lshlrev_b32 v251, 5, v251
    v_and_b32 v252, 1, v254
    v_lshl_add_u32 v251, v252, 4, v251
    s_lshl_b32 s74, s68, 7
    v_add_u32 v251, s74, v251
    v_lshrrev_b32 v252, 3, v254
    s_mul_i32 s74, s64, 458752
    v_lshl_add_u32 v253, v252, 10, v251
    v_add_u32 v240, s74, v253
    v_add_u32 v241, 7168, v240
    v_add_u32 v242, 14336, v240
    v_add_u32 v243, 21504, v240
    v_lshrrev_b32 v253, 2, v252
    v_lshlrev_b32 v253, 3, v253
    v_and_b32 v252, 3, v252
    v_add_u32 v252, v252, v253
    s_mul_i32 s74, s64, 131072
    v_lshl_add_u32 v253, v252, 10, v251
    v_add_u32 v244, s74, v253
    v_add_u32 v245, 15360, v244
    v_add_u32 v246, 2048, v244
    v_add_u32 v247, 17408, v244
    v_lshlrev_b32 v255, 7, v254
    s_mov_b32 s80, 0xffff0000
    s_mov_b32 s81, -1
    v_mov_b32 v253, 0x7f000000
    v_cndmask_b32 v255, v255, v253, s[80:81]
    s_lshr_b32 s74, s2, 3
    s_lshl_b32 s74, s74, 2
    s_add_u32 s74, s74, s64
    s_lshr_b32 s75, s74, 5
    s_and_b32 s74, s74, 31
    s_lshl_b32 s74, s74, 11
    s_mul_i32 s96, s75, 458752
    s_add_u32 s96, s96, s74
    s_lshl_b32 s33, s75, 17
    s_add_u32 s33, s33, s74
    s_mov_b32 s75, s96
    s_and_b32 s74, s2, 7
    s_cmp_ge_u32 s74, 7
    s_cselect_b32 s73, 7, 0
    s_sub_u32 s74, s74, s73
    s_lshl_b32 s73, s74, 16
    s_add_u32 s96, s75, s73
    s_add_u32 s74, s74, 1
    s_cmp_ge_u32 s74, 7
    s_cselect_b32 s73, 7, 0
    s_sub_u32 s74, s74, s73
    s_lshl_b32 s73, s74, 16
    s_add_u32 s97, s75, s73
    s_add_u32 s74, s74, 1
    s_cmp_ge_u32 s74, 7
    s_cselect_b32 s73, 7, 0
    s_sub_u32 s74, s74, s73
    s_lshl_b32 s73, s74, 16
    s_add_u32 s98, s75, s73
    s_add_u32 s74, s74, 1
    s_cmp_ge_u32 s74, 7
    s_cselect_b32 s73, 7, 0
    s_sub_u32 s74, s74, s73
    s_lshl_b32 s73, s74, 16
    s_add_u32 s99, s75, s73
    s_add_u32 s74, s74, 1
    s_cmp_ge_u32 s74, 7
    s_cselect_b32 s73, 7, 0
    s_sub_u32 s74, s74, s73
    s_lshl_b32 s73, s74, 16
    s_add_u32 s100, s75, s73
    s_add_u32 s74, s74, 1
    s_cmp_ge_u32 s74, 7
    s_cselect_b32 s73, 7, 0
    s_sub_u32 s74, s74, s73
    s_lshl_b32 s73, s74, 16
    s_add_u32 s101, s75, s73
    s_add_u32 s74, s74, 1
    s_cmp_ge_u32 s74, 7
    s_cselect_b32 s73, 7, 0
    s_sub_u32 s74, s74, s73
    s_lshl_b32 s73, s74, 16
    s_add_u32 s32, s75, s73
    s_add_u32 s34, s33, 65536
    v_bfe_u32 v212, v254, 2, 2
    v_lshrrev_b32 v213, 4, v254
    v_lshl_add_u32 v214, v213, 2, v212
    v_bfe_u32 v215, v214, 1, 2
    v_lshlrev_b32 v214, 7, v214
    v_and_b32 v212, 3, v254
    v_lshl_add_u32 v214, v212, 3, v214
    s_add_u32 s74, s4, 90112
    v_add_u32 v214, s74, v214
    v_xor_b32 v212, 0, v215
    v_lshl_add_u32 v232, v212, 5, v214
    v_xor_b32 v212, 1, v215
    v_lshl_add_u32 v233, v212, 5, v214
    v_xor_b32 v212, 2, v215
    v_lshl_add_u32 v234, v212, 5, v214
    v_xor_b32 v212, 3, v215
    v_lshl_add_u32 v235, v212, 5, v214
    s_waitcnt vmcnt(4)
    s_barrier
    ds_read_b64_tr_b16 a[32:33], v206
    ds_read_b64_tr_b16 a[34:35], v206 offset:1024
    ds_read_b64_tr_b16 a[36:37], v208
    ds_read_b64_tr_b16 a[38:39], v208 offset:1024
    ds_read_b64_tr_b16 a[40:41], v206 offset:8192
    ds_read_b64_tr_b16 a[42:43], v206 offset:9216
    ds_read_b64_tr_b16 a[44:45], v208 offset:8192
    ds_read_b64_tr_b16 a[46:47], v208 offset:9216
    ds_read_b128 a[0:3], v202
    ds_read_b128 a[4:7], v202 offset:2048
    ds_read_b128 a[8:11], v202 offset:4096
    ds_read_b128 a[12:15], v202 offset:6144
    ds_read_b128 a[16:19], v202 offset:8192
    s_waitcnt lgkmcnt(4)
    v_mfma_f32_16x16x32_bf16 v[0:3], a[32:35], a[0:3], 0
    ds_read_b128 a[20:23], v202 offset:10240
    v_mfma_f32_16x16x32_bf16 v[4:7], a[36:39], a[0:3], 0
    s_add_u32 m0, s69, 24576
    v_mfma_f32_16x16x32_bf16 v[8:11], a[40:43], a[0:3], 0
    buffer_load_dwordx4 v192, s[8:11], s41 offen lds
    v_mfma_f32_16x16x32_bf16 v[12:15], a[44:47], a[0:3], 0
    s_waitcnt lgkmcnt(4)
    v_mfma_f32_16x16x32_bf16 v[16:19], a[32:35], a[4:7], 0
    ds_read_b128 a[24:27], v202 offset:12288
    v_mfma_f32_16x16x32_bf16 v[20:23], a[36:39], a[4:7], 0
    v_mfma_f32_16x16x32_bf16 v[24:27], a[40:43], a[4:7], 0
    buffer_load_dwordx4 v193, s[8:11], s41 offen offset:1024 lds
    v_mfma_f32_16x16x32_bf16 v[28:31], a[44:47], a[4:7], 0
    s_waitcnt lgkmcnt(4)
    v_mfma_f32_16x16x32_bf16 v[32:35], a[32:35], a[8:11], 0
    ds_read_b128 a[0:3], v202 offset:14336
    v_mfma_f32_16x16x32_bf16 v[36:39], a[36:39], a[8:11], 0
    v_mfma_f32_16x16x32_bf16 v[40:43], a[40:43], a[8:11], 0
    buffer_load_dwordx4 v194, s[8:11], s41 offen offset:2048 lds
    v_mfma_f32_16x16x32_bf16 v[44:47], a[44:47], a[8:11], 0
    s_waitcnt lgkmcnt(4)
    v_mfma_f32_16x16x32_bf16 v[48:51], a[32:35], a[12:15], 0
    ds_read_b128 a[4:7], v202 offset:16384
    v_mfma_f32_16x16x32_bf16 v[52:55], a[36:39], a[12:15], 0
    v_mfma_f32_16x16x32_bf16 v[56:59], a[40:43], a[12:15], 0
    buffer_load_dwordx4 v195, s[8:11], s41 offen offset:3072 lds
    v_mfma_f32_16x16x32_bf16 v[60:63], a[44:47], a[12:15], 0
    s_waitcnt lgkmcnt(4)
    v_mfma_f32_16x16x32_bf16 v[64:67], a[32:35], a[16:19], 0
    ds_read_b128 a[8:11], v202 offset:18432
    v_mfma_f32_16x16x32_bf16 v[68:71], a[36:39], a[16:19], 0
    s_add_u32 m0, s69, 28672
    v_mfma_f32_16x16x32_bf16 v[72:75], a[40:43], a[16:19], 0
    buffer_load_dwordx4 v196, s[8:11], s41 offen lds
    v_mfma_f32_16x16x32_bf16 v[76:79], a[44:47], a[16:19], 0
    s_waitcnt lgkmcnt(4)
    v_mfma_f32_16x16x32_bf16 v[80:83], a[32:35], a[20:23], 0
    ds_read_b128 a[12:15], v202 offset:20480
    v_mfma_f32_16x16x32_bf16 v[84:87], a[36:39], a[20:23], 0
    v_mfma_f32_16x16x32_bf16 v[88:91], a[40:43], a[20:23], 0
    buffer_load_dwordx4 v197, s[8:11], s41 offen offset:1024 lds
    v_mfma_f32_16x16x32_bf16 v[92:95], a[44:47], a[20:23], 0
    s_waitcnt lgkmcnt(4)
    v_mfma_f32_16x16x32_bf16 v[96:99], a[32:35], a[24:27], 0
    ds_read_b128 a[16:19], v202 offset:22528
    v_mfma_f32_16x16x32_bf16 v[100:103], a[36:39], a[24:27], 0
    s_add_u32 m0, s70, 32768
    v_mfma_f32_16x16x32_bf16 v[104:107], a[40:43], a[24:27], 0
    buffer_load_dwordx4 v198, s[12:15], s50 offen lds
    v_mfma_f32_16x16x32_bf16 v[108:111], a[44:47], a[24:27], 0
    s_waitcnt lgkmcnt(4)
    v_mfma_f32_16x16x32_bf16 v[112:115], a[32:35], a[0:3], 0
    v_mfma_f32_16x16x32_bf16 v[116:119], a[36:39], a[0:3], 0
    s_waitcnt vmcnt(7)
    s_waitcnt lgkmcnt(0)
    s_barrier
    v_mfma_f32_16x16x32_bf16 v[120:123], a[40:43], a[0:3], 0
    ds_read_b64_tr_b16 a[48:49], v206 offset:16384
    v_mfma_f32_16x16x32_bf16 v[124:127], a[44:47], a[0:3], 0
    ds_read_b64_tr_b16 a[50:51], v206 offset:17408
    buffer_load_dwordx4 v199, s[12:15], s50 offen offset:1024 lds
    v_mfma_f32_16x16x32_bf16 v[128:131], a[32:35], a[4:7], 0
    ds_read_b64_tr_b16 a[52:53], v208 offset:16384
    v_mfma_f32_16x16x32_bf16 v[132:135], a[36:39], a[4:7], 0
    ds_read_b64_tr_b16 a[54:55], v208 offset:17408
    v_mfma_f32_16x16x32_bf16 v[136:139], a[40:43], a[4:7], 0
    ds_read_b64_tr_b16 a[56:57], v206 offset:24576
    v_mfma_f32_16x16x32_bf16 v[140:143], a[44:47], a[4:7], 0
    ds_read_b64_tr_b16 a[58:59], v206 offset:25600
    buffer_load_dwordx4 v200, s[12:15], s50 offen offset:2048 lds
    v_mfma_f32_16x16x32_bf16 v[144:147], a[32:35], a[8:11], 0
    ds_read_b64_tr_b16 a[60:61], v208 offset:24576
    v_mfma_f32_16x16x32_bf16 v[148:151], a[36:39], a[8:11], 0
    ds_read_b64_tr_b16 a[62:63], v208 offset:25600
    v_mfma_f32_16x16x32_bf16 v[152:155], a[40:43], a[8:11], 0
    ds_read_b128 a[20:23], v204
    v_mfma_f32_16x16x32_bf16 v[156:159], a[44:47], a[8:11], 0
    ds_read_b128 a[24:27], v204 offset:2048
    buffer_load_dwordx4 v201, s[12:15], s50 offen offset:3072 lds
    v_mfma_f32_16x16x32_bf16 v[160:163], a[32:35], a[12:15], 0
    ds_read_b128 a[0:3], v204 offset:4096
    v_mfma_f32_16x16x32_bf16 v[164:167], a[36:39], a[12:15], 0
    ds_read_b128 a[4:7], v204 offset:6144
    v_mfma_f32_16x16x32_bf16 v[168:171], a[40:43], a[12:15], 0
    s_add_u32 m0, s70, 49152
    v_mfma_f32_16x16x32_bf16 v[172:175], a[44:47], a[12:15], 0
    buffer_load_dwordx4 v198, s[12:15], s51 offen lds
    v_mfma_f32_16x16x32_bf16 v[176:179], a[32:35], a[16:19], 0
    ds_read_b128 a[8:11], v204 offset:8192
    v_mfma_f32_16x16x32_bf16 v[180:183], a[36:39], a[16:19], 0
    v_mfma_f32_16x16x32_bf16 v[184:187], a[40:43], a[16:19], 0
    buffer_load_dwordx4 v199, s[12:15], s51 offen offset:1024 lds
    v_mfma_f32_16x16x32_bf16 v[188:191], a[44:47], a[16:19], 0
    s_waitcnt lgkmcnt(4)
    v_mfma_f32_16x16x32_bf16 v[0:3], a[48:51], a[20:23], v[0:3]
    ds_read_b128 a[12:15], v204 offset:10240
    v_mfma_f32_16x16x32_bf16 v[4:7], a[52:55], a[20:23], v[4:7]
    v_mfma_f32_16x16x32_bf16 v[8:11], a[56:59], a[20:23], v[8:11]
    buffer_load_dwordx4 v200, s[12:15], s51 offen offset:2048 lds
    v_mfma_f32_16x16x32_bf16 v[12:15], a[60:63], a[20:23], v[12:15]
    s_waitcnt lgkmcnt(4)
    v_mfma_f32_16x16x32_bf16 v[16:19], a[48:51], a[24:27], v[16:19]
    ds_read_b128 a[16:19], v204 offset:12288
    v_mfma_f32_16x16x32_bf16 v[20:23], a[52:55], a[24:27], v[20:23]
    v_mfma_f32_16x16x32_bf16 v[24:27], a[56:59], a[24:27], v[24:27]
    buffer_load_dwordx4 v201, s[12:15], s51 offen offset:3072 lds
    v_mfma_f32_16x16x32_bf16 v[28:31], a[60:63], a[24:27], v[28:31]
    s_waitcnt lgkmcnt(4)
    v_mfma_f32_16x16x32_bf16 v[32:35], a[48:51], a[0:3], v[32:35]
    ds_read_b128 a[20:23], v204 offset:14336
    v_mfma_f32_16x16x32_bf16 v[36:39], a[52:55], a[0:3], v[36:39]
    s_add_u32 m0, s69, 49152
    v_mfma_f32_16x16x32_bf16 v[40:43], a[56:59], a[0:3], v[40:43]
    buffer_load_dwordx4 v192, s[8:11], s42 offen lds
    v_mfma_f32_16x16x32_bf16 v[44:47], a[60:63], a[0:3], v[44:47]
    s_waitcnt lgkmcnt(4)
    v_mfma_f32_16x16x32_bf16 v[48:51], a[48:51], a[4:7], v[48:51]
    ds_read_b128 a[24:27], v204 offset:16384
    v_mfma_f32_16x16x32_bf16 v[52:55], a[52:55], a[4:7], v[52:55]
    v_mfma_f32_16x16x32_bf16 v[56:59], a[56:59], a[4:7], v[56:59]
    buffer_load_dwordx4 v193, s[8:11], s42 offen offset:1024 lds
    v_mfma_f32_16x16x32_bf16 v[60:63], a[60:63], a[4:7], v[60:63]
    s_waitcnt lgkmcnt(4)
    v_mfma_f32_16x16x32_bf16 v[64:67], a[48:51], a[8:11], v[64:67]
    ds_read_b128 a[0:3], v204 offset:18432
    v_mfma_f32_16x16x32_bf16 v[68:71], a[52:55], a[8:11], v[68:71]
    v_mfma_f32_16x16x32_bf16 v[72:75], a[56:59], a[8:11], v[72:75]
    buffer_load_dwordx4 v194, s[8:11], s42 offen offset:2048 lds
    v_mfma_f32_16x16x32_bf16 v[76:79], a[60:63], a[8:11], v[76:79]
    s_waitcnt lgkmcnt(4)
    v_mfma_f32_16x16x32_bf16 v[80:83], a[48:51], a[12:15], v[80:83]
    ds_read_b128 a[4:7], v204 offset:20480
    v_mfma_f32_16x16x32_bf16 v[84:87], a[52:55], a[12:15], v[84:87]
    v_mfma_f32_16x16x32_bf16 v[88:91], a[56:59], a[12:15], v[88:91]
    buffer_load_dwordx4 v195, s[8:11], s42 offen offset:3072 lds
    v_mfma_f32_16x16x32_bf16 v[92:95], a[60:63], a[12:15], v[92:95]
    s_waitcnt lgkmcnt(4)
    v_mfma_f32_16x16x32_bf16 v[96:99], a[48:51], a[16:19], v[96:99]
    ds_read_b128 a[8:11], v204 offset:22528
    v_mfma_f32_16x16x32_bf16 v[100:103], a[52:55], a[16:19], v[100:103]
    s_add_u32 m0, s69, 53248
    v_mfma_f32_16x16x32_bf16 v[104:107], a[56:59], a[16:19], v[104:107]
    buffer_load_dwordx4 v196, s[8:11], s42 offen lds
    v_mfma_f32_16x16x32_bf16 v[108:111], a[60:63], a[16:19], v[108:111]
    s_waitcnt lgkmcnt(4)
    v_mfma_f32_16x16x32_bf16 v[112:115], a[48:51], a[20:23], v[112:115]
    v_mfma_f32_16x16x32_bf16 v[116:119], a[52:55], a[20:23], v[116:119]
    s_waitcnt vmcnt(9)
    s_waitcnt lgkmcnt(0)
    s_barrier
    v_mfma_f32_16x16x32_bf16 v[120:123], a[56:59], a[20:23], v[120:123]
    ds_read_b64_tr_b16 a[32:33], v206 offset:32768
    v_mfma_f32_16x16x32_bf16 v[124:127], a[60:63], a[20:23], v[124:127]
    ds_read_b64_tr_b16 a[34:35], v206 offset:33792
    buffer_load_dwordx4 v197, s[8:11], s42 offen offset:1024 lds
    v_mfma_f32_16x16x32_bf16 v[128:131], a[48:51], a[24:27], v[128:131]
    ds_read_b64_tr_b16 a[36:37], v208 offset:32768
    v_mfma_f32_16x16x32_bf16 v[132:135], a[52:55], a[24:27], v[132:135]
    ds_read_b64_tr_b16 a[38:39], v208 offset:33792
    v_mfma_f32_16x16x32_bf16 v[136:139], a[56:59], a[24:27], v[136:139]
    ds_read_b64_tr_b16 a[40:41], v206 offset:40960
    s_add_u32 m0, s70, 65536
    v_mfma_f32_16x16x32_bf16 v[140:143], a[60:63], a[24:27], v[140:143]
    ds_read_b64_tr_b16 a[42:43], v206 offset:41984
    buffer_load_dwordx4 v198, s[12:15], s52 offen lds
    v_mfma_f32_16x16x32_bf16 v[144:147], a[48:51], a[0:3], v[144:147]
    ds_read_b64_tr_b16 a[44:45], v208 offset:40960
    v_mfma_f32_16x16x32_bf16 v[148:151], a[52:55], a[0:3], v[148:151]
    ds_read_b64_tr_b16 a[46:47], v208 offset:41984
    v_mfma_f32_16x16x32_bf16 v[152:155], a[56:59], a[0:3], v[152:155]
    ds_read_b128 a[12:15], v202 offset:24576
    v_mfma_f32_16x16x32_bf16 v[156:159], a[60:63], a[0:3], v[156:159]
    ds_read_b128 a[16:19], v202 offset:26624
    buffer_load_dwordx4 v199, s[12:15], s52 offen offset:1024 lds
    v_mfma_f32_16x16x32_bf16 v[160:163], a[48:51], a[4:7], v[160:163]
    ds_read_b128 a[20:23], v202 offset:28672
    v_mfma_f32_16x16x32_bf16 v[164:167], a[52:55], a[4:7], v[164:167]
    ds_read_b128 a[24:27], v202 offset:30720
    v_mfma_f32_16x16x32_bf16 v[168:171], a[56:59], a[4:7], v[168:171]
    v_mfma_f32_16x16x32_bf16 v[172:175], a[60:63], a[4:7], v[172:175]
    buffer_load_dwordx4 v200, s[12:15], s52 offen offset:2048 lds
    v_mfma_f32_16x16x32_bf16 v[176:179], a[48:51], a[8:11], v[176:179]
    ds_read_b128 a[0:3], v202 offset:32768
    v_mfma_f32_16x16x32_bf16 v[180:183], a[52:55], a[8:11], v[180:183]
    v_mfma_f32_16x16x32_bf16 v[184:187], a[56:59], a[8:11], v[184:187]
    buffer_load_dwordx4 v201, s[12:15], s52 offen offset:3072 lds
    v_mfma_f32_16x16x32_bf16 v[188:191], a[60:63], a[8:11], v[188:191]
    s_waitcnt lgkmcnt(4)
    v_mfma_f32_16x16x32_bf16 v[0:3], a[32:35], a[12:15], v[0:3]
    ds_read_b128 a[4:7], v202 offset:34816
    v_mfma_f32_16x16x32_bf16 v[4:7], a[36:39], a[12:15], v[4:7]
    s_add_u32 m0, s70, 0
    v_mfma_f32_16x16x32_bf16 v[8:11], a[40:43], a[12:15], v[8:11]
    buffer_load_dwordx4 v198, s[12:15], s53 offen lds
    v_mfma_f32_16x16x32_bf16 v[12:15], a[44:47], a[12:15], v[12:15]
    s_waitcnt lgkmcnt(4)
    v_mfma_f32_16x16x32_bf16 v[16:19], a[32:35], a[16:19], v[16:19]
    ds_read_b128 a[8:11], v202 offset:36864
    v_mfma_f32_16x16x32_bf16 v[20:23], a[36:39], a[16:19], v[20:23]
    v_mfma_f32_16x16x32_bf16 v[24:27], a[40:43], a[16:19], v[24:27]
    buffer_load_dwordx4 v199, s[12:15], s53 offen offset:1024 lds
    v_mfma_f32_16x16x32_bf16 v[28:31], a[44:47], a[16:19], v[28:31]
    s_waitcnt lgkmcnt(4)
    v_mfma_f32_16x16x32_bf16 v[32:35], a[32:35], a[20:23], v[32:35]
    ds_read_b128 a[12:15], v202 offset:38912
    v_mfma_f32_16x16x32_bf16 v[36:39], a[36:39], a[20:23], v[36:39]
    v_mfma_f32_16x16x32_bf16 v[40:43], a[40:43], a[20:23], v[40:43]
    buffer_load_dwordx4 v200, s[12:15], s53 offen offset:2048 lds
    v_mfma_f32_16x16x32_bf16 v[44:47], a[44:47], a[20:23], v[44:47]
    s_waitcnt lgkmcnt(4)
    v_mfma_f32_16x16x32_bf16 v[48:51], a[32:35], a[24:27], v[48:51]
    ds_read_b128 a[16:19], v202 offset:40960
    v_mfma_f32_16x16x32_bf16 v[52:55], a[36:39], a[24:27], v[52:55]
    v_mfma_f32_16x16x32_bf16 v[56:59], a[40:43], a[24:27], v[56:59]
    buffer_load_dwordx4 v201, s[12:15], s53 offen offset:3072 lds
    v_mfma_f32_16x16x32_bf16 v[60:63], a[44:47], a[24:27], v[60:63]
    s_waitcnt lgkmcnt(4)
    v_mfma_f32_16x16x32_bf16 v[64:67], a[32:35], a[0:3], v[64:67]
    ds_read_b128 a[20:23], v202 offset:43008
    v_mfma_f32_16x16x32_bf16 v[68:71], a[36:39], a[0:3], v[68:71]
    s_add_u32 m0, s69, 0
    v_mfma_f32_16x16x32_bf16 v[72:75], a[40:43], a[0:3], v[72:75]
    buffer_load_dwordx4 v192, s[8:11], s43 offen lds
    v_mfma_f32_16x16x32_bf16 v[76:79], a[44:47], a[0:3], v[76:79]
    s_waitcnt lgkmcnt(4)
    v_mfma_f32_16x16x32_bf16 v[80:83], a[32:35], a[4:7], v[80:83]
    ds_read_b128 a[24:27], v202 offset:45056
    v_mfma_f32_16x16x32_bf16 v[84:87], a[36:39], a[4:7], v[84:87]
    v_mfma_f32_16x16x32_bf16 v[88:91], a[40:43], a[4:7], v[88:91]
    buffer_load_dwordx4 v193, s[8:11], s43 offen offset:1024 lds
    v_mfma_f32_16x16x32_bf16 v[92:95], a[44:47], a[4:7], v[92:95]
    s_waitcnt lgkmcnt(4)
    v_mfma_f32_16x16x32_bf16 v[96:99], a[32:35], a[8:11], v[96:99]
    ds_read_b128 a[0:3], v202 offset:47104
    v_mfma_f32_16x16x32_bf16 v[100:103], a[36:39], a[8:11], v[100:103]
    v_mfma_f32_16x16x32_bf16 v[104:107], a[40:43], a[8:11], v[104:107]
    buffer_load_dwordx4 v194, s[8:11], s43 offen offset:2048 lds
    v_mfma_f32_16x16x32_bf16 v[108:111], a[44:47], a[8:11], v[108:111]
    s_waitcnt lgkmcnt(4)
    v_mfma_f32_16x16x32_bf16 v[112:115], a[32:35], a[12:15], v[112:115]
    v_mfma_f32_16x16x32_bf16 v[116:119], a[36:39], a[12:15], v[116:119]
    s_waitcnt vmcnt(17)
    s_waitcnt lgkmcnt(0)
    s_barrier
    v_mfma_f32_16x16x32_bf16 v[120:123], a[40:43], a[12:15], v[120:123]
    ds_read_b64_tr_b16 a[48:49], v206 offset:49152
    v_mfma_f32_16x16x32_bf16 v[124:127], a[44:47], a[12:15], v[124:127]
    ds_read_b64_tr_b16 a[50:51], v206 offset:50176
    buffer_load_dwordx4 v195, s[8:11], s43 offen offset:3072 lds
    v_mfma_f32_16x16x32_bf16 v[128:131], a[32:35], a[16:19], v[128:131]
    ds_read_b64_tr_b16 a[52:53], v208 offset:49152
    v_mfma_f32_16x16x32_bf16 v[132:135], a[36:39], a[16:19], v[132:135]
    ds_read_b64_tr_b16 a[54:55], v208 offset:50176
    v_mfma_f32_16x16x32_bf16 v[136:139], a[40:43], a[16:19], v[136:139]
    ds_read_b64_tr_b16 a[56:57], v206 offset:57344
    s_add_u32 m0, s69, 4096
    v_mfma_f32_16x16x32_bf16 v[140:143], a[44:47], a[16:19], v[140:143]
    ds_read_b64_tr_b16 a[58:59], v206 offset:58368
    buffer_load_dwordx4 v196, s[8:11], s43 offen lds
    v_mfma_f32_16x16x32_bf16 v[144:147], a[32:35], a[20:23], v[144:147]
    ds_read_b64_tr_b16 a[60:61], v208 offset:57344
    v_mfma_f32_16x16x32_bf16 v[148:151], a[36:39], a[20:23], v[148:151]
    ds_read_b64_tr_b16 a[62:63], v208 offset:58368
    v_mfma_f32_16x16x32_bf16 v[152:155], a[40:43], a[20:23], v[152:155]
    ds_read_b128 a[4:7], v204 offset:24576
    v_mfma_f32_16x16x32_bf16 v[156:159], a[44:47], a[20:23], v[156:159]
    ds_read_b128 a[8:11], v204 offset:26624
    buffer_load_dwordx4 v197, s[8:11], s43 offen offset:1024 lds
    v_mfma_f32_16x16x32_bf16 v[160:163], a[32:35], a[24:27], v[160:163]
    ds_read_b128 a[12:15], v204 offset:28672
    v_mfma_f32_16x16x32_bf16 v[164:167], a[36:39], a[24:27], v[164:167]
    ds_read_b128 a[16:19], v204 offset:30720
    v_mfma_f32_16x16x32_bf16 v[168:171], a[40:43], a[24:27], v[168:171]
    s_add_u32 m0, s70, 16384
    v_mfma_f32_16x16x32_bf16 v[172:175], a[44:47], a[24:27], v[172:175]
    buffer_load_dwordx4 v198, s[12:15], s54 offen lds
    v_mfma_f32_16x16x32_bf16 v[176:179], a[32:35], a[0:3], v[176:179]
    ds_read_b128 a[20:23], v204 offset:32768
    v_mfma_f32_16x16x32_bf16 v[180:183], a[36:39], a[0:3], v[180:183]
    v_mfma_f32_16x16x32_bf16 v[184:187], a[40:43], a[0:3], v[184:187]
    buffer_load_dwordx4 v199, s[12:15], s54 offen offset:1024 lds
    v_mfma_f32_16x16x32_bf16 v[188:191], a[44:47], a[0:3], v[188:191]
    s_waitcnt lgkmcnt(4)
    v_mfma_f32_16x16x32_bf16 v[0:3], a[48:51], a[4:7], v[0:3]
    ds_read_b128 a[24:27], v204 offset:34816
    v_mfma_f32_16x16x32_bf16 v[4:7], a[52:55], a[4:7], v[4:7]
    v_mfma_f32_16x16x32_bf16 v[8:11], a[56:59], a[4:7], v[8:11]
    buffer_load_dwordx4 v200, s[12:15], s54 offen offset:2048 lds
    v_mfma_f32_16x16x32_bf16 v[12:15], a[60:63], a[4:7], v[12:15]
    s_waitcnt lgkmcnt(4)
    v_mfma_f32_16x16x32_bf16 v[16:19], a[48:51], a[8:11], v[16:19]
    ds_read_b128 a[0:3], v204 offset:36864
    v_mfma_f32_16x16x32_bf16 v[20:23], a[52:55], a[8:11], v[20:23]
    v_mfma_f32_16x16x32_bf16 v[24:27], a[56:59], a[8:11], v[24:27]
    buffer_load_dwordx4 v201, s[12:15], s54 offen offset:3072 lds
    v_mfma_f32_16x16x32_bf16 v[28:31], a[60:63], a[8:11], v[28:31]
    s_waitcnt lgkmcnt(4)
    v_mfma_f32_16x16x32_bf16 v[32:35], a[48:51], a[12:15], v[32:35]
    ds_read_b128 a[4:7], v204 offset:38912
    v_mfma_f32_16x16x32_bf16 v[36:39], a[52:55], a[12:15], v[36:39]
    s_add_u32 m0, s70, 32768
    v_mfma_f32_16x16x32_bf16 v[40:43], a[56:59], a[12:15], v[40:43]
    buffer_load_dwordx4 v198, s[12:15], s55 offen lds
    v_mfma_f32_16x16x32_bf16 v[44:47], a[60:63], a[12:15], v[44:47]
    s_waitcnt lgkmcnt(4)
    v_mfma_f32_16x16x32_bf16 v[48:51], a[48:51], a[16:19], v[48:51]
    ds_read_b128 a[8:11], v204 offset:40960
    v_mfma_f32_16x16x32_bf16 v[52:55], a[52:55], a[16:19], v[52:55]
    v_mfma_f32_16x16x32_bf16 v[56:59], a[56:59], a[16:19], v[56:59]
    buffer_load_dwordx4 v199, s[12:15], s55 offen offset:1024 lds
    v_mfma_f32_16x16x32_bf16 v[60:63], a[60:63], a[16:19], v[60:63]
    s_waitcnt lgkmcnt(4)
    v_mfma_f32_16x16x32_bf16 v[64:67], a[48:51], a[20:23], v[64:67]
    ds_read_b128 a[12:15], v204 offset:43008
    v_mfma_f32_16x16x32_bf16 v[68:71], a[52:55], a[20:23], v[68:71]
    v_mfma_f32_16x16x32_bf16 v[72:75], a[56:59], a[20:23], v[72:75]
    buffer_load_dwordx4 v200, s[12:15], s55 offen offset:2048 lds
    v_mfma_f32_16x16x32_bf16 v[76:79], a[60:63], a[20:23], v[76:79]
    s_waitcnt lgkmcnt(4)
    v_mfma_f32_16x16x32_bf16 v[80:83], a[48:51], a[24:27], v[80:83]
    ds_read_b128 a[16:19], v204 offset:45056
    v_mfma_f32_16x16x32_bf16 v[84:87], a[52:55], a[24:27], v[84:87]
    v_mfma_f32_16x16x32_bf16 v[88:91], a[56:59], a[24:27], v[88:91]
    buffer_load_dwordx4 v201, s[12:15], s55 offen offset:3072 lds
    v_mfma_f32_16x16x32_bf16 v[92:95], a[60:63], a[24:27], v[92:95]
    s_waitcnt lgkmcnt(4)
    v_mfma_f32_16x16x32_bf16 v[96:99], a[48:51], a[0:3], v[96:99]
    ds_read_b128 a[20:23], v204 offset:47104
    v_mfma_f32_16x16x32_bf16 v[100:103], a[52:55], a[0:3], v[100:103]
    v_mfma_f32_16x16x32_bf16 v[104:107], a[56:59], a[0:3], v[104:107]
    v_mfma_f32_16x16x32_bf16 v[108:111], a[60:63], a[0:3], v[108:111]
    s_waitcnt lgkmcnt(4)
    v_mfma_f32_16x16x32_bf16 v[112:115], a[48:51], a[4:7], v[112:115]
    v_mfma_f32_16x16x32_bf16 v[116:119], a[52:55], a[4:7], v[116:119]
    s_waitcnt vmcnt(18)
    s_waitcnt lgkmcnt(0)
    s_barrier
    v_mfma_f32_16x16x32_bf16 v[120:123], a[56:59], a[4:7], v[120:123]
    ds_read_b64_tr_b16 a[32:33], v207
    v_mfma_f32_16x16x32_bf16 v[124:127], a[60:63], a[4:7], v[124:127]
    ds_read_b64_tr_b16 a[34:35], v207 offset:1024
    v_mfma_f32_16x16x32_bf16 v[128:131], a[48:51], a[8:11], v[128:131]
    ds_read_b64_tr_b16 a[36:37], v209
    v_mfma_f32_16x16x32_bf16 v[132:135], a[52:55], a[8:11], v[132:135]
    ds_read_b64_tr_b16 a[38:39], v209 offset:1024
    v_mfma_f32_16x16x32_bf16 v[136:139], a[56:59], a[8:11], v[136:139]
    ds_read_b64_tr_b16 a[40:41], v207 offset:8192
    v_mfma_f32_16x16x32_bf16 v[140:143], a[60:63], a[8:11], v[140:143]
    ds_read_b64_tr_b16 a[42:43], v207 offset:9216
    v_mfma_f32_16x16x32_bf16 v[144:147], a[48:51], a[12:15], v[144:147]
    ds_read_b64_tr_b16 a[44:45], v209 offset:8192
    v_mfma_f32_16x16x32_bf16 v[148:151], a[52:55], a[12:15], v[148:151]
    ds_read_b64_tr_b16 a[46:47], v209 offset:9216
    v_mfma_f32_16x16x32_bf16 v[152:155], a[56:59], a[12:15], v[152:155]
    ds_read_b128 a[24:27], v202 offset:49152
    v_mfma_f32_16x16x32_bf16 v[156:159], a[60:63], a[12:15], v[156:159]
    ds_read_b128 a[0:3], v202 offset:51200
    v_mfma_f32_16x16x32_bf16 v[160:163], a[48:51], a[16:19], v[160:163]
    ds_read_b128 a[4:7], v202 offset:53248
    v_mfma_f32_16x16x32_bf16 v[164:167], a[52:55], a[16:19], v[164:167]
    ds_read_b128 a[8:11], v202 offset:55296
    v_mfma_f32_16x16x32_bf16 v[168:171], a[56:59], a[16:19], v[168:171]
    v_mfma_f32_16x16x32_bf16 v[172:175], a[60:63], a[16:19], v[172:175]
    v_mfma_f32_16x16x32_bf16 v[176:179], a[48:51], a[20:23], v[176:179]
    ds_read_b128 a[12:15], v202 offset:57344
    v_mfma_f32_16x16x32_bf16 v[180:183], a[52:55], a[20:23], v[180:183]
    s_add_u32 m0, s69, 24576
    v_mfma_f32_16x16x32_bf16 v[184:187], a[56:59], a[20:23], v[184:187]
    buffer_load_dwordx4 v192, s[8:11], s44 offen lds
    v_mfma_f32_16x16x32_bf16 v[188:191], a[60:63], a[20:23], v[188:191]
    s_waitcnt lgkmcnt(4)
    v_mfma_f32_16x16x32_bf16 v[0:3], a[32:35], a[24:27], v[0:3]
    ds_read_b128 a[16:19], v202 offset:59392
    v_mfma_f32_16x16x32_bf16 v[4:7], a[36:39], a[24:27], v[4:7]
    v_mfma_f32_16x16x32_bf16 v[8:11], a[40:43], a[24:27], v[8:11]
    buffer_load_dwordx4 v193, s[8:11], s44 offen offset:1024 lds
    v_mfma_f32_16x16x32_bf16 v[12:15], a[44:47], a[24:27], v[12:15]
    s_waitcnt lgkmcnt(4)
    v_mfma_f32_16x16x32_bf16 v[16:19], a[32:35], a[0:3], v[16:19]
    ds_read_b128 a[20:23], v202 offset:61440
    v_mfma_f32_16x16x32_bf16 v[20:23], a[36:39], a[0:3], v[20:23]
    v_mfma_f32_16x16x32_bf16 v[24:27], a[40:43], a[0:3], v[24:27]
    buffer_load_dwordx4 v194, s[8:11], s44 offen offset:2048 lds
    v_mfma_f32_16x16x32_bf16 v[28:31], a[44:47], a[0:3], v[28:31]
    s_waitcnt lgkmcnt(4)
    v_mfma_f32_16x16x32_bf16 v[32:35], a[32:35], a[4:7], v[32:35]
    ds_read_b128 a[24:27], v202 offset:63488
    v_mfma_f32_16x16x32_bf16 v[36:39], a[36:39], a[4:7], v[36:39]
    v_mfma_f32_16x16x32_bf16 v[40:43], a[40:43], a[4:7], v[40:43]
    buffer_load_dwordx4 v195, s[8:11], s44 offen offset:3072 lds
    v_mfma_f32_16x16x32_bf16 v[44:47], a[44:47], a[4:7], v[44:47]
    s_waitcnt lgkmcnt(4)
    v_mfma_f32_16x16x32_bf16 v[48:51], a[32:35], a[8:11], v[48:51]
    ds_read_b128 a[0:3], v203
    v_mfma_f32_16x16x32_bf16 v[52:55], a[36:39], a[8:11], v[52:55]
    s_add_u32 m0, s69, 28672
    v_mfma_f32_16x16x32_bf16 v[56:59], a[40:43], a[8:11], v[56:59]
    buffer_load_dwordx4 v196, s[8:11], s44 offen lds
    v_mfma_f32_16x16x32_bf16 v[60:63], a[44:47], a[8:11], v[60:63]
    s_waitcnt lgkmcnt(4)
    v_mfma_f32_16x16x32_bf16 v[64:67], a[32:35], a[12:15], v[64:67]
    ds_read_b128 a[4:7], v203 offset:2048
    v_mfma_f32_16x16x32_bf16 v[68:71], a[36:39], a[12:15], v[68:71]
    v_mfma_f32_16x16x32_bf16 v[72:75], a[40:43], a[12:15], v[72:75]
    buffer_load_dwordx4 v197, s[8:11], s44 offen offset:1024 lds
    v_mfma_f32_16x16x32_bf16 v[76:79], a[44:47], a[12:15], v[76:79]
    s_waitcnt lgkmcnt(4)
    v_mfma_f32_16x16x32_bf16 v[80:83], a[32:35], a[16:19], v[80:83]
    ds_read_b128 a[8:11], v203 offset:4096
    v_mfma_f32_16x16x32_bf16 v[84:87], a[36:39], a[16:19], v[84:87]
    s_add_u32 m0, s70, 49152
    v_mfma_f32_16x16x32_bf16 v[88:91], a[40:43], a[16:19], v[88:91]
    buffer_load_dwordx4 v198, s[12:15], s56 offen lds
    v_mfma_f32_16x16x32_bf16 v[92:95], a[44:47], a[16:19], v[92:95]
    s_waitcnt lgkmcnt(4)
    v_mfma_f32_16x16x32_bf16 v[96:99], a[32:35], a[20:23], v[96:99]
    ds_read_b128 a[12:15], v203 offset:6144
    v_mfma_f32_16x16x32_bf16 v[100:103], a[36:39], a[20:23], v[100:103]
    v_mfma_f32_16x16x32_bf16 v[104:107], a[40:43], a[20:23], v[104:107]
    buffer_load_dwordx4 v199, s[12:15], s56 offen offset:1024 lds
    v_mfma_f32_16x16x32_bf16 v[108:111], a[44:47], a[20:23], v[108:111]
    s_waitcnt lgkmcnt(4)
    v_mfma_f32_16x16x32_bf16 v[112:115], a[32:35], a[24:27], v[112:115]
    v_mfma_f32_16x16x32_bf16 v[116:119], a[36:39], a[24:27], v[116:119]
    s_waitcnt vmcnt(22)
    s_waitcnt lgkmcnt(0)
    s_barrier
    v_mfma_f32_16x16x32_bf16 v[120:123], a[40:43], a[24:27], v[120:123]
    ds_read_b64_tr_b16 a[48:49], v206
    buffer_load_dword v239, v255, s[20:23], s96 offen
    v_mfma_f32_16x16x32_bf16 v[124:127], a[44:47], a[24:27], v[124:127]
    ds_read_b64_tr_b16 a[50:51], v206 offset:1024
    v_mfma_f32_16x16x32_bf16 v[128:131], a[32:35], a[0:3], v[128:131]
    ds_read_b64_tr_b16 a[52:53], v208
    v_mfma_f32_16x16x32_bf16 v[132:135], a[36:39], a[0:3], v[132:135]
    ds_read_b64_tr_b16 a[54:55], v208 offset:1024
    v_mfma_f32_16x16x32_bf16 v[136:139], a[40:43], a[0:3], v[136:139]
    ds_read_b64_tr_b16 a[56:57], v206 offset:8192
    v_mfma_f32_16x16x32_bf16 v[140:143], a[44:47], a[0:3], v[140:143]
    ds_read_b64_tr_b16 a[58:59], v206 offset:9216
    v_mfma_f32_16x16x32_bf16 v[144:147], a[32:35], a[4:7], v[144:147]
    ds_read_b64_tr_b16 a[60:61], v208 offset:8192
    v_mfma_f32_16x16x32_bf16 v[148:151], a[36:39], a[4:7], v[148:151]
    ds_read_b64_tr_b16 a[62:63], v208 offset:9216
    v_mfma_f32_16x16x32_bf16 v[152:155], a[40:43], a[4:7], v[152:155]
    ds_read_b128 a[16:19], v204 offset:49152
    v_mfma_f32_16x16x32_bf16 v[156:159], a[44:47], a[4:7], v[156:159]
    ds_read_b128 a[20:23], v204 offset:51200
    v_mfma_f32_16x16x32_bf16 v[160:163], a[32:35], a[8:11], v[160:163]
    ds_read_b128 a[24:27], v204 offset:53248
    v_mfma_f32_16x16x32_bf16 v[164:167], a[36:39], a[8:11], v[164:167]
    ds_read_b128 a[0:3], v204 offset:55296
    v_mfma_f32_16x16x32_bf16 v[168:171], a[40:43], a[8:11], v[168:171]
    v_mfma_f32_16x16x32_bf16 v[172:175], a[44:47], a[8:11], v[172:175]
    v_mfma_f32_16x16x32_bf16 v[176:179], a[32:35], a[12:15], v[176:179]
    ds_read_b128 a[4:7], v204 offset:57344
    v_mfma_f32_16x16x32_bf16 v[180:183], a[36:39], a[12:15], v[180:183]
    v_mfma_f32_16x16x32_bf16 v[184:187], a[40:43], a[12:15], v[184:187]
    buffer_load_dwordx4 v200, s[12:15], s56 offen offset:2048 lds
    v_mfma_f32_16x16x32_bf16 v[188:191], a[44:47], a[12:15], v[188:191]
    s_waitcnt lgkmcnt(4)
    v_mfma_f32_16x16x32_bf16 v[0:3], a[48:51], a[16:19], v[0:3]
    ds_read_b128 a[8:11], v204 offset:59392
    v_mfma_f32_16x16x32_bf16 v[4:7], a[52:55], a[16:19], v[4:7]
    v_mfma_f32_16x16x32_bf16 v[8:11], a[56:59], a[16:19], v[8:11]
    buffer_load_dwordx4 v201, s[12:15], s56 offen offset:3072 lds
    v_mfma_f32_16x16x32_bf16 v[12:15], a[60:63], a[16:19], v[12:15]
    s_waitcnt lgkmcnt(4)
    v_mfma_f32_16x16x32_bf16 v[16:19], a[48:51], a[20:23], v[16:19]
    ds_read_b128 a[12:15], v204 offset:61440
    v_mfma_f32_16x16x32_bf16 v[20:23], a[52:55], a[20:23], v[20:23]
    s_add_u32 m0, s70, 65536
    v_mfma_f32_16x16x32_bf16 v[24:27], a[56:59], a[20:23], v[24:27]
    buffer_load_dwordx4 v198, s[12:15], s57 offen lds
    v_mfma_f32_16x16x32_bf16 v[28:31], a[60:63], a[20:23], v[28:31]
    s_waitcnt lgkmcnt(4)
    v_mfma_f32_16x16x32_bf16 v[32:35], a[48:51], a[24:27], v[32:35]
    ds_read_b128 a[16:19], v204 offset:63488
    v_mfma_f32_16x16x32_bf16 v[36:39], a[52:55], a[24:27], v[36:39]
    v_mfma_f32_16x16x32_bf16 v[40:43], a[56:59], a[24:27], v[40:43]
    buffer_load_dwordx4 v199, s[12:15], s57 offen offset:1024 lds
    v_mfma_f32_16x16x32_bf16 v[44:47], a[60:63], a[24:27], v[44:47]
    s_waitcnt lgkmcnt(4)
    v_mfma_f32_16x16x32_bf16 v[48:51], a[48:51], a[0:3], v[48:51]
    ds_read_b128 a[20:23], v205
    v_mfma_f32_16x16x32_bf16 v[52:55], a[52:55], a[0:3], v[52:55]
    v_mfma_f32_16x16x32_bf16 v[56:59], a[56:59], a[0:3], v[56:59]
    buffer_load_dwordx4 v200, s[12:15], s57 offen offset:2048 lds
    v_mfma_f32_16x16x32_bf16 v[60:63], a[60:63], a[0:3], v[60:63]
    s_waitcnt lgkmcnt(4)
    v_mfma_f32_16x16x32_bf16 v[64:67], a[48:51], a[4:7], v[64:67]
    ds_read_b128 a[24:27], v205 offset:2048
    v_mfma_f32_16x16x32_bf16 v[68:71], a[52:55], a[4:7], v[68:71]
    v_mfma_f32_16x16x32_bf16 v[72:75], a[56:59], a[4:7], v[72:75]
    buffer_load_dwordx4 v201, s[12:15], s57 offen offset:3072 lds
    v_mfma_f32_16x16x32_bf16 v[76:79], a[60:63], a[4:7], v[76:79]
    s_waitcnt lgkmcnt(4)
    v_mfma_f32_16x16x32_bf16 v[80:83], a[48:51], a[8:11], v[80:83]
    ds_read_b128 a[0:3], v205 offset:4096
    v_mfma_f32_16x16x32_bf16 v[84:87], a[52:55], a[8:11], v[84:87]
    v_mfma_f32_16x16x32_bf16 v[88:91], a[56:59], a[8:11], v[88:91]
    v_mfma_f32_16x16x32_bf16 v[92:95], a[60:63], a[8:11], v[92:95]
    s_waitcnt lgkmcnt(4)
    v_mfma_f32_16x16x32_bf16 v[96:99], a[48:51], a[12:15], v[96:99]
    ds_read_b128 a[4:7], v205 offset:6144
    v_mfma_f32_16x16x32_bf16 v[100:103], a[52:55], a[12:15], v[100:103]
    v_mfma_f32_16x16x32_bf16 v[104:107], a[56:59], a[12:15], v[104:107]
    v_mfma_f32_16x16x32_bf16 v[108:111], a[60:63], a[12:15], v[108:111]
    s_waitcnt lgkmcnt(4)
    v_mfma_f32_16x16x32_bf16 v[112:115], a[48:51], a[16:19], v[112:115]
    v_mfma_f32_16x16x32_bf16 v[116:119], a[52:55], a[16:19], v[116:119]
    s_waitcnt vmcnt(19)
    s_waitcnt lgkmcnt(0)
    s_barrier
    v_mfma_f32_16x16x32_bf16 v[120:123], a[56:59], a[16:19], v[120:123]
    ds_read_b64_tr_b16 a[32:33], v206 offset:16384
    buffer_load_dword v239, v255, s[20:23], s97 offen
    v_mfma_f32_16x16x32_bf16 v[124:127], a[60:63], a[16:19], v[124:127]
    ds_read_b64_tr_b16 a[34:35], v206 offset:17408
    v_mfma_f32_16x16x32_bf16 v[128:131], a[48:51], a[20:23], v[128:131]
    ds_read_b64_tr_b16 a[36:37], v208 offset:16384
    v_mfma_f32_16x16x32_bf16 v[132:135], a[52:55], a[20:23], v[132:135]
    ds_read_b64_tr_b16 a[38:39], v208 offset:17408
    v_mfma_f32_16x16x32_bf16 v[136:139], a[56:59], a[20:23], v[136:139]
    ds_read_b64_tr_b16 a[40:41], v206 offset:24576
    v_mfma_f32_16x16x32_bf16 v[140:143], a[60:63], a[20:23], v[140:143]
    ds_read_b64_tr_b16 a[42:43], v206 offset:25600
    v_mfma_f32_16x16x32_bf16 v[144:147], a[48:51], a[24:27], v[144:147]
    ds_read_b64_tr_b16 a[44:45], v208 offset:24576
    v_mfma_f32_16x16x32_bf16 v[148:151], a[52:55], a[24:27], v[148:151]
    ds_read_b64_tr_b16 a[46:47], v208 offset:25600
    v_mfma_f32_16x16x32_bf16 v[152:155], a[56:59], a[24:27], v[152:155]
    ds_read_b128 a[8:11], v202
    v_mfma_f32_16x16x32_bf16 v[156:159], a[60:63], a[24:27], v[156:159]
    ds_read_b128 a[12:15], v202 offset:2048
    v_mfma_f32_16x16x32_bf16 v[160:163], a[48:51], a[0:3], v[160:163]
    ds_read_b128 a[16:19], v202 offset:4096
    v_mfma_f32_16x16x32_bf16 v[164:167], a[52:55], a[0:3], v[164:167]
    ds_read_b128 a[20:23], v202 offset:6144
    v_mfma_f32_16x16x32_bf16 v[168:171], a[56:59], a[0:3], v[168:171]
    v_mfma_f32_16x16x32_bf16 v[172:175], a[60:63], a[0:3], v[172:175]
    v_mfma_f32_16x16x32_bf16 v[176:179], a[48:51], a[4:7], v[176:179]
    ds_read_b128 a[24:27], v202 offset:8192
    v_mfma_f32_16x16x32_bf16 v[180:183], a[52:55], a[4:7], v[180:183]
    s_add_u32 m0, s69, 49152
    v_mfma_f32_16x16x32_bf16 v[184:187], a[56:59], a[4:7], v[184:187]
    buffer_load_dwordx4 v192, s[8:11], s45 offen lds
    v_mfma_f32_16x16x32_bf16 v[188:191], a[60:63], a[4:7], v[188:191]
    s_waitcnt lgkmcnt(4)
    v_mfma_f32_16x16x32_bf16 v[0:3], a[32:35], a[8:11], v[0:3]
    ds_read_b128 a[0:3], v202 offset:10240
    v_mfma_f32_16x16x32_bf16 v[4:7], a[36:39], a[8:11], v[4:7]
    v_mfma_f32_16x16x32_bf16 v[8:11], a[40:43], a[8:11], v[8:11]
    buffer_load_dwordx4 v193, s[8:11], s45 offen offset:1024 lds
    v_mfma_f32_16x16x32_bf16 v[12:15], a[44:47], a[8:11], v[12:15]
    s_waitcnt lgkmcnt(4)
    v_mfma_f32_16x16x32_bf16 v[16:19], a[32:35], a[12:15], v[16:19]
    ds_read_b128 a[4:7], v202 offset:12288
    v_mfma_f32_16x16x32_bf16 v[20:23], a[36:39], a[12:15], v[20:23]
    v_mfma_f32_16x16x32_bf16 v[24:27], a[40:43], a[12:15], v[24:27]
    buffer_load_dwordx4 v194, s[8:11], s45 offen offset:2048 lds
    v_mfma_f32_16x16x32_bf16 v[28:31], a[44:47], a[12:15], v[28:31]
    s_waitcnt lgkmcnt(4)
    v_mfma_f32_16x16x32_bf16 v[32:35], a[32:35], a[16:19], v[32:35]
    ds_read_b128 a[8:11], v202 offset:14336
    v_mfma_f32_16x16x32_bf16 v[36:39], a[36:39], a[16:19], v[36:39]
    v_mfma_f32_16x16x32_bf16 v[40:43], a[40:43], a[16:19], v[40:43]
    buffer_load_dwordx4 v195, s[8:11], s45 offen offset:3072 lds
    v_mfma_f32_16x16x32_bf16 v[44:47], a[44:47], a[16:19], v[44:47]
    s_waitcnt lgkmcnt(4)
    v_mfma_f32_16x16x32_bf16 v[48:51], a[32:35], a[20:23], v[48:51]
    ds_read_b128 a[12:15], v202 offset:16384
    v_mfma_f32_16x16x32_bf16 v[52:55], a[36:39], a[20:23], v[52:55]
    s_add_u32 m0, s69, 53248
    v_mfma_f32_16x16x32_bf16 v[56:59], a[40:43], a[20:23], v[56:59]
    buffer_load_dwordx4 v196, s[8:11], s45 offen lds
    v_mfma_f32_16x16x32_bf16 v[60:63], a[44:47], a[20:23], v[60:63]
    s_waitcnt lgkmcnt(4)
    v_mfma_f32_16x16x32_bf16 v[64:67], a[32:35], a[24:27], v[64:67]
    ds_read_b128 a[16:19], v202 offset:18432
    v_mfma_f32_16x16x32_bf16 v[68:71], a[36:39], a[24:27], v[68:71]
    v_mfma_f32_16x16x32_bf16 v[72:75], a[40:43], a[24:27], v[72:75]
    buffer_load_dwordx4 v197, s[8:11], s45 offen offset:1024 lds
    v_mfma_f32_16x16x32_bf16 v[76:79], a[44:47], a[24:27], v[76:79]
    s_waitcnt lgkmcnt(4)
    v_mfma_f32_16x16x32_bf16 v[80:83], a[32:35], a[0:3], v[80:83]
    ds_read_b128 a[20:23], v202 offset:20480
    v_mfma_f32_16x16x32_bf16 v[84:87], a[36:39], a[0:3], v[84:87]
    s_add_u32 m0, s70, 0
    v_mfma_f32_16x16x32_bf16 v[88:91], a[40:43], a[0:3], v[88:91]
    buffer_load_dwordx4 v198, s[12:15], s58 offen lds
    v_mfma_f32_16x16x32_bf16 v[92:95], a[44:47], a[0:3], v[92:95]
    s_waitcnt lgkmcnt(4)
    v_mfma_f32_16x16x32_bf16 v[96:99], a[32:35], a[4:7], v[96:99]
    ds_read_b128 a[24:27], v202 offset:22528
    v_mfma_f32_16x16x32_bf16 v[100:103], a[36:39], a[4:7], v[100:103]
    v_mfma_f32_16x16x32_bf16 v[104:107], a[40:43], a[4:7], v[104:107]
    buffer_load_dwordx4 v199, s[12:15], s58 offen offset:1024 lds
    v_mfma_f32_16x16x32_bf16 v[108:111], a[44:47], a[4:7], v[108:111]
    s_waitcnt lgkmcnt(4)
    v_mfma_f32_16x16x32_bf16 v[112:115], a[32:35], a[8:11], v[112:115]
    v_mfma_f32_16x16x32_bf16 v[116:119], a[36:39], a[8:11], v[116:119]
    s_waitcnt vmcnt(24)
    s_waitcnt lgkmcnt(0)
    s_barrier
    v_mfma_f32_16x16x32_bf16 v[120:123], a[40:43], a[8:11], v[120:123]
    ds_read_b64_tr_b16 a[48:49], v206 offset:32768
    buffer_load_dword v239, v255, s[20:23], s98 offen
    v_mfma_f32_16x16x32_bf16 v[124:127], a[44:47], a[8:11], v[124:127]
    ds_read_b64_tr_b16 a[50:51], v206 offset:33792
    v_mfma_f32_16x16x32_bf16 v[128:131], a[32:35], a[12:15], v[128:131]
    ds_read_b64_tr_b16 a[52:53], v208 offset:32768
    v_mfma_f32_16x16x32_bf16 v[132:135], a[36:39], a[12:15], v[132:135]
    ds_read_b64_tr_b16 a[54:55], v208 offset:33792
    v_mfma_f32_16x16x32_bf16 v[136:139], a[40:43], a[12:15], v[136:139]
    ds_read_b64_tr_b16 a[56:57], v206 offset:40960
    v_mfma_f32_16x16x32_bf16 v[140:143], a[44:47], a[12:15], v[140:143]
    ds_read_b64_tr_b16 a[58:59], v206 offset:41984
    v_mfma_f32_16x16x32_bf16 v[144:147], a[32:35], a[16:19], v[144:147]
    ds_read_b64_tr_b16 a[60:61], v208 offset:40960
    v_mfma_f32_16x16x32_bf16 v[148:151], a[36:39], a[16:19], v[148:151]
    ds_read_b64_tr_b16 a[62:63], v208 offset:41984
    v_mfma_f32_16x16x32_bf16 v[152:155], a[40:43], a[16:19], v[152:155]
    ds_read_b128 a[0:3], v204
    v_mfma_f32_16x16x32_bf16 v[156:159], a[44:47], a[16:19], v[156:159]
    ds_read_b128 a[4:7], v204 offset:2048
    v_mfma_f32_16x16x32_bf16 v[160:163], a[32:35], a[20:23], v[160:163]
    ds_read_b128 a[8:11], v204 offset:4096
    v_mfma_f32_16x16x32_bf16 v[164:167], a[36:39], a[20:23], v[164:167]
    ds_read_b128 a[12:15], v204 offset:6144
    v_mfma_f32_16x16x32_bf16 v[168:171], a[40:43], a[20:23], v[168:171]
    v_mfma_f32_16x16x32_bf16 v[172:175], a[44:47], a[20:23], v[172:175]
    v_mfma_f32_16x16x32_bf16 v[176:179], a[32:35], a[24:27], v[176:179]
    ds_read_b128 a[16:19], v204 offset:8192
    v_mfma_f32_16x16x32_bf16 v[180:183], a[36:39], a[24:27], v[180:183]
    v_mfma_f32_16x16x32_bf16 v[184:187], a[40:43], a[24:27], v[184:187]
    buffer_load_dwordx4 v200, s[12:15], s58 offen offset:2048 lds
    v_mfma_f32_16x16x32_bf16 v[188:191], a[44:47], a[24:27], v[188:191]
    s_waitcnt lgkmcnt(4)
    v_mfma_f32_16x16x32_bf16 v[0:3], a[48:51], a[0:3], v[0:3]
    ds_read_b128 a[20:23], v204 offset:10240
    v_mfma_f32_16x16x32_bf16 v[4:7], a[52:55], a[0:3], v[4:7]
    v_mfma_f32_16x16x32_bf16 v[8:11], a[56:59], a[0:3], v[8:11]
    buffer_load_dwordx4 v201, s[12:15], s58 offen offset:3072 lds
    v_mfma_f32_16x16x32_bf16 v[12:15], a[60:63], a[0:3], v[12:15]
    s_waitcnt lgkmcnt(4)
    v_mfma_f32_16x16x32_bf16 v[16:19], a[48:51], a[4:7], v[16:19]
    ds_read_b128 a[24:27], v204 offset:12288
    v_mfma_f32_16x16x32_bf16 v[20:23], a[52:55], a[4:7], v[20:23]
    s_add_u32 m0, s70, 16384
    v_mfma_f32_16x16x32_bf16 v[24:27], a[56:59], a[4:7], v[24:27]
    buffer_load_dwordx4 v198, s[12:15], s59 offen lds
    v_mfma_f32_16x16x32_bf16 v[28:31], a[60:63], a[4:7], v[28:31]
    s_waitcnt lgkmcnt(4)
    v_mfma_f32_16x16x32_bf16 v[32:35], a[48:51], a[8:11], v[32:35]
    ds_read_b128 a[0:3], v204 offset:14336
    v_mfma_f32_16x16x32_bf16 v[36:39], a[52:55], a[8:11], v[36:39]
    v_mfma_f32_16x16x32_bf16 v[40:43], a[56:59], a[8:11], v[40:43]
    buffer_load_dwordx4 v199, s[12:15], s59 offen offset:1024 lds
    v_mfma_f32_16x16x32_bf16 v[44:47], a[60:63], a[8:11], v[44:47]
    s_waitcnt lgkmcnt(4)
    v_mfma_f32_16x16x32_bf16 v[48:51], a[48:51], a[12:15], v[48:51]
    ds_read_b128 a[4:7], v204 offset:16384
    v_mfma_f32_16x16x32_bf16 v[52:55], a[52:55], a[12:15], v[52:55]
    v_mfma_f32_16x16x32_bf16 v[56:59], a[56:59], a[12:15], v[56:59]
    buffer_load_dwordx4 v200, s[12:15], s59 offen offset:2048 lds
    v_mfma_f32_16x16x32_bf16 v[60:63], a[60:63], a[12:15], v[60:63]
    s_waitcnt lgkmcnt(4)
    v_mfma_f32_16x16x32_bf16 v[64:67], a[48:51], a[16:19], v[64:67]
    ds_read_b128 a[8:11], v204 offset:18432
    v_mfma_f32_16x16x32_bf16 v[68:71], a[52:55], a[16:19], v[68:71]
    v_mfma_f32_16x16x32_bf16 v[72:75], a[56:59], a[16:19], v[72:75]
    buffer_load_dwordx4 v201, s[12:15], s59 offen offset:3072 lds
    v_mfma_f32_16x16x32_bf16 v[76:79], a[60:63], a[16:19], v[76:79]
    s_waitcnt lgkmcnt(4)
    v_mfma_f32_16x16x32_bf16 v[80:83], a[48:51], a[20:23], v[80:83]
    ds_read_b128 a[12:15], v204 offset:20480
    v_mfma_f32_16x16x32_bf16 v[84:87], a[52:55], a[20:23], v[84:87]
    v_mfma_f32_16x16x32_bf16 v[88:91], a[56:59], a[20:23], v[88:91]
    v_mfma_f32_16x16x32_bf16 v[92:95], a[60:63], a[20:23], v[92:95]
    s_waitcnt lgkmcnt(4)
    v_mfma_f32_16x16x32_bf16 v[96:99], a[48:51], a[24:27], v[96:99]
    ds_read_b128 a[16:19], v204 offset:22528
    v_mfma_f32_16x16x32_bf16 v[100:103], a[52:55], a[24:27], v[100:103]
    v_mfma_f32_16x16x32_bf16 v[104:107], a[56:59], a[24:27], v[104:107]
    v_mfma_f32_16x16x32_bf16 v[108:111], a[60:63], a[24:27], v[108:111]
    s_waitcnt lgkmcnt(4)
    v_mfma_f32_16x16x32_bf16 v[112:115], a[48:51], a[0:3], v[112:115]
    v_mfma_f32_16x16x32_bf16 v[116:119], a[52:55], a[0:3], v[116:119]
    s_waitcnt vmcnt(20)
    s_waitcnt lgkmcnt(0)
    s_barrier
    v_mfma_f32_16x16x32_bf16 v[120:123], a[56:59], a[0:3], v[120:123]
    ds_read_b64_tr_b16 a[32:33], v206 offset:49152
    buffer_load_dword v239, v255, s[20:23], s99 offen
    v_mfma_f32_16x16x32_bf16 v[124:127], a[60:63], a[0:3], v[124:127]
    ds_read_b64_tr_b16 a[34:35], v206 offset:50176
    v_mfma_f32_16x16x32_bf16 v[128:131], a[48:51], a[4:7], v[128:131]
    ds_read_b64_tr_b16 a[36:37], v208 offset:49152
    v_mfma_f32_16x16x32_bf16 v[132:135], a[52:55], a[4:7], v[132:135]
    ds_read_b64_tr_b16 a[38:39], v208 offset:50176
    v_mfma_f32_16x16x32_bf16 v[136:139], a[56:59], a[4:7], v[136:139]
    ds_read_b64_tr_b16 a[40:41], v206 offset:57344
    v_mfma_f32_16x16x32_bf16 v[140:143], a[60:63], a[4:7], v[140:143]
    ds_read_b64_tr_b16 a[42:43], v206 offset:58368
    v_mfma_f32_16x16x32_bf16 v[144:147], a[48:51], a[8:11], v[144:147]
    ds_read_b64_tr_b16 a[44:45], v208 offset:57344
    v_mfma_f32_16x16x32_bf16 v[148:151], a[52:55], a[8:11], v[148:151]
    ds_read_b64_tr_b16 a[46:47], v208 offset:58368
    v_mfma_f32_16x16x32_bf16 v[152:155], a[56:59], a[8:11], v[152:155]
    ds_read_b128 a[20:23], v202 offset:24576
    v_mfma_f32_16x16x32_bf16 v[156:159], a[60:63], a[8:11], v[156:159]
    ds_read_b128 a[24:27], v202 offset:26624
    v_mfma_f32_16x16x32_bf16 v[160:163], a[48:51], a[12:15], v[160:163]
    ds_read_b128 a[0:3], v202 offset:28672
    v_mfma_f32_16x16x32_bf16 v[164:167], a[52:55], a[12:15], v[164:167]
    ds_read_b128 a[4:7], v202 offset:30720
    v_mfma_f32_16x16x32_bf16 v[168:171], a[56:59], a[12:15], v[168:171]
    v_mfma_f32_16x16x32_bf16 v[172:175], a[60:63], a[12:15], v[172:175]
    v_mfma_f32_16x16x32_bf16 v[176:179], a[48:51], a[16:19], v[176:179]
    ds_read_b128 a[8:11], v202 offset:32768
    v_mfma_f32_16x16x32_bf16 v[180:183], a[52:55], a[16:19], v[180:183]
    s_add_u32 m0, s69, 0
    v_mfma_f32_16x16x32_bf16 v[184:187], a[56:59], a[16:19], v[184:187]
    buffer_load_dwordx4 v192, s[8:11], s46 offen lds
    v_mfma_f32_16x16x32_bf16 v[188:191], a[60:63], a[16:19], v[188:191]
    s_waitcnt lgkmcnt(4)
    v_mfma_f32_16x16x32_bf16 v[0:3], a[32:35], a[20:23], v[0:3]
    ds_read_b128 a[12:15], v202 offset:34816
    v_mfma_f32_16x16x32_bf16 v[4:7], a[36:39], a[20:23], v[4:7]
    v_mfma_f32_16x16x32_bf16 v[8:11], a[40:43], a[20:23], v[8:11]
    buffer_load_dwordx4 v193, s[8:11], s46 offen offset:1024 lds
    v_mfma_f32_16x16x32_bf16 v[12:15], a[44:47], a[20:23], v[12:15]
    s_waitcnt lgkmcnt(4)
    v_mfma_f32_16x16x32_bf16 v[16:19], a[32:35], a[24:27], v[16:19]
    ds_read_b128 a[16:19], v202 offset:36864
    v_mfma_f32_16x16x32_bf16 v[20:23], a[36:39], a[24:27], v[20:23]
    v_mfma_f32_16x16x32_bf16 v[24:27], a[40:43], a[24:27], v[24:27]
    buffer_load_dwordx4 v194, s[8:11], s46 offen offset:2048 lds
    v_mfma_f32_16x16x32_bf16 v[28:31], a[44:47], a[24:27], v[28:31]
    s_waitcnt lgkmcnt(4)
    v_mfma_f32_16x16x32_bf16 v[32:35], a[32:35], a[0:3], v[32:35]
    ds_read_b128 a[20:23], v202 offset:38912
    v_mfma_f32_16x16x32_bf16 v[36:39], a[36:39], a[0:3], v[36:39]
    v_mfma_f32_16x16x32_bf16 v[40:43], a[40:43], a[0:3], v[40:43]
    buffer_load_dwordx4 v195, s[8:11], s46 offen offset:3072 lds
    v_mfma_f32_16x16x32_bf16 v[44:47], a[44:47], a[0:3], v[44:47]
    s_waitcnt lgkmcnt(4)
    v_mfma_f32_16x16x32_bf16 v[48:51], a[32:35], a[4:7], v[48:51]
    ds_read_b128 a[24:27], v202 offset:40960
    v_mfma_f32_16x16x32_bf16 v[52:55], a[36:39], a[4:7], v[52:55]
    s_add_u32 m0, s69, 4096
    v_mfma_f32_16x16x32_bf16 v[56:59], a[40:43], a[4:7], v[56:59]
    buffer_load_dwordx4 v196, s[8:11], s46 offen lds
    v_mfma_f32_16x16x32_bf16 v[60:63], a[44:47], a[4:7], v[60:63]
    s_waitcnt lgkmcnt(4)
    v_mfma_f32_16x16x32_bf16 v[64:67], a[32:35], a[8:11], v[64:67]
    ds_read_b128 a[0:3], v202 offset:43008
    v_mfma_f32_16x16x32_bf16 v[68:71], a[36:39], a[8:11], v[68:71]
    v_mfma_f32_16x16x32_bf16 v[72:75], a[40:43], a[8:11], v[72:75]
    buffer_load_dwordx4 v197, s[8:11], s46 offen offset:1024 lds
    v_mfma_f32_16x16x32_bf16 v[76:79], a[44:47], a[8:11], v[76:79]
    s_waitcnt lgkmcnt(4)
    v_mfma_f32_16x16x32_bf16 v[80:83], a[32:35], a[12:15], v[80:83]
    ds_read_b128 a[4:7], v202 offset:45056
    v_mfma_f32_16x16x32_bf16 v[84:87], a[36:39], a[12:15], v[84:87]
    s_add_u32 m0, s70, 32768
    v_mfma_f32_16x16x32_bf16 v[88:91], a[40:43], a[12:15], v[88:91]
    buffer_load_dwordx4 v198, s[12:15], s60 offen lds
    v_mfma_f32_16x16x32_bf16 v[92:95], a[44:47], a[12:15], v[92:95]
    s_waitcnt lgkmcnt(4)
    v_mfma_f32_16x16x32_bf16 v[96:99], a[32:35], a[16:19], v[96:99]
    ds_read_b128 a[8:11], v202 offset:47104
    v_mfma_f32_16x16x32_bf16 v[100:103], a[36:39], a[16:19], v[100:103]
    v_mfma_f32_16x16x32_bf16 v[104:107], a[40:43], a[16:19], v[104:107]
    buffer_load_dwordx4 v199, s[12:15], s60 offen offset:1024 lds
    v_mfma_f32_16x16x32_bf16 v[108:111], a[44:47], a[16:19], v[108:111]
    s_waitcnt lgkmcnt(4)
    v_mfma_f32_16x16x32_bf16 v[112:115], a[32:35], a[20:23], v[112:115]
    v_mfma_f32_16x16x32_bf16 v[116:119], a[36:39], a[20:23], v[116:119]
    s_waitcnt vmcnt(25)
    s_waitcnt lgkmcnt(0)
    s_barrier
    v_mfma_f32_16x16x32_bf16 v[120:123], a[40:43], a[20:23], v[120:123]
    ds_read_b64_tr_b16 a[48:49], v207
    buffer_load_dword v239, v255, s[20:23], s100 offen
    v_mfma_f32_16x16x32_bf16 v[124:127], a[44:47], a[20:23], v[124:127]
    ds_read_b64_tr_b16 a[50:51], v207 offset:1024
    v_mfma_f32_16x16x32_bf16 v[128:131], a[32:35], a[24:27], v[128:131]
    ds_read_b64_tr_b16 a[52:53], v209
    v_mfma_f32_16x16x32_bf16 v[132:135], a[36:39], a[24:27], v[132:135]
    ds_read_b64_tr_b16 a[54:55], v209 offset:1024
    v_mfma_f32_16x16x32_bf16 v[136:139], a[40:43], a[24:27], v[136:139]
    ds_read_b64_tr_b16 a[56:57], v207 offset:8192
    v_mfma_f32_16x16x32_bf16 v[140:143], a[44:47], a[24:27], v[140:143]
    ds_read_b64_tr_b16 a[58:59], v207 offset:9216
    v_mfma_f32_16x16x32_bf16 v[144:147], a[32:35], a[0:3], v[144:147]
    ds_read_b64_tr_b16 a[60:61], v209 offset:8192
    v_mfma_f32_16x16x32_bf16 v[148:151], a[36:39], a[0:3], v[148:151]
    ds_read_b64_tr_b16 a[62:63], v209 offset:9216
    v_mfma_f32_16x16x32_bf16 v[152:155], a[40:43], a[0:3], v[152:155]
    ds_read_b128 a[12:15], v204 offset:24576
    v_mfma_f32_16x16x32_bf16 v[156:159], a[44:47], a[0:3], v[156:159]
    ds_read_b128 a[16:19], v204 offset:26624
    v_mfma_f32_16x16x32_bf16 v[160:163], a[32:35], a[4:7], v[160:163]
    ds_read_b128 a[20:23], v204 offset:28672
    v_mfma_f32_16x16x32_bf16 v[164:167], a[36:39], a[4:7], v[164:167]
    ds_read_b128 a[24:27], v204 offset:30720
    v_mfma_f32_16x16x32_bf16 v[168:171], a[40:43], a[4:7], v[168:171]
    v_mfma_f32_16x16x32_bf16 v[172:175], a[44:47], a[4:7], v[172:175]
    v_mfma_f32_16x16x32_bf16 v[176:179], a[32:35], a[8:11], v[176:179]
    ds_read_b128 a[0:3], v204 offset:32768
    v_mfma_f32_16x16x32_bf16 v[180:183], a[36:39], a[8:11], v[180:183]
    v_mfma_f32_16x16x32_bf16 v[184:187], a[40:43], a[8:11], v[184:187]
    buffer_load_dwordx4 v200, s[12:15], s60 offen offset:2048 lds
    v_mfma_f32_16x16x32_bf16 v[188:191], a[44:47], a[8:11], v[188:191]
    s_waitcnt lgkmcnt(4)
    v_mfma_f32_16x16x32_bf16 v[0:3], a[48:51], a[12:15], v[0:3]
    ds_read_b128 a[4:7], v204 offset:34816
    v_mfma_f32_16x16x32_bf16 v[4:7], a[52:55], a[12:15], v[4:7]
    v_mfma_f32_16x16x32_bf16 v[8:11], a[56:59], a[12:15], v[8:11]
    buffer_load_dwordx4 v201, s[12:15], s60 offen offset:3072 lds
    v_mfma_f32_16x16x32_bf16 v[12:15], a[60:63], a[12:15], v[12:15]
    s_waitcnt lgkmcnt(4)
    v_mfma_f32_16x16x32_bf16 v[16:19], a[48:51], a[16:19], v[16:19]
    ds_read_b128 a[8:11], v204 offset:36864
    v_mfma_f32_16x16x32_bf16 v[20:23], a[52:55], a[16:19], v[20:23]
    s_add_u32 m0, s70, 49152
    v_mfma_f32_16x16x32_bf16 v[24:27], a[56:59], a[16:19], v[24:27]
    buffer_load_dwordx4 v198, s[12:15], s61 offen lds
    v_mfma_f32_16x16x32_bf16 v[28:31], a[60:63], a[16:19], v[28:31]
    s_waitcnt lgkmcnt(4)
    v_mfma_f32_16x16x32_bf16 v[32:35], a[48:51], a[20:23], v[32:35]
    ds_read_b128 a[12:15], v204 offset:38912
    v_mfma_f32_16x16x32_bf16 v[36:39], a[52:55], a[20:23], v[36:39]
    v_mfma_f32_16x16x32_bf16 v[40:43], a[56:59], a[20:23], v[40:43]
    buffer_load_dwordx4 v199, s[12:15], s61 offen offset:1024 lds
    v_mfma_f32_16x16x32_bf16 v[44:47], a[60:63], a[20:23], v[44:47]
    s_waitcnt lgkmcnt(4)
    v_mfma_f32_16x16x32_bf16 v[48:51], a[48:51], a[24:27], v[48:51]
    ds_read_b128 a[16:19], v204 offset:40960
    v_mfma_f32_16x16x32_bf16 v[52:55], a[52:55], a[24:27], v[52:55]
    v_mfma_f32_16x16x32_bf16 v[56:59], a[56:59], a[24:27], v[56:59]
    buffer_load_dwordx4 v200, s[12:15], s61 offen offset:2048 lds
    v_mfma_f32_16x16x32_bf16 v[60:63], a[60:63], a[24:27], v[60:63]
    s_waitcnt lgkmcnt(4)
    v_mfma_f32_16x16x32_bf16 v[64:67], a[48:51], a[0:3], v[64:67]
    ds_read_b128 a[20:23], v204 offset:43008
    v_mfma_f32_16x16x32_bf16 v[68:71], a[52:55], a[0:3], v[68:71]
    v_mfma_f32_16x16x32_bf16 v[72:75], a[56:59], a[0:3], v[72:75]
    buffer_load_dwordx4 v201, s[12:15], s61 offen offset:3072 lds
    v_mfma_f32_16x16x32_bf16 v[76:79], a[60:63], a[0:3], v[76:79]
    s_waitcnt lgkmcnt(4)
    v_mfma_f32_16x16x32_bf16 v[80:83], a[48:51], a[4:7], v[80:83]
    ds_read_b128 a[24:27], v204 offset:45056
    v_mfma_f32_16x16x32_bf16 v[84:87], a[52:55], a[4:7], v[84:87]
    v_mfma_f32_16x16x32_bf16 v[88:91], a[56:59], a[4:7], v[88:91]
    v_mfma_f32_16x16x32_bf16 v[92:95], a[60:63], a[4:7], v[92:95]
    s_waitcnt lgkmcnt(4)
    v_mfma_f32_16x16x32_bf16 v[96:99], a[48:51], a[8:11], v[96:99]
    ds_read_b128 a[0:3], v204 offset:47104
    v_mfma_f32_16x16x32_bf16 v[100:103], a[52:55], a[8:11], v[100:103]
    v_mfma_f32_16x16x32_bf16 v[104:107], a[56:59], a[8:11], v[104:107]
    v_mfma_f32_16x16x32_bf16 v[108:111], a[60:63], a[8:11], v[108:111]
    s_waitcnt lgkmcnt(4)
    v_mfma_f32_16x16x32_bf16 v[112:115], a[48:51], a[12:15], v[112:115]
    v_mfma_f32_16x16x32_bf16 v[116:119], a[52:55], a[12:15], v[116:119]
    s_waitcnt vmcnt(20)
    s_waitcnt lgkmcnt(0)
    s_barrier
    v_mfma_f32_16x16x32_bf16 v[120:123], a[56:59], a[12:15], v[120:123]
    ds_read_b64_tr_b16 a[32:33], v206
    buffer_load_dword v239, v255, s[20:23], s101 offen
    v_mfma_f32_16x16x32_bf16 v[124:127], a[60:63], a[12:15], v[124:127]
    ds_read_b64_tr_b16 a[34:35], v206 offset:1024
    v_mfma_f32_16x16x32_bf16 v[128:131], a[48:51], a[16:19], v[128:131]
    ds_read_b64_tr_b16 a[36:37], v208
    v_mfma_f32_16x16x32_bf16 v[132:135], a[52:55], a[16:19], v[132:135]
    ds_read_b64_tr_b16 a[38:39], v208 offset:1024
    v_mfma_f32_16x16x32_bf16 v[136:139], a[56:59], a[16:19], v[136:139]
    ds_read_b64_tr_b16 a[40:41], v206 offset:8192
    v_mfma_f32_16x16x32_bf16 v[140:143], a[60:63], a[16:19], v[140:143]
    ds_read_b64_tr_b16 a[42:43], v206 offset:9216
    v_mfma_f32_16x16x32_bf16 v[144:147], a[48:51], a[20:23], v[144:147]
    ds_read_b64_tr_b16 a[44:45], v208 offset:8192
    v_mfma_f32_16x16x32_bf16 v[148:151], a[52:55], a[20:23], v[148:151]
    ds_read_b64_tr_b16 a[46:47], v208 offset:9216
    v_mfma_f32_16x16x32_bf16 v[152:155], a[56:59], a[20:23], v[152:155]
    ds_read_b128 a[4:7], v202 offset:49152
    v_mfma_f32_16x16x32_bf16 v[156:159], a[60:63], a[20:23], v[156:159]
    ds_read_b128 a[8:11], v202 offset:51200
    v_mfma_f32_16x16x32_bf16 v[160:163], a[48:51], a[24:27], v[160:163]
    ds_read_b128 a[12:15], v202 offset:53248
    v_mfma_f32_16x16x32_bf16 v[164:167], a[52:55], a[24:27], v[164:167]
    ds_read_b128 a[16:19], v202 offset:55296
    v_mfma_f32_16x16x32_bf16 v[168:171], a[56:59], a[24:27], v[168:171]
    v_mfma_f32_16x16x32_bf16 v[172:175], a[60:63], a[24:27], v[172:175]
    v_mfma_f32_16x16x32_bf16 v[176:179], a[48:51], a[0:3], v[176:179]
    ds_read_b128 a[20:23], v202 offset:57344
    v_mfma_f32_16x16x32_bf16 v[180:183], a[52:55], a[0:3], v[180:183]
    s_add_u32 m0, s69, 24576
    v_mfma_f32_16x16x32_bf16 v[184:187], a[56:59], a[0:3], v[184:187]
    buffer_load_dwordx4 v192, s[8:11], s47 offen lds
    v_mfma_f32_16x16x32_bf16 v[188:191], a[60:63], a[0:3], v[188:191]
    s_waitcnt lgkmcnt(4)
    v_mfma_f32_16x16x32_bf16 v[0:3], a[32:35], a[4:7], v[0:3]
    ds_read_b128 a[24:27], v202 offset:59392
    v_mfma_f32_16x16x32_bf16 v[4:7], a[36:39], a[4:7], v[4:7]
    v_mfma_f32_16x16x32_bf16 v[8:11], a[40:43], a[4:7], v[8:11]
    buffer_load_dwordx4 v193, s[8:11], s47 offen offset:1024 lds
    v_mfma_f32_16x16x32_bf16 v[12:15], a[44:47], a[4:7], v[12:15]
    s_waitcnt lgkmcnt(4)
    v_mfma_f32_16x16x32_bf16 v[16:19], a[32:35], a[8:11], v[16:19]
    ds_read_b128 a[0:3], v202 offset:61440
    v_mfma_f32_16x16x32_bf16 v[20:23], a[36:39], a[8:11], v[20:23]
    v_mfma_f32_16x16x32_bf16 v[24:27], a[40:43], a[8:11], v[24:27]
    buffer_load_dwordx4 v194, s[8:11], s47 offen offset:2048 lds
    v_mfma_f32_16x16x32_bf16 v[28:31], a[44:47], a[8:11], v[28:31]
    s_waitcnt lgkmcnt(4)
    v_mfma_f32_16x16x32_bf16 v[32:35], a[32:35], a[12:15], v[32:35]
    ds_read_b128 a[4:7], v202 offset:63488
    v_mfma_f32_16x16x32_bf16 v[36:39], a[36:39], a[12:15], v[36:39]
    v_mfma_f32_16x16x32_bf16 v[40:43], a[40:43], a[12:15], v[40:43]
    buffer_load_dwordx4 v195, s[8:11], s47 offen offset:3072 lds
    v_mfma_f32_16x16x32_bf16 v[44:47], a[44:47], a[12:15], v[44:47]
    s_waitcnt lgkmcnt(4)
    v_mfma_f32_16x16x32_bf16 v[48:51], a[32:35], a[16:19], v[48:51]
    ds_read_b128 a[8:11], v203
    v_mfma_f32_16x16x32_bf16 v[52:55], a[36:39], a[16:19], v[52:55]
    s_add_u32 m0, s69, 28672
    v_mfma_f32_16x16x32_bf16 v[56:59], a[40:43], a[16:19], v[56:59]
    buffer_load_dwordx4 v196, s[8:11], s47 offen lds
    v_mfma_f32_16x16x32_bf16 v[60:63], a[44:47], a[16:19], v[60:63]
    s_waitcnt lgkmcnt(4)
    v_mfma_f32_16x16x32_bf16 v[64:67], a[32:35], a[20:23], v[64:67]
    ds_read_b128 a[12:15], v203 offset:2048
    v_mfma_f32_16x16x32_bf16 v[68:71], a[36:39], a[20:23], v[68:71]
    v_mfma_f32_16x16x32_bf16 v[72:75], a[40:43], a[20:23], v[72:75]
    buffer_load_dwordx4 v197, s[8:11], s47 offen offset:1024 lds
    v_mfma_f32_16x16x32_bf16 v[76:79], a[44:47], a[20:23], v[76:79]
    s_waitcnt lgkmcnt(4)
    v_mfma_f32_16x16x32_bf16 v[80:83], a[32:35], a[24:27], v[80:83]
    ds_read_b128 a[16:19], v203 offset:4096
    v_mfma_f32_16x16x32_bf16 v[84:87], a[36:39], a[24:27], v[84:87]
    s_add_u32 m0, s70, 65536
    v_mfma_f32_16x16x32_bf16 v[88:91], a[40:43], a[24:27], v[88:91]
    buffer_load_dwordx4 v198, s[12:15], s62 offen lds
    v_mfma_f32_16x16x32_bf16 v[92:95], a[44:47], a[24:27], v[92:95]
    s_waitcnt lgkmcnt(4)
    v_mfma_f32_16x16x32_bf16 v[96:99], a[32:35], a[0:3], v[96:99]
    ds_read_b128 a[20:23], v203 offset:6144
    v_mfma_f32_16x16x32_bf16 v[100:103], a[36:39], a[0:3], v[100:103]
    v_mfma_f32_16x16x32_bf16 v[104:107], a[40:43], a[0:3], v[104:107]
    buffer_load_dwordx4 v199, s[12:15], s62 offen offset:1024 lds
    v_mfma_f32_16x16x32_bf16 v[108:111], a[44:47], a[0:3], v[108:111]
    s_waitcnt lgkmcnt(4)
    v_mfma_f32_16x16x32_bf16 v[112:115], a[32:35], a[4:7], v[112:115]
    v_mfma_f32_16x16x32_bf16 v[116:119], a[36:39], a[4:7], v[116:119]
    s_waitcnt vmcnt(25)
    s_waitcnt lgkmcnt(0)
    s_barrier
    v_mfma_f32_16x16x32_bf16 v[120:123], a[40:43], a[4:7], v[120:123]
    ds_read_b64_tr_b16 a[48:49], v206 offset:16384
    buffer_load_dword v239, v255, s[20:23], s32 offen
    v_mfma_f32_16x16x32_bf16 v[124:127], a[44:47], a[4:7], v[124:127]
    ds_read_b64_tr_b16 a[50:51], v206 offset:17408
    v_mfma_f32_16x16x32_bf16 v[128:131], a[32:35], a[8:11], v[128:131]
    ds_read_b64_tr_b16 a[52:53], v208 offset:16384
    v_mfma_f32_16x16x32_bf16 v[132:135], a[36:39], a[8:11], v[132:135]
    ds_read_b64_tr_b16 a[54:55], v208 offset:17408
    v_mfma_f32_16x16x32_bf16 v[136:139], a[40:43], a[8:11], v[136:139]
    ds_read_b64_tr_b16 a[56:57], v206 offset:24576
    v_mfma_f32_16x16x32_bf16 v[140:143], a[44:47], a[8:11], v[140:143]
    ds_read_b64_tr_b16 a[58:59], v206 offset:25600
    v_mfma_f32_16x16x32_bf16 v[144:147], a[32:35], a[12:15], v[144:147]
    ds_read_b64_tr_b16 a[60:61], v208 offset:24576
    v_mfma_f32_16x16x32_bf16 v[148:151], a[36:39], a[12:15], v[148:151]
    ds_read_b64_tr_b16 a[62:63], v208 offset:25600
    v_mfma_f32_16x16x32_bf16 v[152:155], a[40:43], a[12:15], v[152:155]
    ds_read_b128 a[24:27], v204 offset:49152
    v_mfma_f32_16x16x32_bf16 v[156:159], a[44:47], a[12:15], v[156:159]
    ds_read_b128 a[0:3], v204 offset:51200
    v_mfma_f32_16x16x32_bf16 v[160:163], a[32:35], a[16:19], v[160:163]
    ds_read_b128 a[4:7], v204 offset:53248
    v_mfma_f32_16x16x32_bf16 v[164:167], a[36:39], a[16:19], v[164:167]
    ds_read_b128 a[8:11], v204 offset:55296
    v_mfma_f32_16x16x32_bf16 v[168:171], a[40:43], a[16:19], v[168:171]
    v_mfma_f32_16x16x32_bf16 v[172:175], a[44:47], a[16:19], v[172:175]
    v_mfma_f32_16x16x32_bf16 v[176:179], a[32:35], a[20:23], v[176:179]
    ds_read_b128 a[12:15], v204 offset:57344
    v_mfma_f32_16x16x32_bf16 v[180:183], a[36:39], a[20:23], v[180:183]
    v_mfma_f32_16x16x32_bf16 v[184:187], a[40:43], a[20:23], v[184:187]
    buffer_load_dwordx4 v200, s[12:15], s62 offen offset:2048 lds
    v_mfma_f32_16x16x32_bf16 v[188:191], a[44:47], a[20:23], v[188:191]
    s_waitcnt lgkmcnt(4)
    v_mfma_f32_16x16x32_bf16 v[0:3], a[48:51], a[24:27], v[0:3]
    ds_read_b128 a[16:19], v204 offset:59392
    v_mfma_f32_16x16x32_bf16 v[4:7], a[52:55], a[24:27], v[4:7]
    v_mfma_f32_16x16x32_bf16 v[8:11], a[56:59], a[24:27], v[8:11]
    buffer_load_dwordx4 v201, s[12:15], s62 offen offset:3072 lds
    v_mfma_f32_16x16x32_bf16 v[12:15], a[60:63], a[24:27], v[12:15]
    s_waitcnt lgkmcnt(4)
    v_mfma_f32_16x16x32_bf16 v[16:19], a[48:51], a[0:3], v[16:19]
    ds_read_b128 a[20:23], v204 offset:61440
    v_mfma_f32_16x16x32_bf16 v[20:23], a[52:55], a[0:3], v[20:23]
    s_add_u32 m0, s70, 0
    v_mfma_f32_16x16x32_bf16 v[24:27], a[56:59], a[0:3], v[24:27]
    buffer_load_dwordx4 v198, s[12:15], s63 offen lds
    v_mfma_f32_16x16x32_bf16 v[28:31], a[60:63], a[0:3], v[28:31]
    s_waitcnt lgkmcnt(4)
    v_mfma_f32_16x16x32_bf16 v[32:35], a[48:51], a[4:7], v[32:35]
    ds_read_b128 a[24:27], v204 offset:63488
    v_mfma_f32_16x16x32_bf16 v[36:39], a[52:55], a[4:7], v[36:39]
    v_mfma_f32_16x16x32_bf16 v[40:43], a[56:59], a[4:7], v[40:43]
    buffer_load_dwordx4 v199, s[12:15], s63 offen offset:1024 lds
    v_mfma_f32_16x16x32_bf16 v[44:47], a[60:63], a[4:7], v[44:47]
    s_waitcnt lgkmcnt(4)
    v_mfma_f32_16x16x32_bf16 v[48:51], a[48:51], a[8:11], v[48:51]
    ds_read_b128 a[0:3], v205
    v_mfma_f32_16x16x32_bf16 v[52:55], a[52:55], a[8:11], v[52:55]
    v_mfma_f32_16x16x32_bf16 v[56:59], a[56:59], a[8:11], v[56:59]
    buffer_load_dwordx4 v200, s[12:15], s63 offen offset:2048 lds
    v_mfma_f32_16x16x32_bf16 v[60:63], a[60:63], a[8:11], v[60:63]
    s_waitcnt lgkmcnt(4)
    v_mfma_f32_16x16x32_bf16 v[64:67], a[48:51], a[12:15], v[64:67]
    ds_read_b128 a[4:7], v205 offset:2048
    v_mfma_f32_16x16x32_bf16 v[68:71], a[52:55], a[12:15], v[68:71]
    v_mfma_f32_16x16x32_bf16 v[72:75], a[56:59], a[12:15], v[72:75]
    buffer_load_dwordx4 v201, s[12:15], s63 offen offset:3072 lds
    v_mfma_f32_16x16x32_bf16 v[76:79], a[60:63], a[12:15], v[76:79]
    s_waitcnt lgkmcnt(4)
    v_mfma_f32_16x16x32_bf16 v[80:83], a[48:51], a[16:19], v[80:83]
    ds_read_b128 a[8:11], v205 offset:4096
    v_mfma_f32_16x16x32_bf16 v[84:87], a[52:55], a[16:19], v[84:87]
    v_mfma_f32_16x16x32_bf16 v[88:91], a[56:59], a[16:19], v[88:91]
    v_mfma_f32_16x16x32_bf16 v[92:95], a[60:63], a[16:19], v[92:95]
    s_waitcnt lgkmcnt(4)
    v_mfma_f32_16x16x32_bf16 v[96:99], a[48:51], a[20:23], v[96:99]
    ds_read_b128 a[12:15], v205 offset:6144
    v_mfma_f32_16x16x32_bf16 v[100:103], a[52:55], a[20:23], v[100:103]
    v_mfma_f32_16x16x32_bf16 v[104:107], a[56:59], a[20:23], v[104:107]
    v_mfma_f32_16x16x32_bf16 v[108:111], a[60:63], a[20:23], v[108:111]
    s_waitcnt lgkmcnt(4)
    v_mfma_f32_16x16x32_bf16 v[112:115], a[48:51], a[24:27], v[112:115]
    v_mfma_f32_16x16x32_bf16 v[116:119], a[52:55], a[24:27], v[116:119]
    s_waitcnt vmcnt(20)
    s_waitcnt lgkmcnt(0)
    s_barrier
    v_mfma_f32_16x16x32_bf16 v[120:123], a[56:59], a[24:27], v[120:123]
    ds_read_b64_tr_b16 a[32:33], v206 offset:32768
    s_add_u32 m0, s4, 90112
    s_mov_b32 s72, 0
    buffer_load_dwordx4 v240, s[20:23], s72 offen lds
    buffer_load_dword v239, v255, s[24:27], s33 offen
    v_mfma_f32_16x16x32_bf16 v[124:127], a[60:63], a[24:27], v[124:127]
    ds_read_b64_tr_b16 a[34:35], v206 offset:33792
    v_mfma_f32_16x16x32_bf16 v[128:131], a[48:51], a[0:3], v[128:131]
    ds_read_b64_tr_b16 a[36:37], v208 offset:32768
    v_mfma_f32_16x16x32_bf16 v[132:135], a[52:55], a[0:3], v[132:135]
    ds_read_b64_tr_b16 a[38:39], v208 offset:33792
    v_mfma_f32_16x16x32_bf16 v[136:139], a[56:59], a[0:3], v[136:139]
    ds_read_b64_tr_b16 a[40:41], v206 offset:40960
    buffer_load_dwordx4 v241, s[20:23], s72 offen offset:1024 lds
    v_mfma_f32_16x16x32_bf16 v[140:143], a[60:63], a[0:3], v[140:143]
    ds_read_b64_tr_b16 a[42:43], v206 offset:41984
    v_mfma_f32_16x16x32_bf16 v[144:147], a[48:51], a[4:7], v[144:147]
    ds_read_b64_tr_b16 a[44:45], v208 offset:40960
    v_mfma_f32_16x16x32_bf16 v[148:151], a[52:55], a[4:7], v[148:151]
    ds_read_b64_tr_b16 a[46:47], v208 offset:41984
    v_mfma_f32_16x16x32_bf16 v[152:155], a[56:59], a[4:7], v[152:155]
    ds_read_b128 a[16:19], v202
    buffer_load_dwordx4 v242, s[20:23], s72 offen offset:2048 lds
    v_mfma_f32_16x16x32_bf16 v[156:159], a[60:63], a[4:7], v[156:159]
    ds_read_b128 a[20:23], v202 offset:2048
    v_mfma_f32_16x16x32_bf16 v[160:163], a[48:51], a[8:11], v[160:163]
    ds_read_b128 a[24:27], v202 offset:4096
    v_mfma_f32_16x16x32_bf16 v[164:167], a[52:55], a[8:11], v[164:167]
    ds_read_b128 a[0:3], v202 offset:6144
    v_mfma_f32_16x16x32_bf16 v[168:171], a[56:59], a[8:11], v[168:171]
    buffer_load_dwordx4 v243, s[20:23], s72 offen offset:3072 lds
    v_mfma_f32_16x16x32_bf16 v[172:175], a[60:63], a[8:11], v[172:175]
    v_mfma_f32_16x16x32_bf16 v[176:179], a[48:51], a[12:15], v[176:179]
    ds_read_b128 a[4:7], v202 offset:8192
    v_mfma_f32_16x16x32_bf16 v[180:183], a[52:55], a[12:15], v[180:183]
    v_mfma_f32_16x16x32_bf16 v[184:187], a[56:59], a[12:15], v[184:187]
    v_mfma_f32_16x16x32_bf16 v[188:191], a[60:63], a[12:15], v[188:191]
    s_waitcnt lgkmcnt(4)
    v_mfma_f32_16x16x32_bf16 v[0:3], a[32:35], a[16:19], v[0:3]
    ds_read_b128 a[8:11], v202 offset:10240
    v_mfma_f32_16x16x32_bf16 v[4:7], a[36:39], a[16:19], v[4:7]
    v_mfma_f32_16x16x32_bf16 v[8:11], a[40:43], a[16:19], v[8:11]
    v_mfma_f32_16x16x32_bf16 v[12:15], a[44:47], a[16:19], v[12:15]
    s_waitcnt lgkmcnt(4)
    v_mfma_f32_16x16x32_bf16 v[16:19], a[32:35], a[20:23], v[16:19]
    ds_read_b128 a[12:15], v202 offset:12288
    v_mfma_f32_16x16x32_bf16 v[20:23], a[36:39], a[20:23], v[20:23]
    v_mfma_f32_16x16x32_bf16 v[24:27], a[40:43], a[20:23], v[24:27]
    v_mfma_f32_16x16x32_bf16 v[28:31], a[44:47], a[20:23], v[28:31]
    s_waitcnt lgkmcnt(4)
    v_mfma_f32_16x16x32_bf16 v[32:35], a[32:35], a[24:27], v[32:35]
    ds_read_b128 a[16:19], v202 offset:14336
    v_mfma_f32_16x16x32_bf16 v[36:39], a[36:39], a[24:27], v[36:39]
    v_mfma_f32_16x16x32_bf16 v[40:43], a[40:43], a[24:27], v[40:43]
    v_mfma_f32_16x16x32_bf16 v[44:47], a[44:47], a[24:27], v[44:47]
    s_waitcnt lgkmcnt(4)
    v_mfma_f32_16x16x32_bf16 v[48:51], a[32:35], a[0:3], v[48:51]
    ds_read_b128 a[20:23], v202 offset:16384
    v_mfma_f32_16x16x32_bf16 v[52:55], a[36:39], a[0:3], v[52:55]
    v_mfma_f32_16x16x32_bf16 v[56:59], a[40:43], a[0:3], v[56:59]
    v_mfma_f32_16x16x32_bf16 v[60:63], a[44:47], a[0:3], v[60:63]
    s_waitcnt lgkmcnt(4)
    v_mfma_f32_16x16x32_bf16 v[64:67], a[32:35], a[4:7], v[64:67]
    ds_read_b128 a[24:27], v202 offset:18432
    v_mfma_f32_16x16x32_bf16 v[68:71], a[36:39], a[4:7], v[68:71]
    v_mfma_f32_16x16x32_bf16 v[72:75], a[40:43], a[4:7], v[72:75]
    v_mfma_f32_16x16x32_bf16 v[76:79], a[44:47], a[4:7], v[76:79]
    s_waitcnt lgkmcnt(4)
    v_mfma_f32_16x16x32_bf16 v[80:83], a[32:35], a[8:11], v[80:83]
    ds_read_b128 a[0:3], v202 offset:20480
    v_mfma_f32_16x16x32_bf16 v[84:87], a[36:39], a[8:11], v[84:87]
    v_mfma_f32_16x16x32_bf16 v[88:91], a[40:43], a[8:11], v[88:91]
    v_mfma_f32_16x16x32_bf16 v[92:95], a[44:47], a[8:11], v[92:95]
    s_waitcnt lgkmcnt(4)
    v_mfma_f32_16x16x32_bf16 v[96:99], a[32:35], a[12:15], v[96:99]
    ds_read_b128 a[4:7], v202 offset:22528
    v_mfma_f32_16x16x32_bf16 v[100:103], a[36:39], a[12:15], v[100:103]
    v_mfma_f32_16x16x32_bf16 v[104:107], a[40:43], a[12:15], v[104:107]
    v_mfma_f32_16x16x32_bf16 v[108:111], a[44:47], a[12:15], v[108:111]
    s_waitcnt lgkmcnt(4)
    v_mfma_f32_16x16x32_bf16 v[112:115], a[32:35], a[16:19], v[112:115]
    v_mfma_f32_16x16x32_bf16 v[116:119], a[36:39], a[16:19], v[116:119]
    s_waitcnt vmcnt(21)
    s_waitcnt lgkmcnt(0)
    s_barrier
    buffer_load_dword v239, off, s[16:19], s77 sc1
    s_mov_b32 s74, 13643776
    buffer_load_dword v251, off, s[16:19], s74 sc1
    v_mfma_f32_16x16x32_bf16 v[120:123], a[40:43], a[16:19], v[120:123]
    ds_read_b64_tr_b16 a[48:49], v206 offset:49152
    s_add_u32 m0, s4, 106496
    s_mov_b32 s72, 32768
    buffer_load_dwordx4 v240, s[20:23], s72 offen lds
    buffer_load_dword v239, v255, s[24:27], s34 offen
    v_mfma_f32_16x16x32_bf16 v[124:127], a[44:47], a[16:19], v[124:127]
    ds_read_b64_tr_b16 a[50:51], v206 offset:50176
    v_mfma_f32_16x16x32_bf16 v[128:131], a[32:35], a[20:23], v[128:131]
    ds_read_b64_tr_b16 a[52:53], v208 offset:49152
    v_mfma_f32_16x16x32_bf16 v[132:135], a[36:39], a[20:23], v[132:135]
    ds_read_b64_tr_b16 a[54:55], v208 offset:50176
    v_mfma_f32_16x16x32_bf16 v[136:139], a[40:43], a[20:23], v[136:139]
    ds_read_b64_tr_b16 a[56:57], v206 offset:57344
    buffer_load_dwordx4 v241, s[20:23], s72 offen offset:1024 lds
    v_mfma_f32_16x16x32_bf16 v[140:143], a[44:47], a[20:23], v[140:143]
    ds_read_b64_tr_b16 a[58:59], v206 offset:58368
    v_mfma_f32_16x16x32_bf16 v[144:147], a[32:35], a[24:27], v[144:147]
    ds_read_b64_tr_b16 a[60:61], v208 offset:57344
    v_mfma_f32_16x16x32_bf16 v[148:151], a[36:39], a[24:27], v[148:151]
    ds_read_b64_tr_b16 a[62:63], v208 offset:58368
    v_mfma_f32_16x16x32_bf16 v[152:155], a[40:43], a[24:27], v[152:155]
    ds_read_b128 a[8:11], v204
    buffer_load_dwordx4 v242, s[20:23], s72 offen offset:2048 lds
    v_mfma_f32_16x16x32_bf16 v[156:159], a[44:47], a[24:27], v[156:159]
    ds_read_b128 a[12:15], v204 offset:2048
    v_mfma_f32_16x16x32_bf16 v[160:163], a[32:35], a[0:3], v[160:163]
    ds_read_b128 a[16:19], v204 offset:4096
    v_mfma_f32_16x16x32_bf16 v[164:167], a[36:39], a[0:3], v[164:167]
    ds_read_b128 a[20:23], v204 offset:6144
    v_mfma_f32_16x16x32_bf16 v[168:171], a[40:43], a[0:3], v[168:171]
    buffer_load_dwordx4 v243, s[20:23], s72 offen offset:3072 lds
    v_mfma_f32_16x16x32_bf16 v[172:175], a[44:47], a[0:3], v[172:175]
    v_mfma_f32_16x16x32_bf16 v[176:179], a[32:35], a[4:7], v[176:179]
    ds_read_b128 a[24:27], v204 offset:8192
    v_mfma_f32_16x16x32_bf16 v[180:183], a[36:39], a[4:7], v[180:183]
    v_mfma_f32_16x16x32_bf16 v[184:187], a[40:43], a[4:7], v[184:187]
    v_mfma_f32_16x16x32_bf16 v[188:191], a[44:47], a[4:7], v[188:191]
    s_waitcnt lgkmcnt(4)
    v_mfma_f32_16x16x32_bf16 v[0:3], a[48:51], a[8:11], v[0:3]
    ds_read_b128 a[0:3], v204 offset:10240
    v_mfma_f32_16x16x32_bf16 v[4:7], a[52:55], a[8:11], v[4:7]
    v_mfma_f32_16x16x32_bf16 v[8:11], a[56:59], a[8:11], v[8:11]
    v_mfma_f32_16x16x32_bf16 v[12:15], a[60:63], a[8:11], v[12:15]
    s_waitcnt lgkmcnt(4)
    v_mfma_f32_16x16x32_bf16 v[16:19], a[48:51], a[12:15], v[16:19]
    ds_read_b128 a[4:7], v204 offset:12288
    v_mfma_f32_16x16x32_bf16 v[20:23], a[52:55], a[12:15], v[20:23]
    v_mfma_f32_16x16x32_bf16 v[24:27], a[56:59], a[12:15], v[24:27]
    v_mfma_f32_16x16x32_bf16 v[28:31], a[60:63], a[12:15], v[28:31]
    s_waitcnt lgkmcnt(4)
    v_mfma_f32_16x16x32_bf16 v[32:35], a[48:51], a[16:19], v[32:35]
    ds_read_b128 a[8:11], v204 offset:14336
    v_mfma_f32_16x16x32_bf16 v[36:39], a[52:55], a[16:19], v[36:39]
    v_mfma_f32_16x16x32_bf16 v[40:43], a[56:59], a[16:19], v[40:43]
    v_mfma_f32_16x16x32_bf16 v[44:47], a[60:63], a[16:19], v[44:47]
    s_waitcnt lgkmcnt(4)
    v_mfma_f32_16x16x32_bf16 v[48:51], a[48:51], a[20:23], v[48:51]
    ds_read_b128 a[12:15], v204 offset:16384
    v_mfma_f32_16x16x32_bf16 v[52:55], a[52:55], a[20:23], v[52:55]
    v_mfma_f32_16x16x32_bf16 v[56:59], a[56:59], a[20:23], v[56:59]
    v_mfma_f32_16x16x32_bf16 v[60:63], a[60:63], a[20:23], v[60:63]
    s_waitcnt lgkmcnt(4)
    v_mfma_f32_16x16x32_bf16 v[64:67], a[48:51], a[24:27], v[64:67]
    ds_read_b128 a[16:19], v204 offset:18432
    v_mfma_f32_16x16x32_bf16 v[68:71], a[52:55], a[24:27], v[68:71]
    v_mfma_f32_16x16x32_bf16 v[72:75], a[56:59], a[24:27], v[72:75]
    s_waitcnt vmcnt(7)
    ds_read_b64_tr_b16 a[96:97], v232
    ds_read_b64_tr_b16 a[98:99], v232 offset:2048
    ds_read_b64_tr_b16 a[100:101], v233
    ds_read_b64_tr_b16 a[102:103], v233 offset:2048
    v_mfma_f32_16x16x32_bf16 v[76:79], a[60:63], a[24:27], v[76:79]
    ds_read_b64_tr_b16 a[104:105], v234
    ds_read_b64_tr_b16 a[106:107], v234 offset:2048
    ds_read_b64_tr_b16 a[108:109], v235
    ds_read_b64_tr_b16 a[110:111], v235 offset:2048
    s_waitcnt lgkmcnt(12)
    v_mfma_f32_16x16x32_bf16 v[80:83], a[48:51], a[0:3], v[80:83]
    ds_read_b128 a[20:23], v204 offset:20480
    v_mfma_f32_16x16x32_bf16 v[84:87], a[52:55], a[0:3], v[84:87]
    v_mfma_f32_16x16x32_bf16 v[88:91], a[56:59], a[0:3], v[88:91]
    v_mfma_f32_16x16x32_bf16 v[92:95], a[60:63], a[0:3], v[92:95]
    s_waitcnt lgkmcnt(12)
    v_mfma_f32_16x16x32_bf16 v[96:99], a[48:51], a[4:7], v[96:99]
    ds_read_b128 a[24:27], v204 offset:22528
    v_mfma_f32_16x16x32_bf16 v[100:103], a[52:55], a[4:7], v[100:103]
    v_mfma_f32_16x16x32_bf16 v[104:107], a[56:59], a[4:7], v[104:107]
    v_mfma_f32_16x16x32_bf16 v[108:111], a[60:63], a[4:7], v[108:111]
    s_waitcnt lgkmcnt(12)
    v_mfma_f32_16x16x32_bf16 v[112:115], a[48:51], a[8:11], v[112:115]
    v_mfma_f32_16x16x32_bf16 v[116:119], a[52:55], a[8:11], v[116:119]
    s_waitcnt lgkmcnt(0)
    s_barrier
    v_mfma_f32_16x16x32_bf16 v[120:123], a[56:59], a[8:11], v[120:123]
    ds_read_b64_tr_b16 a[32:33], v207
    s_add_u32 m0, s4, 122880
    s_mov_b32 s72, 65536
    buffer_load_dwordx4 v240, s[20:23], s72 offen lds
    v_mfma_f32_16x16x32_bf16 v[124:127], a[60:63], a[8:11], v[124:127]
    ds_read_b64_tr_b16 a[34:35], v207 offset:1024
    v_mfma_f32_16x16x32_bf16 v[128:131], a[48:51], a[12:15], v[128:131]
    ds_read_b64_tr_b16 a[36:37], v209
    v_mfma_f32_16x16x32_bf16 v[132:135], a[52:55], a[12:15], v[132:135]
    ds_read_b64_tr_b16 a[38:39], v209 offset:1024
    v_mfma_f32_16x16x32_bf16 v[136:139], a[56:59], a[12:15], v[136:139]
    ds_read_b64_tr_b16 a[40:41], v207 offset:8192
    buffer_load_dwordx4 v241, s[20:23], s72 offen offset:1024 lds
    v_mfma_f32_16x16x32_bf16 v[140:143], a[60:63], a[12:15], v[140:143]
    ds_read_b64_tr_b16 a[42:43], v207 offset:9216
    v_mfma_f32_16x16x32_bf16 v[144:147], a[48:51], a[16:19], v[144:147]
    ds_read_b64_tr_b16 a[44:45], v209 offset:8192
    v_mfma_f32_16x16x32_bf16 v[148:151], a[52:55], a[16:19], v[148:151]
    ds_read_b64_tr_b16 a[46:47], v209 offset:9216
    v_mfma_f32_16x16x32_bf16 v[152:155], a[56:59], a[16:19], v[152:155]
    ds_read_b128 a[0:3], v202 offset:24576
    buffer_load_dwordx4 v242, s[20:23], s72 offen offset:2048 lds
    v_mfma_f32_16x16x32_bf16 v[156:159], a[60:63], a[16:19], v[156:159]
    ds_read_b128 a[4:7], v202 offset:26624
    v_mfma_f32_16x16x32_bf16 v[160:163], a[48:51], a[20:23], v[160:163]
    ds_read_b128 a[8:11], v202 offset:28672
    v_mfma_f32_16x16x32_bf16 v[164:167], a[52:55], a[20:23], v[164:167]
    ds_read_b128 a[12:15], v202 offset:30720
    v_mfma_f32_16x16x32_bf16 v[168:171], a[56:59], a[20:23], v[168:171]
    buffer_load_dwordx4 v243, s[20:23], s72 offen offset:3072 lds
    v_mfma_f32_16x16x32_bf16 v[172:175], a[60:63], a[20:23], v[172:175]
    v_mfma_f32_16x16x32_bf16 v[176:179], a[48:51], a[24:27], v[176:179]
    ds_read_b128 a[16:19], v202 offset:32768
    v_mfma_f32_16x16x32_bf16 v[180:183], a[52:55], a[24:27], v[180:183]
    v_mfma_f32_16x16x32_bf16 v[184:187], a[56:59], a[24:27], v[184:187]
    s_add_u32 m0, s4, 90112
    s_mov_b32 s72, 131072
    buffer_load_dwordx4 v240, s[20:23], s72 offen lds
    v_mfma_f32_16x16x32_bf16 v[188:191], a[60:63], a[24:27], v[188:191]
    s_waitcnt lgkmcnt(4)
    v_mfma_f32_16x16x32_bf16 v[0:3], a[32:35], a[0:3], v[0:3]
    ds_read_b128 a[20:23], v202 offset:34816
    v_mfma_f32_16x16x32_bf16 v[4:7], a[36:39], a[0:3], v[4:7]
    v_mfma_f32_16x16x32_bf16 v[8:11], a[40:43], a[0:3], v[8:11]
    buffer_load_dwordx4 v241, s[20:23], s72 offen offset:1024 lds
    v_mfma_f32_16x16x32_bf16 v[12:15], a[44:47], a[0:3], v[12:15]
    s_waitcnt lgkmcnt(4)
    v_mfma_f32_16x16x32_bf16 v[16:19], a[32:35], a[4:7], v[16:19]
    ds_read_b128 a[24:27], v202 offset:36864
    v_mfma_f32_16x16x32_bf16 v[20:23], a[36:39], a[4:7], v[20:23]
    v_mfma_f32_16x16x32_bf16 v[24:27], a[40:43], a[4:7], v[24:27]
    buffer_load_dwordx4 v242, s[20:23], s72 offen offset:2048 lds
    v_mfma_f32_16x16x32_bf16 v[28:31], a[44:47], a[4:7], v[28:31]
    s_waitcnt lgkmcnt(4)
    v_mfma_f32_16x16x32_bf16 v[32:35], a[32:35], a[8:11], v[32:35]
    ds_read_b128 a[0:3], v202 offset:38912
    v_mfma_f32_16x16x32_bf16 v[36:39], a[36:39], a[8:11], v[36:39]
    v_mfma_f32_16x16x32_bf16 v[40:43], a[40:43], a[8:11], v[40:43]
    buffer_load_dwordx4 v243, s[20:23], s72 offen offset:3072 lds
    v_mfma_f32_16x16x32_bf16 v[44:47], a[44:47], a[8:11], v[44:47]
    s_waitcnt lgkmcnt(4)
    v_mfma_f32_16x16x32_bf16 v[48:51], a[32:35], a[12:15], v[48:51]
    ds_read_b128 a[4:7], v202 offset:40960
    v_mfma_f32_16x16x32_bf16 v[52:55], a[36:39], a[12:15], v[52:55]
    v_mfma_f32_16x16x32_bf16 v[56:59], a[40:43], a[12:15], v[56:59]
    v_mfma_f32_16x16x32_bf16 v[60:63], a[44:47], a[12:15], v[60:63]
    s_waitcnt lgkmcnt(4)
    v_mfma_f32_16x16x32_bf16 v[64:67], a[32:35], a[16:19], v[64:67]
    ds_read_b128 a[8:11], v202 offset:43008
    v_mfma_f32_16x16x32_bf16 v[68:71], a[36:39], a[16:19], v[68:71]
    v_mfma_f32_16x16x32_bf16 v[72:75], a[40:43], a[16:19], v[72:75]
    v_mfma_f32_16x16x32_bf16 v[76:79], a[44:47], a[16:19], v[76:79]
    s_waitcnt lgkmcnt(4)
    v_mfma_f32_16x16x32_bf16 v[80:83], a[32:35], a[20:23], v[80:83]
    ds_read_b128 a[12:15], v202 offset:45056
    v_mfma_f32_16x16x32_bf16 v[84:87], a[36:39], a[20:23], v[84:87]
    v_mfma_f32_16x16x32_bf16 v[88:91], a[40:43], a[20:23], v[88:91]
    v_mfma_f32_16x16x32_bf16 v[92:95], a[44:47], a[20:23], v[92:95]
    s_waitcnt lgkmcnt(4)
    v_mfma_f32_16x16x32_bf16 v[96:99], a[32:35], a[24:27], v[96:99]
    ds_read_b128 a[16:19], v202 offset:47104
    v_mfma_f32_16x16x32_bf16 v[100:103], a[36:39], a[24:27], v[100:103]
    v_mfma_f32_16x16x32_bf16 v[104:107], a[40:43], a[24:27], v[104:107]
    v_mfma_f32_16x16x32_bf16 v[108:111], a[44:47], a[24:27], v[108:111]
    s_waitcnt lgkmcnt(4)
    v_mfma_f32_16x16x32_bf16 v[112:115], a[32:35], a[0:3], v[112:115]
    v_mfma_f32_16x16x32_bf16 v[116:119], a[36:39], a[0:3], v[116:119]
    s_waitcnt lgkmcnt(0)
    s_barrier
    v_mfma_f32_16x16x32_bf16 v[120:123], a[40:43], a[0:3], v[120:123]
    ds_read_b64_tr_b16 a[48:49], v206
    v_mfma_f32_16x16x32_bf16 v[124:127], a[44:47], a[0:3], v[124:127]
    ds_read_b64_tr_b16 a[50:51], v206 offset:1024
    v_mfma_f32_16x16x32_bf16 v[128:131], a[32:35], a[4:7], v[128:131]
    ds_read_b64_tr_b16 a[52:53], v208
    v_mfma_f32_16x16x32_bf16 v[132:135], a[36:39], a[4:7], v[132:135]
    ds_read_b64_tr_b16 a[54:55], v208 offset:1024
    v_mfma_f32_16x16x32_bf16 v[136:139], a[40:43], a[4:7], v[136:139]
    ds_read_b64_tr_b16 a[56:57], v206 offset:8192
    s_waitcnt vmcnt(8)
    ds_read_b64_tr_b16 a[112:113], v232 offset:16384
    ds_read_b64_tr_b16 a[114:115], v232 offset:18432
    ds_read_b64_tr_b16 a[116:117], v233 offset:16384
    ds_read_b64_tr_b16 a[118:119], v233 offset:18432
    v_mfma_f32_16x16x32_bf16 v[140:143], a[44:47], a[4:7], v[140:143]
    ds_read_b64_tr_b16 a[58:59], v206 offset:9216
    ds_read_b64_tr_b16 a[120:121], v234 offset:16384
    ds_read_b64_tr_b16 a[122:123], v234 offset:18432
    ds_read_b64_tr_b16 a[124:125], v235 offset:16384
    ds_read_b64_tr_b16 a[126:127], v235 offset:18432
    v_mfma_f32_16x16x32_bf16 v[144:147], a[32:35], a[8:11], v[144:147]
    ds_read_b64_tr_b16 a[60:61], v208 offset:8192
    s_add_u32 m0, s4, 139264
    s_mov_b32 s72, 98304
    buffer_load_dwordx4 v240, s[20:23], s72 offen lds
    v_mfma_f32_16x16x32_bf16 v[148:151], a[36:39], a[8:11], v[148:151]
    s_waitcnt lgkmcnt(14)
    ds_read_b64_tr_b16 a[62:63], v208 offset:9216
    v_mfma_f32_16x16x32_bf16 v[152:155], a[40:43], a[8:11], v[152:155]
    s_waitcnt lgkmcnt(14)
    ds_read_b128 a[20:23], v204 offset:24576
    v_mfma_f32_16x16x32_bf16 v[156:159], a[44:47], a[8:11], v[156:159]
    s_waitcnt lgkmcnt(14)
    ds_read_b128 a[24:27], v204 offset:26624
    v_mfma_f32_16x16x32_bf16 v[160:163], a[32:35], a[12:15], v[160:163]
    s_waitcnt lgkmcnt(14)
    ds_read_b128 a[0:3], v204 offset:28672
    buffer_load_dwordx4 v241, s[20:23], s72 offen offset:1024 lds
    v_mfma_f32_16x16x32_bf16 v[164:167], a[36:39], a[12:15], v[164:167]
    s_waitcnt lgkmcnt(14)
    ds_read_b128 a[4:7], v204 offset:30720
    v_mfma_f32_16x16x32_bf16 v[168:171], a[40:43], a[12:15], v[168:171]
    v_mfma_f32_16x16x32_bf16 v[172:175], a[44:47], a[12:15], v[172:175]
    v_mfma_f32_16x16x32_bf16 v[176:179], a[32:35], a[16:19], v[176:179]
    s_waitcnt lgkmcnt(14)
    ds_read_b128 a[8:11], v204 offset:32768
    buffer_load_dwordx4 v242, s[20:23], s72 offen offset:2048 lds
    v_mfma_f32_16x16x32_bf16 v[180:183], a[36:39], a[16:19], v[180:183]
    v_mfma_f32_16x16x32_bf16 v[184:187], a[40:43], a[16:19], v[184:187]
    v_mfma_f32_16x16x32_bf16 v[188:191], a[44:47], a[16:19], v[188:191]
    s_waitcnt lgkmcnt(4)
    v_mfma_f32_16x16x32_bf16 v[0:3], a[48:51], a[20:23], v[0:3]
    ds_read_b128 a[12:15], v204 offset:34816
    buffer_load_dwordx4 v243, s[20:23], s72 offen offset:3072 lds
    v_mfma_f32_16x16x32_bf16 v[4:7], a[52:55], a[20:23], v[4:7]
    v_mfma_f32_16x16x32_bf16 v[8:11], a[56:59], a[20:23], v[8:11]
    v_mfma_f32_16x16x32_bf16 v[12:15], a[60:63], a[20:23], v[12:15]
    s_waitcnt lgkmcnt(4)
    v_mfma_f32_16x16x32_bf16 v[16:19], a[48:51], a[24:27], v[16:19]
    ds_read_b128 a[16:19], v204 offset:36864
    s_add_u32 m0, s4, 106496
    s_mov_b32 s72, 163840
    buffer_load_dwordx4 v240, s[20:23], s72 offen lds
    v_mfma_f32_16x16x32_bf16 v[20:23], a[52:55], a[24:27], v[20:23]
    v_mfma_f32_16x16x32_bf16 v[24:27], a[56:59], a[24:27], v[24:27]
    v_mfma_f32_16x16x32_bf16 v[28:31], a[60:63], a[24:27], v[28:31]
    s_waitcnt lgkmcnt(4)
    v_mfma_f32_16x16x32_bf16 v[32:35], a[48:51], a[0:3], v[32:35]
    ds_read_b128 a[20:23], v204 offset:38912
    buffer_load_dwordx4 v241, s[20:23], s72 offen offset:1024 lds
    v_mfma_f32_16x16x32_bf16 v[36:39], a[52:55], a[0:3], v[36:39]
    v_mfma_f32_16x16x32_bf16 v[40:43], a[56:59], a[0:3], v[40:43]
    v_mfma_f32_16x16x32_bf16 v[44:47], a[60:63], a[0:3], v[44:47]
    s_waitcnt lgkmcnt(4)
    v_mfma_f32_16x16x32_bf16 v[48:51], a[48:51], a[4:7], v[48:51]
    ds_read_b128 a[24:27], v204 offset:40960
    buffer_load_dwordx4 v242, s[20:23], s72 offen offset:2048 lds
    v_mfma_f32_16x16x32_bf16 v[52:55], a[52:55], a[4:7], v[52:55]
    v_mfma_f32_16x16x32_bf16 v[56:59], a[56:59], a[4:7], v[56:59]
    v_mfma_f32_16x16x32_bf16 v[60:63], a[60:63], a[4:7], v[60:63]
    s_waitcnt lgkmcnt(4)
    v_mfma_f32_16x16x32_bf16 v[64:67], a[48:51], a[8:11], v[64:67]
    ds_read_b128 a[0:3], v204 offset:43008
    buffer_load_dwordx4 v243, s[20:23], s72 offen offset:3072 lds
    v_mfma_f32_16x16x32_bf16 v[68:71], a[52:55], a[8:11], v[68:71]
    v_mfma_f32_16x16x32_bf16 v[72:75], a[56:59], a[8:11], v[72:75]
    v_mfma_f32_16x16x32_bf16 v[76:79], a[60:63], a[8:11], v[76:79]
    s_waitcnt lgkmcnt(4)
    v_mfma_f32_16x16x32_bf16 v[80:83], a[48:51], a[12:15], v[80:83]
    ds_read_b128 a[4:7], v204 offset:45056
    v_mfma_f32_16x16x32_bf16 v[84:87], a[52:55], a[12:15], v[84:87]
    v_mfma_f32_16x16x32_bf16 v[88:91], a[56:59], a[12:15], v[88:91]
    v_mfma_f32_16x16x32_bf16 v[92:95], a[60:63], a[12:15], v[92:95]
    s_waitcnt lgkmcnt(4)
    v_mfma_f32_16x16x32_bf16 v[96:99], a[48:51], a[16:19], v[96:99]
    ds_read_b128 a[8:11], v204 offset:47104
    v_mfma_f32_16x16x32_bf16 v[100:103], a[52:55], a[16:19], v[100:103]
    v_mfma_f32_16x16x32_bf16 v[104:107], a[56:59], a[16:19], v[104:107]
    v_mfma_f32_16x16x32_bf16 v[108:111], a[60:63], a[16:19], v[108:111]
    s_waitcnt lgkmcnt(4)
    v_mfma_f32_16x16x32_bf16 v[112:115], a[48:51], a[20:23], v[112:115]
    v_mfma_f32_16x16x32_bf16 v[116:119], a[52:55], a[20:23], v[116:119]
    s_waitcnt lgkmcnt(0)
    s_barrier
    v_mfma_f32_16x16x32_bf16 v[120:123], a[56:59], a[20:23], v[120:123]
    v_mfma_f32_16x16x32_bf16 v[124:127], a[60:63], a[20:23], v[124:127]
    v_mfma_f32_16x16x32_bf16 v[128:131], a[48:51], a[24:27], v[128:131]
    v_mfma_f32_16x16x32_bf16 v[132:135], a[52:55], a[24:27], v[132:135]
    v_mfma_f32_16x16x32_bf16 v[136:139], a[56:59], a[24:27], v[136:139]
    v_mfma_f32_16x16x32_bf16 v[140:143], a[60:63], a[24:27], v[140:143]
    v_mfma_f32_16x16x32_bf16 v[144:147], a[48:51], a[0:3], v[144:147]
    v_mfma_f32_16x16x32_bf16 v[148:151], a[52:55], a[0:3], v[148:151]
    v_mfma_f32_16x16x32_bf16 v[152:155], a[56:59], a[0:3], v[152:155]
    v_mfma_f32_16x16x32_bf16 v[156:159], a[60:63], a[0:3], v[156:159]
    v_mfma_f32_16x16x32_bf16 v[160:163], a[48:51], a[4:7], v[160:163]
    s_waitcnt vmcnt(12)
    ds_read_b64_tr_b16 a[128:129], v232 offset:32768
    ds_read_b64_tr_b16 a[130:131], v232 offset:34816
    ds_read_b64_tr_b16 a[132:133], v233 offset:32768
    ds_read_b64_tr_b16 a[134:135], v233 offset:34816
    v_mfma_f32_16x16x32_bf16 v[164:167], a[52:55], a[4:7], v[164:167]
    ds_read_b64_tr_b16 a[136:137], v234 offset:32768
    ds_read_b64_tr_b16 a[138:139], v234 offset:34816
    ds_read_b64_tr_b16 a[140:141], v235 offset:32768
    ds_read_b64_tr_b16 a[142:143], v235 offset:34816
    v_mfma_f32_16x16x32_bf16 v[168:171], a[56:59], a[4:7], v[168:171]
    s_waitcnt vmcnt(8)
    ds_read_b64_tr_b16 a[160:161], v232
    ds_read_b64_tr_b16 a[162:163], v232 offset:2048
    ds_read_b64_tr_b16 a[164:165], v233
    ds_read_b64_tr_b16 a[166:167], v233 offset:2048
    v_mfma_f32_16x16x32_bf16 v[172:175], a[60:63], a[4:7], v[172:175]
    ds_read_b64_tr_b16 a[168:169], v234
    ds_read_b64_tr_b16 a[170:171], v234 offset:2048
    ds_read_b64_tr_b16 a[172:173], v235
    s_waitcnt lgkmcnt(14)
    ds_read_b64_tr_b16 a[174:175], v235 offset:2048
    v_mfma_f32_16x16x32_bf16 v[176:179], a[48:51], a[8:11], v[176:179]
    s_waitcnt lgkmcnt(8)
    s_add_u32 m0, s4, 122880
    s_mov_b32 s72, 196608
    buffer_load_dwordx4 v240, s[20:23], s72 offen lds
    v_mfma_f32_16x16x32_bf16 v[180:183], a[52:55], a[8:11], v[180:183]
    v_mfma_f32_16x16x32_bf16 v[184:187], a[56:59], a[8:11], v[184:187]
    v_mfma_f32_16x16x32_bf16 v[188:191], a[60:63], a[8:11], v[188:191]
    v_readfirstlane_b32 s38, v251
    s_nop 0
    s_add_u32 s38, s38, 0x9e3779b9
    v_pk_mul_f32 v[212:213], v[0:1], s[78:79] op_sel_hi:[1,0]
    v_pk_mul_f32 v[214:215], v[2:3], s[78:79] op_sel_hi:[1,0]
    v_exp_f32 v212, v212
    v_exp_f32 v213, v213
    v_exp_f32 v214, v214
    v_exp_f32 v215, v215
    v_pk_mul_f32 v[8:9], v[0:1], v[8:9]
    v_pk_mul_f32 v[10:11], v[2:3], v[10:11]
    v_pk_add_f32 v[212:213], v[212:213], 1.0 op_sel_hi:[1,0]
    v_pk_add_f32 v[214:215], v[214:215], 1.0 op_sel_hi:[1,0]
    v_rcp_f32 v212, v212
    v_rcp_f32 v213, v213
    v_rcp_f32 v214, v214
    v_rcp_f32 v215, v215
    v_pk_mul_f32 v[8:9], v[8:9], v[212:213]
    v_pk_mul_f32 v[10:11], v[10:11], v[214:215]
    v_pk_mul_f32 v[216:217], v[4:5], s[78:79] op_sel_hi:[1,0]
    v_pk_mul_f32 v[218:219], v[6:7], s[78:79] op_sel_hi:[1,0]
    v_exp_f32 v216, v216
    v_exp_f32 v217, v217
    v_exp_f32 v218, v218
    v_exp_f32 v219, v219
    v_pk_mul_f32 v[12:13], v[4:5], v[12:13]
    v_pk_mul_f32 v[14:15], v[6:7], v[14:15]
    v_pk_add_f32 v[216:217], v[216:217], 1.0 op_sel_hi:[1,0]
    v_pk_add_f32 v[218:219], v[218:219], 1.0 op_sel_hi:[1,0]
    v_rcp_f32 v216, v216
    v_rcp_f32 v217, v217
    v_rcp_f32 v218, v218
    v_rcp_f32 v219, v219
    v_pk_mul_f32 v[12:13], v[12:13], v[216:217]
    v_pk_mul_f32 v[14:15], v[14:15], v[218:219]
    v_cvt_pk_bf16_f32 v220, v8, v9
    v_cvt_pk_bf16_f32 v221, v10, v11
    v_cvt_pk_bf16_f32 v222, v12, v13
    v_cvt_pk_bf16_f32 v223, v14, v15
    s_mov_b32 s74, 0
    buffer_store_dwordx4 v[220:223], v210, s[16:19], s74 offen sc1
    v_pk_mul_f32 v[212:213], v[16:17], s[78:79] op_sel_hi:[1,0]
    v_pk_mul_f32 v[214:215], v[18:19], s[78:79] op_sel_hi:[1,0]
    v_exp_f32 v212, v212
    v_exp_f32 v213, v213
    v_exp_f32 v214, v214
    v_exp_f32 v215, v215
    v_pk_mul_f32 v[24:25], v[16:17], v[24:25]
    v_pk_mul_f32 v[26:27], v[18:19], v[26:27]
    v_pk_add_f32 v[212:213], v[212:213], 1.0 op_sel_hi:[1,0]
    v_pk_add_f32 v[214:215], v[214:215], 1.0 op_sel_hi:[1,0]
    v_rcp_f32 v212, v212
    v_rcp_f32 v213, v213
    v_rcp_f32 v214, v214
    v_rcp_f32 v215, v215
    v_pk_mul_f32 v[24:25], v[24:25], v[212:213]
    v_pk_mul_f32 v[26:27], v[26:27], v[214:215]
    v_pk_mul_f32 v[216:217], v[20:21], s[78:79] op_sel_hi:[1,0]
    v_pk_mul_f32 v[218:219], v[22:23], s[78:79] op_sel_hi:[1,0]
    v_exp_f32 v216, v216
    v_exp_f32 v217, v217
    v_exp_f32 v218, v218
    v_exp_f32 v219, v219
    v_pk_mul_f32 v[28:29], v[20:21], v[28:29]
    v_pk_mul_f32 v[30:31], v[22:23], v[30:31]
    v_pk_add_f32 v[216:217], v[216:217], 1.0 op_sel_hi:[1,0]
    v_pk_add_f32 v[218:219], v[218:219], 1.0 op_sel_hi:[1,0]
    v_rcp_f32 v216, v216
    v_rcp_f32 v217, v217
    v_rcp_f32 v218, v218
    v_rcp_f32 v219, v219
    v_pk_mul_f32 v[28:29], v[28:29], v[216:217]
    v_pk_mul_f32 v[30:31], v[30:31], v[218:219]
    v_cvt_pk_bf16_f32 v224, v24, v25
    v_cvt_pk_bf16_f32 v225, v26, v27
    v_cvt_pk_bf16_f32 v226, v28, v29
    v_cvt_pk_bf16_f32 v227, v30, v31
    s_mov_b32 s74, 57344
    buffer_store_dwordx4 v[224:227], v210, s[16:19], s74 offen sc1
    v_pk_mul_f32 v[212:213], v[32:33], s[78:79] op_sel_hi:[1,0]
    v_pk_mul_f32 v[214:215], v[34:35], s[78:79] op_sel_hi:[1,0]
    v_exp_f32 v212, v212
    v_exp_f32 v213, v213
    v_exp_f32 v214, v214
    v_exp_f32 v215, v215
    v_pk_mul_f32 v[40:41], v[32:33], v[40:41]
    v_pk_mul_f32 v[42:43], v[34:35], v[42:43]
    v_pk_add_f32 v[212:213], v[212:213], 1.0 op_sel_hi:[1,0]
    v_pk_add_f32 v[214:215], v[214:215], 1.0 op_sel_hi:[1,0]
    v_rcp_f32 v212, v212
    v_rcp_f32 v213, v213
    v_rcp_f32 v214, v214
    v_rcp_f32 v215, v215
    v_pk_mul_f32 v[40:41], v[40:41], v[212:213]
    v_pk_mul_f32 v[42:43], v[42:43], v[214:215]
    v_pk_mul_f32 v[216:217], v[36:37], s[78:79] op_sel_hi:[1,0]
    v_pk_mul_f32 v[218:219], v[38:39], s[78:79] op_sel_hi:[1,0]
    v_exp_f32 v216, v216
    v_exp_f32 v217, v217
    v_exp_f32 v218, v218
    v_exp_f32 v219, v219
    v_pk_mul_f32 v[44:45], v[36:37], v[44:45]
    v_pk_mul_f32 v[46:47], v[38:39], v[46:47]
    v_pk_add_f32 v[216:217], v[216:217], 1.0 op_sel_hi:[1,0]
    v_pk_add_f32 v[218:219], v[218:219], 1.0 op_sel_hi:[1,0]
    v_rcp_f32 v216, v216
    v_rcp_f32 v217, v217
    v_rcp_f32 v218, v218
    v_rcp_f32 v219, v219
    v_pk_mul_f32 v[44:45], v[44:45], v[216:217]
    v_pk_mul_f32 v[46:47], v[46:47], v[218:219]
    v_cvt_pk_bf16_f32 v220, v40, v41
    v_cvt_pk_bf16_f32 v221, v42, v43
    v_cvt_pk_bf16_f32 v222, v44, v45
    v_cvt_pk_bf16_f32 v223, v46, v47
    s_mov_b32 s74, 114688
    buffer_store_dwordx4 v[220:223], v210, s[16:19], s74 offen sc1
    v_pk_mul_f32 v[212:213], v[48:49], s[78:79] op_sel_hi:[1,0]
    v_pk_mul_f32 v[214:215], v[50:51], s[78:79] op_sel_hi:[1,0]
    v_exp_f32 v212, v212
    v_exp_f32 v213, v213
    v_exp_f32 v214, v214
    v_exp_f32 v215, v215
    v_pk_mul_f32 v[56:57], v[48:49], v[56:57]
    v_pk_mul_f32 v[58:59], v[50:51], v[58:59]
    v_pk_add_f32 v[212:213], v[212:213], 1.0 op_sel_hi:[1,0]
    v_pk_add_f32 v[214:215], v[214:215], 1.0 op_sel_hi:[1,0]
    v_rcp_f32 v212, v212
    v_rcp_f32 v213, v213
    v_rcp_f32 v214, v214
    v_rcp_f32 v215, v215
    v_pk_mul_f32 v[56:57], v[56:57], v[212:213]
    v_pk_mul_f32 v[58:59], v[58:59], v[214:215]
    v_pk_mul_f32 v[216:217], v[52:53], s[78:79] op_sel_hi:[1,0]
    v_pk_mul_f32 v[218:219], v[54:55], s[78:79] op_sel_hi:[1,0]
    v_exp_f32 v216, v216
    v_exp_f32 v217, v217
    v_exp_f32 v218, v218
    v_exp_f32 v219, v219
    v_pk_mul_f32 v[60:61], v[52:53], v[60:61]
    v_pk_mul_f32 v[62:63], v[54:55], v[62:63]
    v_pk_add_f32 v[216:217], v[216:217], 1.0 op_sel_hi:[1,0]
    v_pk_add_f32 v[218:219], v[218:219], 1.0 op_sel_hi:[1,0]
    v_rcp_f32 v216, v216
    v_rcp_f32 v217, v217
    v_rcp_f32 v218, v218
    v_rcp_f32 v219, v219
    v_pk_mul_f32 v[60:61], v[60:61], v[216:217]
    v_pk_mul_f32 v[62:63], v[62:63], v[218:219]
    v_cvt_pk_bf16_f32 v224, v56, v57
    v_cvt_pk_bf16_f32 v225, v58, v59
    v_cvt_pk_bf16_f32 v226, v60, v61
    v_cvt_pk_bf16_f32 v227, v62, v63
    s_mov_b32 s74, 172032
    buffer_store_dwordx4 v[224:227], v210, s[16:19], s74 offen sc1
    v_pk_mul_f32 v[212:213], v[64:65], s[78:79] op_sel_hi:[1,0]
    v_pk_mul_f32 v[214:215], v[66:67], s[78:79] op_sel_hi:[1,0]
    v_exp_f32 v212, v212
    v_exp_f32 v213, v213
    v_exp_f32 v214, v214
    v_exp_f32 v215, v215
    v_pk_mul_f32 v[72:73], v[64:65], v[72:73]
    v_pk_mul_f32 v[74:75], v[66:67], v[74:75]
    v_pk_add_f32 v[212:213], v[212:213], 1.0 op_sel_hi:[1,0]
    v_pk_add_f32 v[214:215], v[214:215], 1.0 op_sel_hi:[1,0]
    v_rcp_f32 v212, v212
    v_rcp_f32 v213, v213
    v_rcp_f32 v214, v214
    v_rcp_f32 v215, v215
    v_pk_mul_f32 v[72:73], v[72:73], v[212:213]
    v_pk_mul_f32 v[74:75], v[74:75], v[214:215]
    v_pk_mul_f32 v[216:217], v[68:69], s[78:79] op_sel_hi:[1,0]
    v_pk_mul_f32 v[218:219], v[70:71], s[78:79] op_sel_hi:[1,0]
    v_exp_f32 v216, v216
    v_exp_f32 v217, v217
    v_exp_f32 v218, v218
    v_exp_f32 v219, v219
    v_pk_mul_f32 v[76:77], v[68:69], v[76:77]
    v_pk_mul_f32 v[78:79], v[70:71], v[78:79]
    v_pk_add_f32 v[216:217], v[216:217], 1.0 op_sel_hi:[1,0]
    v_pk_add_f32 v[218:219], v[218:219], 1.0 op_sel_hi:[1,0]
    v_rcp_f32 v216, v216
    v_rcp_f32 v217, v217
    v_rcp_f32 v218, v218
    v_rcp_f32 v219, v219
    v_pk_mul_f32 v[76:77], v[76:77], v[216:217]
    v_pk_mul_f32 v[78:79], v[78:79], v[218:219]
    v_cvt_pk_bf16_f32 v220, v72, v73
    v_cvt_pk_bf16_f32 v221, v74, v75
    v_cvt_pk_bf16_f32 v222, v76, v77
    v_cvt_pk_bf16_f32 v223, v78, v79
    s_mov_b32 s74, 229376
    buffer_store_dwordx4 v[220:223], v210, s[16:19], s74 offen sc1
    v_pk_mul_f32 v[212:213], v[80:81], s[78:79] op_sel_hi:[1,0]
    v_pk_mul_f32 v[214:215], v[82:83], s[78:79] op_sel_hi:[1,0]
    v_exp_f32 v212, v212
    v_exp_f32 v213, v213
    v_exp_f32 v214, v214
    v_exp_f32 v215, v215
    v_pk_mul_f32 v[88:89], v[80:81], v[88:89]
    v_pk_mul_f32 v[90:91], v[82:83], v[90:91]
    v_pk_add_f32 v[212:213], v[212:213], 1.0 op_sel_hi:[1,0]
    v_pk_add_f32 v[214:215], v[214:215], 1.0 op_sel_hi:[1,0]
    v_rcp_f32 v212, v212
    v_rcp_f32 v213, v213
    v_rcp_f32 v214, v214
    v_rcp_f32 v215, v215
    v_pk_mul_f32 v[88:89], v[88:89], v[212:213]
    v_pk_mul_f32 v[90:91], v[90:91], v[214:215]
    v_pk_mul_f32 v[216:217], v[84:85], s[78:79] op_sel_hi:[1,0]
    v_pk_mul_f32 v[218:219], v[86:87], s[78:79] op_sel_hi:[1,0]
    v_exp_f32 v216, v216
    v_exp_f32 v217, v217
    v_exp_f32 v218, v218
    v_exp_f32 v219, v219
    v_pk_mul_f32 v[92:93], v[84:85], v[92:93]
    v_pk_mul_f32 v[94:95], v[86:87], v[94:95]
    v_pk_add_f32 v[216:217], v[216:217], 1.0 op_sel_hi:[1,0]
    v_pk_add_f32 v[218:219], v[218:219], 1.0 op_sel_hi:[1,0]
    v_rcp_f32 v216, v216
    v_rcp_f32 v217, v217
    v_rcp_f32 v218, v218
    v_rcp_f32 v219, v219
    v_pk_mul_f32 v[92:93], v[92:93], v[216:217]
    v_pk_mul_f32 v[94:95], v[94:95], v[218:219]
    v_cvt_pk_bf16_f32 v224, v88, v89
    v_cvt_pk_bf16_f32 v225, v90, v91
    v_cvt_pk_bf16_f32 v226, v92, v93
    v_cvt_pk_bf16_f32 v227, v94, v95
    s_mov_b32 s74, 286720
    buffer_store_dwordx4 v[224:227], v210, s[16:19], s74 offen sc1
    v_pk_mul_f32 v[212:213], v[96:97], s[78:79] op_sel_hi:[1,0]
    v_pk_mul_f32 v[214:215], v[98:99], s[78:79] op_sel_hi:[1,0]
    v_exp_f32 v212, v212
    v_exp_f32 v213, v213
    v_exp_f32 v214, v214
    v_exp_f32 v215, v215
    v_pk_mul_f32 v[104:105], v[96:97], v[104:105]
    v_pk_mul_f32 v[106:107], v[98:99], v[106:107]
    v_pk_add_f32 v[212:213], v[212:213], 1.0 op_sel_hi:[1,0]
    v_pk_add_f32 v[214:215], v[214:215], 1.0 op_sel_hi:[1,0]
    v_rcp_f32 v212, v212
    v_rcp_f32 v213, v213
    v_rcp_f32 v214, v214
    v_rcp_f32 v215, v215
    v_pk_mul_f32 v[104:105], v[104:105], v[212:213]
    v_pk_mul_f32 v[106:107], v[106:107], v[214:215]
    v_pk_mul_f32 v[216:217], v[100:101], s[78:79] op_sel_hi:[1,0]
    v_pk_mul_f32 v[218:219], v[102:103], s[78:79] op_sel_hi:[1,0]
    v_exp_f32 v216, v216
    v_exp_f32 v217, v217
    v_exp_f32 v218, v218
    v_exp_f32 v219, v219
    v_pk_mul_f32 v[108:109], v[100:101], v[108:109]
    v_pk_mul_f32 v[110:111], v[102:103], v[110:111]
    v_pk_add_f32 v[216:217], v[216:217], 1.0 op_sel_hi:[1,0]
    v_pk_add_f32 v[218:219], v[218:219], 1.0 op_sel_hi:[1,0]
    v_rcp_f32 v216, v216
    v_rcp_f32 v217, v217
    v_rcp_f32 v218, v218
    v_rcp_f32 v219, v219
    v_pk_mul_f32 v[108:109], v[108:109], v[216:217]
    v_pk_mul_f32 v[110:111], v[110:111], v[218:219]
    v_cvt_pk_bf16_f32 v220, v104, v105
    v_cvt_pk_bf16_f32 v221, v106, v107
    v_cvt_pk_bf16_f32 v222, v108, v109
    v_cvt_pk_bf16_f32 v223, v110, v111
    s_mov_b32 s74, 344064
    buffer_store_dwordx4 v[220:223], v210, s[16:19], s74 offen sc1
    v_pk_mul_f32 v[212:213], v[112:113], s[78:79] op_sel_hi:[1,0]
    v_pk_mul_f32 v[214:215], v[114:115], s[78:79] op_sel_hi:[1,0]
    v_exp_f32 v212, v212
    v_exp_f32 v213, v213
    v_exp_f32 v214, v214
    v_exp_f32 v215, v215
    v_pk_mul_f32 v[120:121], v[112:113], v[120:121]
    v_pk_mul_f32 v[122:123], v[114:115], v[122:123]
    v_pk_add_f32 v[212:213], v[212:213], 1.0 op_sel_hi:[1,0]
    v_pk_add_f32 v[214:215], v[214:215], 1.0 op_sel_hi:[1,0]
    v_rcp_f32 v212, v212
    v_rcp_f32 v213, v213
    v_rcp_f32 v214, v214
    v_rcp_f32 v215, v215
    v_pk_mul_f32 v[120:121], v[120:121], v[212:213]
    v_pk_mul_f32 v[122:123], v[122:123], v[214:215]
    v_pk_mul_f32 v[216:217], v[116:117], s[78:79] op_sel_hi:[1,0]
    v_pk_mul_f32 v[218:219], v[118:119], s[78:79] op_sel_hi:[1,0]
    v_exp_f32 v216, v216
    v_exp_f32 v217, v217
    v_exp_f32 v218, v218
    v_exp_f32 v219, v219
    v_pk_mul_f32 v[124:125], v[116:117], v[124:125]
    v_pk_mul_f32 v[126:127], v[118:119], v[126:127]
    v_pk_add_f32 v[216:217], v[216:217], 1.0 op_sel_hi:[1,0]
    v_pk_add_f32 v[218:219], v[218:219], 1.0 op_sel_hi:[1,0]
    v_rcp_f32 v216, v216
    v_rcp_f32 v217, v217
    v_rcp_f32 v218, v218
    v_rcp_f32 v219, v219
    v_pk_mul_f32 v[124:125], v[124:125], v[216:217]
    v_pk_mul_f32 v[126:127], v[126:127], v[218:219]
    v_cvt_pk_bf16_f32 v224, v120, v121
    v_cvt_pk_bf16_f32 v225, v122, v123
    v_cvt_pk_bf16_f32 v226, v124, v125
    v_cvt_pk_bf16_f32 v227, v126, v127
    s_mov_b32 s74, 401408
    buffer_store_dwordx4 v[224:227], v210, s[16:19], s74 offen sc1
    v_pk_mul_f32 v[212:213], v[128:129], s[78:79] op_sel_hi:[1,0]
    v_pk_mul_f32 v[214:215], v[130:131], s[78:79] op_sel_hi:[1,0]
    v_exp_f32 v212, v212
    v_exp_f32 v213, v213
    v_exp_f32 v214, v214
    v_exp_f32 v215, v215
    v_pk_mul_f32 v[136:137], v[128:129], v[136:137]
    v_pk_mul_f32 v[138:139], v[130:131], v[138:139]
    v_pk_add_f32 v[212:213], v[212:213], 1.0 op_sel_hi:[1,0]
    v_pk_add_f32 v[214:215], v[214:215], 1.0 op_sel_hi:[1,0]
    v_rcp_f32 v212, v212
    v_rcp_f32 v213, v213
    v_rcp_f32 v214, v214
    v_rcp_f32 v215, v215
    v_pk_mul_f32 v[136:137], v[136:137], v[212:213]
    v_pk_mul_f32 v[138:139], v[138:139], v[214:215]
    v_pk_mul_f32 v[216:217], v[132:133], s[78:79] op_sel_hi:[1,0]
    v_pk_mul_f32 v[218:219], v[134:135], s[78:79] op_sel_hi:[1,0]
    v_exp_f32 v216, v216
    v_exp_f32 v217, v217
    v_exp_f32 v218, v218
    v_exp_f32 v219, v219
    v_pk_mul_f32 v[140:141], v[132:133], v[140:141]
    v_pk_mul_f32 v[142:143], v[134:135], v[142:143]
    v_pk_add_f32 v[216:217], v[216:217], 1.0 op_sel_hi:[1,0]
    v_pk_add_f32 v[218:219], v[218:219], 1.0 op_sel_hi:[1,0]
    v_rcp_f32 v216, v216
    v_rcp_f32 v217, v217
    v_rcp_f32 v218, v218
    v_rcp_f32 v219, v219
    v_pk_mul_f32 v[140:141], v[140:141], v[216:217]
    v_pk_mul_f32 v[142:143], v[142:143], v[218:219]
    v_cvt_pk_bf16_f32 v220, v136, v137
    v_cvt_pk_bf16_f32 v221, v138, v139
    v_cvt_pk_bf16_f32 v222, v140, v141
    v_cvt_pk_bf16_f32 v223, v142, v143
    s_mov_b32 s74, 458752
    buffer_store_dwordx4 v[220:223], v210, s[16:19], s74 offen sc1
    v_pk_mul_f32 v[212:213], v[144:145], s[78:79] op_sel_hi:[1,0]
    v_pk_mul_f32 v[214:215], v[146:147], s[78:79] op_sel_hi:[1,0]
    v_exp_f32 v212, v212
    v_exp_f32 v213, v213
    v_exp_f32 v214, v214
    v_exp_f32 v215, v215
    v_pk_mul_f32 v[152:153], v[144:145], v[152:153]
    v_pk_mul_f32 v[154:155], v[146:147], v[154:155]
    v_pk_add_f32 v[212:213], v[212:213], 1.0 op_sel_hi:[1,0]
    v_pk_add_f32 v[214:215], v[214:215], 1.0 op_sel_hi:[1,0]
    v_rcp_f32 v212, v212
    v_rcp_f32 v213, v213
    v_rcp_f32 v214, v214
    v_rcp_f32 v215, v215
    v_pk_mul_f32 v[152:153], v[152:153], v[212:213]
    v_pk_mul_f32 v[154:155], v[154:155], v[214:215]
    v_pk_mul_f32 v[216:217], v[148:149], s[78:79] op_sel_hi:[1,0]
    v_pk_mul_f32 v[218:219], v[150:151], s[78:79] op_sel_hi:[1,0]
    v_exp_f32 v216, v216
    v_exp_f32 v217, v217
    v_exp_f32 v218, v218
    v_exp_f32 v219, v219
    v_pk_mul_f32 v[156:157], v[148:149], v[156:157]
    v_pk_mul_f32 v[158:159], v[150:151], v[158:159]
    v_pk_add_f32 v[216:217], v[216:217], 1.0 op_sel_hi:[1,0]
    v_pk_add_f32 v[218:219], v[218:219], 1.0 op_sel_hi:[1,0]
    v_rcp_f32 v216, v216
    v_rcp_f32 v217, v217
    v_rcp_f32 v218, v218
    v_rcp_f32 v219, v219
    v_pk_mul_f32 v[156:157], v[156:157], v[216:217]
    v_pk_mul_f32 v[158:159], v[158:159], v[218:219]
    v_cvt_pk_bf16_f32 v224, v152, v153
    v_cvt_pk_bf16_f32 v225, v154, v155
    v_cvt_pk_bf16_f32 v226, v156, v157
    v_cvt_pk_bf16_f32 v227, v158, v159
    s_mov_b32 s74, 516096
    buffer_store_dwordx4 v[224:227], v210, s[16:19], s74 offen sc1
    v_pk_mul_f32 v[212:213], v[160:161], s[78:79] op_sel_hi:[1,0]
    v_pk_mul_f32 v[214:215], v[162:163], s[78:79] op_sel_hi:[1,0]
    v_exp_f32 v212, v212
    v_exp_f32 v213, v213
    v_exp_f32 v214, v214
    v_exp_f32 v215, v215
    v_pk_mul_f32 v[168:169], v[160:161], v[168:169]
    v_pk_mul_f32 v[170:171], v[162:163], v[170:171]
    v_pk_add_f32 v[212:213], v[212:213], 1.0 op_sel_hi:[1,0]
    v_pk_add_f32 v[214:215], v[214:215], 1.0 op_sel_hi:[1,0]
    v_rcp_f32 v212, v212
    v_rcp_f32 v213, v213
    v_rcp_f32 v214, v214
    v_rcp_f32 v215, v215
    v_pk_mul_f32 v[168:169], v[168:169], v[212:213]
    v_pk_mul_f32 v[170:171], v[170:171], v[214:215]
    v_pk_mul_f32 v[216:217], v[164:165], s[78:79] op_sel_hi:[1,0]
    v_pk_mul_f32 v[218:219], v[166:167], s[78:79] op_sel_hi:[1,0]
    v_exp_f32 v216, v216
    v_exp_f32 v217, v217
    v_exp_f32 v218, v218
    v_exp_f32 v219, v219
    v_pk_mul_f32 v[172:173], v[164:165], v[172:173]
    v_pk_mul_f32 v[174:175], v[166:167], v[174:175]
    v_pk_add_f32 v[216:217], v[216:217], 1.0 op_sel_hi:[1,0]
    v_pk_add_f32 v[218:219], v[218:219], 1.0 op_sel_hi:[1,0]
    v_rcp_f32 v216, v216
    v_rcp_f32 v217, v217
    v_rcp_f32 v218, v218
    v_rcp_f32 v219, v219
    v_pk_mul_f32 v[172:173], v[172:173], v[216:217]
    v_pk_mul_f32 v[174:175], v[174:175], v[218:219]
    v_cvt_pk_bf16_f32 v220, v168, v169
    v_cvt_pk_bf16_f32 v221, v170, v171
    v_cvt_pk_bf16_f32 v222, v172, v173
    v_cvt_pk_bf16_f32 v223, v174, v175
    s_mov_b32 s74, 573440
    buffer_store_dwordx4 v[220:223], v210, s[16:19], s74 offen sc1
    v_pk_mul_f32 v[212:213], v[176:177], s[78:79] op_sel_hi:[1,0]
    v_pk_mul_f32 v[214:215], v[178:179], s[78:79] op_sel_hi:[1,0]
    v_exp_f32 v212, v212
    v_exp_f32 v213, v213
    v_exp_f32 v214, v214
    v_exp_f32 v215, v215
    v_pk_mul_f32 v[184:185], v[176:177], v[184:185]
    v_pk_mul_f32 v[186:187], v[178:179], v[186:187]
    v_pk_add_f32 v[212:213], v[212:213], 1.0 op_sel_hi:[1,0]
    v_pk_add_f32 v[214:215], v[214:215], 1.0 op_sel_hi:[1,0]
    v_rcp_f32 v212, v212
    v_rcp_f32 v213, v213
    v_rcp_f32 v214, v214
    v_rcp_f32 v215, v215
    v_pk_mul_f32 v[184:185], v[184:185], v[212:213]
    v_pk_mul_f32 v[186:187], v[186:187], v[214:215]
    v_pk_mul_f32 v[216:217], v[180:181], s[78:79] op_sel_hi:[1,0]
    v_pk_mul_f32 v[218:219], v[182:183], s[78:79] op_sel_hi:[1,0]
    v_exp_f32 v216, v216
    v_exp_f32 v217, v217
    v_exp_f32 v218, v218
    v_exp_f32 v219, v219
    v_pk_mul_f32 v[188:189], v[180:181], v[188:189]
    v_pk_mul_f32 v[190:191], v[182:183], v[190:191]
    v_pk_add_f32 v[216:217], v[216:217], 1.0 op_sel_hi:[1,0]
    v_pk_add_f32 v[218:219], v[218:219], 1.0 op_sel_hi:[1,0]
    v_rcp_f32 v216, v216
    v_rcp_f32 v217, v217
    v_rcp_f32 v218, v218
    v_rcp_f32 v219, v219
    v_pk_mul_f32 v[188:189], v[188:189], v[216:217]
    v_pk_mul_f32 v[190:191], v[190:191], v[218:219]
    v_cvt_pk_bf16_f32 v224, v184, v185
    v_cvt_pk_bf16_f32 v225, v186, v187
    v_cvt_pk_bf16_f32 v226, v188, v189
    v_cvt_pk_bf16_f32 v227, v190, v191
    s_mov_b32 s74, 630784
    buffer_store_dwordx4 v[224:227], v210, s[16:19], s74 offen sc1
    s_waitcnt vmcnt(0)
    s_barrier
    s_cmp_lg_u32 s64, 0
    s_cbranch_scc1 L_skip_2
    v_mov_b32 v252, s38
    s_mov_b32 exec_lo, 1
    s_mov_b32 exec_hi, 0
    buffer_store_dword v252, off, s[16:19], s77 sc1
    s_mov_b32 exec_lo, -1
    s_mov_b32 exec_hi, -1
L_skip_2:
    buffer_load_dwordx4 v241, s[20:23], s72 offen offset:1024 lds
    buffer_load_dwordx4 v242, s[20:23], s72 offen offset:2048 lds
    buffer_load_dwordx4 v243, s[20:23], s72 offen offset:3072 lds
    ds_read_b64_tr_b16 a[144:145], v232 offset:49152
    ds_read_b64_tr_b16 a[146:147], v232 offset:51200
    ds_read_b64_tr_b16 a[148:149], v233 offset:49152
    ds_read_b64_tr_b16 a[150:151], v233 offset:51200
    ds_read_b64_tr_b16 a[152:153], v234 offset:49152
    ds_read_b64_tr_b16 a[154:155], v234 offset:51200
    ds_read_b64_tr_b16 a[156:157], v235 offset:49152
    s_waitcnt lgkmcnt(14)
    ds_read_b64_tr_b16 a[158:159], v235 offset:51200
    s_waitcnt lgkmcnt(0)
    s_add_u32 m0, s4, 139264
    s_mov_b32 s72, 229376
    buffer_load_dwordx4 v240, s[20:23], s72 offen lds
    buffer_load_dwordx4 v241, s[20:23], s72 offen offset:1024 lds
    buffer_load_dwordx4 v242, s[20:23], s72 offen offset:2048 lds
    buffer_load_dwordx4 v243, s[20:23], s72 offen offset:3072 lds
    ds_read_b64_tr_b16 a[176:177], v232 offset:16384
    ds_read_b64_tr_b16 a[178:179], v232 offset:18432
    ds_read_b64_tr_b16 a[180:181], v233 offset:16384
    ds_read_b64_tr_b16 a[182:183], v233 offset:18432
    ds_read_b64_tr_b16 a[184:185], v234 offset:16384
    ds_read_b64_tr_b16 a[186:187], v234 offset:18432
    ds_read_b64_tr_b16 a[188:189], v235 offset:16384
    ds_read_b64_tr_b16 a[190:191], v235 offset:18432
    s_waitcnt vmcnt(4)
    ds_read_b64_tr_b16 a[192:193], v232 offset:32768
    ds_read_b64_tr_b16 a[194:195], v232 offset:34816
    ds_read_b64_tr_b16 a[196:197], v233 offset:32768
    ds_read_b64_tr_b16 a[198:199], v233 offset:34816
    ds_read_b64_tr_b16 a[200:201], v234 offset:32768
    ds_read_b64_tr_b16 a[202:203], v234 offset:34816
    ds_read_b64_tr_b16 a[204:205], v235 offset:32768
    s_waitcnt lgkmcnt(14)
    ds_read_b64_tr_b16 a[206:207], v235 offset:34816
    s_waitcnt vmcnt(0)
    s_waitcnt lgkmcnt(14)
    ds_read_b64_tr_b16 a[208:209], v232 offset:49152
    s_waitcnt lgkmcnt(14)
    ds_read_b64_tr_b16 a[210:211], v232 offset:51200
    s_waitcnt lgkmcnt(14)
    ds_read_b64_tr_b16 a[212:213], v233 offset:49152
    s_waitcnt lgkmcnt(14)
    ds_read_b64_tr_b16 a[214:215], v233 offset:51200
    s_waitcnt lgkmcnt(14)
    ds_read_b64_tr_b16 a[216:217], v234 offset:49152
    s_waitcnt lgkmcnt(14)
    ds_read_b64_tr_b16 a[218:219], v234 offset:51200
    s_waitcnt lgkmcnt(14)
    ds_read_b64_tr_b16 a[220:221], v235 offset:49152
    s_waitcnt lgkmcnt(14)
    ds_read_b64_tr_b16 a[222:223], v235 offset:51200
    s_waitcnt lgkmcnt(0)
    v_lshlrev_b32 v184, 4, v254
    v_add_u32 v185, 57344, v184
    v_add_u32 v186, 114688, v184
    v_add_u32 v187, 172032, v184
    s_lshl_b32 s74, s67, 6
    s_mul_hi_u32 s75, s74, 0x1555556
    s_add_u32 s73, s74, 63
    s_mul_hi_u32 s73, s73, 0x1555556
    s_lshl_b32 s75, s75, 7
    s_lshl_b32 s73, s73, 7
    v_mov_b32 v212, s75
    v_mov_b32 v213, s73
    s_mov_b32 s80, 0xffff0000
    s_mov_b32 s81, 0
    v_cndmask_b32 v188, v212, v213, s[80:81]
    s_mul_hi_u32 s75, s74, 0x1745d18
    s_add_u32 s73, s74, 63
    s_mul_hi_u32 s73, s73, 0x1745d18
    s_lshl_b32 s75, s75, 7
    s_lshl_b32 s73, s73, 7
    s_add_u32 s75, s75, 4096
    s_add_u32 s73, s73, 4096
    v_mov_b32 v212, s75
    v_mov_b32 v213, s73
    s_mov_b32 s80, 0
    s_mov_b32 s81, 0x0000ffff
    v_cndmask_b32 v188, v188, v212, s[80:81]
    s_mov_b32 s81, 0xffff0000
    v_cndmask_b32 v188, v188, v213, s[80:81]
    v_and_b32 v212, 15, v254
    v_lshl_add_u32 v188, v212, 2, v188
    v_add_u32 v188, 13631488, v188
    s_mul_i32 s69, s67, 224
    s_mul_i32 s74, s64, 14
    s_add_u32 s69, s69, s74
    s_lshl_b32 s69, s69, 10
    s_lshl_b32 s70, s67, 6
    s_lshl_b32 s74, s64, 2
    s_add_u32 s70, s70, s74
    s_lshl_b32 s70, s70, 10
    s_add_u32 s70, s70, 8388608
    v_bfe_u32 v212, v254, 2, 2
    v_lshrrev_b32 v213, 4, v254
    v_lshl_add_u32 v214, v213, 2, v212
    v_bfe_u32 v215, v214, 1, 2
    v_lshlrev_b32 v214, 7, v214
    v_and_b32 v212, 3, v254
    v_lshl_add_u32 v214, v212, 3, v214
    s_add_u32 s74, s4, 0
    v_add_u32 v214, s74, v214
    v_xor_b32 v212, 0, v215
    v_lshl_add_u32 v232, v212, 5, v214
    v_xor_b32 v212, 1, v215
    v_lshl_add_u32 v233, v212, 5, v214
    v_xor_b32 v212, 2, v215
    v_lshl_add_u32 v234, v212, 5, v214
    v_xor_b32 v212, 3, v215
    v_lshl_add_u32 v235, v212, 5, v214
    s_barrier
    s_add_u32 m0, s4, 0
    s_mov_b32 s72, 262144
    buffer_load_dwordx4 v240, s[20:23], s72 offen lds
    buffer_load_dwordx4 v241, s[20:23], s72 offen offset:1024 lds
    buffer_load_dwordx4 v242, s[20:23], s72 offen offset:2048 lds
    buffer_load_dwordx4 v243, s[20:23], s72 offen offset:3072 lds
    s_add_u32 m0, s4, 16384
    s_mov_b32 s72, 294912
    buffer_load_dwordx4 v240, s[20:23], s72 offen lds
    buffer_load_dwordx4 v241, s[20:23], s72 offen offset:1024 lds
    buffer_load_dwordx4 v242, s[20:23], s72 offen offset:2048 lds
    buffer_load_dwordx4 v243, s[20:23], s72 offen offset:3072 lds
    s_add_u32 m0, s4, 32768
    s_mov_b32 s72, 327680
    buffer_load_dwordx4 v240, s[20:23], s72 offen lds
    buffer_load_dwordx4 v241, s[20:23], s72 offen offset:1024 lds
    buffer_load_dwordx4 v242, s[20:23], s72 offen offset:2048 lds
    buffer_load_dwordx4 v243, s[20:23], s72 offen offset:3072 lds
    s_add_u32 m0, s4, 49152
    s_mov_b32 s72, 360448
    buffer_load_dwordx4 v240, s[20:23], s72 offen lds
    buffer_load_dwordx4 v241, s[20:23], s72 offen offset:1024 lds
    buffer_load_dwordx4 v242, s[20:23], s72 offen offset:2048 lds
    buffer_load_dwordx4 v243, s[20:23], s72 offen offset:3072 lds
    s_add_u32 m0, s4, 65536
    s_mov_b32 s72, 393216
    buffer_load_dwordx4 v240, s[20:23], s72 offen lds
    buffer_load_dwordx4 v241, s[20:23], s72 offen offset:1024 lds
    buffer_load_dwordx4 v242, s[20:23], s72 offen offset:2048 lds
    buffer_load_dwordx4 v243, s[20:23], s72 offen offset:3072 lds
    s_add_u32 m0, s4, 81920
    s_mov_b32 s72, 425984
    buffer_load_dwordx4 v240, s[20:23], s72 offen lds
    buffer_load_dwordx4 v241, s[20:23], s72 offen offset:1024 lds
    buffer_load_dwordx4 v242, s[20:23], s72 offen offset:2048 lds
    buffer_load_dwordx4 v243, s[20:23], s72 offen offset:3072 lds
    s_add_u32 m0, s4, 98304
    s_mov_b32 s72, 0
    buffer_load_dwordx4 v244, s[24:27], s72 offen lds
    buffer_load_dwordx4 v245, s[24:27], s72 offen offset:1024 lds
    buffer_load_dwordx4 v246, s[24:27], s72 offen offset:2048 lds
    buffer_load_dwordx4 v247, s[24:27], s72 offen offset:3072 lds
    s_add_u32 m0, s4, 114688
    s_mov_b32 s72, 32768
    buffer_load_dwordx4 v244, s[24:27], s72 offen lds
    buffer_load_dwordx4 v245, s[24:27], s72 offen offset:1024 lds
    buffer_load_dwordx4 v246, s[24:27], s72 offen offset:2048 lds
    buffer_load_dwordx4 v247, s[24:27], s72 offen offset:3072 lds
    s_add_u32 m0, s4, 131072
    s_mov_b32 s72, 65536
    buffer_load_dwordx4 v244, s[24:27], s72 offen lds
    buffer_load_dwordx4 v245, s[24:27], s72 offen offset:1024 lds
    buffer_load_dwordx4 v246, s[24:27], s72 offen offset:2048 lds
    buffer_load_dwordx4 v247, s[24:27], s72 offen offset:3072 lds
    s_add_u32 m0, s4, 147456
    s_mov_b32 s72, 98304
    buffer_load_dwordx4 v244, s[24:27], s72 offen lds
    buffer_load_dwordx4 v245, s[24:27], s72 offen offset:1024 lds
    buffer_load_dwordx4 v246, s[24:27], s72 offen offset:2048 lds
    buffer_load_dwordx4 v247, s[24:27], s72 offen offset:3072 lds
    s_mul_i32 s74, s64, 7
    s_lshr_b32 s74, s74, 1
    s_lshl_b32 s80, 0x000f000f, s74
    s_mov_b32 s81, 0
    s_mov_b32 s5, 0
L_hpoll_3:
    buffer_load_dword v189, v188, s[16:19], 0 offen sc1
    s_waitcnt vmcnt(0)
    v_cmp_eq_u32 vcc, s38, v189
    s_nop 0
    s_and_b64 s[82:83], vcc, s[80:81]
    s_cmp_eq_u64 s[82:83], s[80:81]
    s_cbranch_scc1 L_hpoll_ok_4
    s_add_u32 s5, s5, 1
    s_cmp_lt_u32 s5, 131072
    s_cbranch_scc1 L_hpoll_3
L_hpoll_ok_4:
    s_add_u32 s71, s69, 0
    buffer_load_dwordx4 a[0:3], v184, s[16:19], s71 offen
    buffer_load_dwordx4 a[4:7], v185, s[16:19], s71 offen
    buffer_load_dwordx4 a[8:11], v186, s[16:19], s71 offen
    buffer_load_dwordx4 a[12:15], v187, s[16:19], s71 offen
    buffer_load_dwordx4 a[16:19], v184, s[16:19], s71 offen offset:1024
    buffer_load_dwordx4 a[20:23], v185, s[16:19], s71 offen offset:1024
    buffer_load_dwordx4 a[24:27], v186, s[16:19], s71 offen offset:1024
    buffer_load_dwordx4 a[28:31], v187, s[16:19], s71 offen offset:1024
    buffer_load_dwordx4 a[32:35], v184, s[16:19], s71 offen offset:2048
    buffer_load_dwordx4 a[36:39], v185, s[16:19], s71 offen offset:2048
    buffer_load_dwordx4 a[40:43], v186, s[16:19], s71 offen offset:2048
    buffer_load_dwordx4 a[44:47], v187, s[16:19], s71 offen offset:2048
    s_mov_b32 s77, 0
    s_branch L_phase2
L_qkv_b:
    s_sub_u32 s66, s74, 90
    s_waitcnt lgkmcnt(0)
    s_mov_b32 s16, s62
    s_mov_b32 s17, s63
    s_mov_b32 s18, 14680064
    s_mov_b32 s19, 0x20000
    s_mov_b32 s20, s54
    s_mov_b32 s21, s55
    s_mov_b32 s22, 1835008
    s_mov_b32 s23, 0x20000
    s_mov_b32 s24, s46
    s_mov_b32 s25, s47
    s_mov_b32 s26, 524288
    s_mov_b32 s27, 0x20000
    s_mov_b32 s28, s58
    s_mov_b32 s29, s59
    s_mov_b32 s30, 2097152
    s_mov_b32 s31, 0x20000
    s_lshl_b32 s4, s64, 12
    v_bfe_u32 v251, v254, 1, 2
    v_lshrrev_b32 v252, 4, v254
    v_xor_b32 v251, v251, v252
    v_lshlrev_b32 v251, 5, v251
    v_and_b32 v252, 1, v254
    v_lshl_add_u32 v251, v252, 4, v251
    s_lshl_b32 s74, s68, 7
    v_add_u32 v251, s74, v251
    v_lshrrev_b32 v252, 3, v254
    s_mul_i32 s74, s64, 458752
    v_lshl_add_u32 v253, v252, 10, v251
    v_add_u32 v240, s74, v253
    v_add_u32 v241, 7168, v240
    v_add_u32 v242, 14336, v240
    v_add_u32 v243, 21504, v240
    v_lshrrev_b32 v253, 2, v252
    v_lshlrev_b32 v253, 3, v253
    v_and_b32 v252, 3, v252
    v_add_u32 v252, v252, v253
    s_mul_i32 s74, s64, 131072
    v_lshl_add_u32 v253, v252, 10, v251
    v_add_u32 v244, s74, v253
    v_add_u32 v245, 15360, v244
    v_add_u32 v246, 2048, v244
    v_add_u32 v247, 17408, v244
    v_lshlrev_b32 v255, 7, v254
    s_mov_b32 s80, 0xffff0000
    s_mov_b32 s81, -1
    v_mov_b32 v253, 0x7f000000
    v_cndmask_b32 v255, v255, v253, s[80:81]
    s_lshr_b32 s74, s2, 3
    s_lshl_b32 s74, s74, 2
    s_add_u32 s74, s74, s64
    s_lshr_b32 s75, s74, 5
    s_and_b32 s74, s74, 31
    s_lshl_b32 s74, s74, 11
    s_mul_i32 s96, s75, 458752
    s_add_u32 s96, s96, s74
    s_lshl_b32 s33, s75, 17
    s_add_u32 s33, s33, s74
    s_mov_b32 s75, s96
    s_and_b32 s74, s2, 7
    s_cmp_ge_u32 s74, 7
    s_cselect_b32 s73, 7, 0
    s_sub_u32 s74, s74, s73
    s_lshl_b32 s73, s74, 16
    s_add_u32 s96, s75, s73
    s_add_u32 s74, s74, 1
    s_cmp_ge_u32 s74, 7
    s_cselect_b32 s73, 7, 0
    s_sub_u32 s74, s74, s73
    s_lshl_b32 s73, s74, 16
    s_add_u32 s97, s75, s73
    s_add_u32 s74, s74, 1
    s_cmp_ge_u32 s74, 7
    s_cselect_b32 s73, 7, 0
    s_sub_u32 s74, s74, s73
    s_lshl_b32 s73, s74, 16
    s_add_u32 s98, s75, s73
    s_add_u32 s74, s74, 1
    s_cmp_ge_u32 s74, 7
    s_cselect_b32 s73, 7, 0
    s_sub_u32 s74, s74, s73
    s_lshl_b32 s73, s74, 16
    s_add_u32 s99, s75, s73
    s_add_u32 s74, s74, 1
    s_cmp_ge_u32 s74, 7
    s_cselect_b32 s73, 7, 0
    s_sub_u32 s74, s74, s73
    s_lshl_b32 s73, s74, 16
    s_add_u32 s100, s75, s73
    s_add_u32 s74, s74, 1
    s_cmp_ge_u32 s74, 7
    s_cselect_b32 s73, 7, 0
    s_sub_u32 s74, s74, s73
    s_lshl_b32 s73, s74, 16
    s_add_u32 s101, s75, s73
    s_add_u32 s74, s74, 1
    s_cmp_ge_u32 s74, 7
    s_cselect_b32 s73, 7, 0
    s_sub_u32 s74, s74, s73
    s_lshl_b32 s73, s74, 16
    s_add_u32 s32, s75, s73
    s_add_u32 s34, s33, 65536
    v_bfe_u32 v140, v254, 2, 2
    v_lshrrev_b32 v141, 4, v254
    v_lshl_add_u32 v142, v141, 2, v140
    v_bfe_u32 v143, v142, 1, 2
    v_lshlrev_b32 v142, 7, v142
    v_and_b32 v140, 3, v254
    v_lshl_add_u32 v142, v140, 3, v142
    s_add_u32 s74, s4, 0
    v_add_u32 v142, s74, v142
    v_xor_b32 v140, 0, v143
    v_lshl_add_u32 v232, v140, 5, v142
    v_xor_b32 v140, 1, v143
    v_lshl_add_u32 v233, v140, 5, v142
    v_xor_b32 v140, 2, v143
    v_lshl_add_u32 v234, v140, 5, v142
    v_xor_b32 v140, 3, v143
    v_lshl_add_u32 v235, v140, 5, v142
    s_lshl_b32 s77, s66, 2
    s_add_u32 s77, s77, 13632896
    buffer_load_dword v239, off, s[16:19], s77 sc1
    s_mov_b32 s74, 13643776
    buffer_load_dword v251, off, s[16:19], s74 sc1
    s_waitcnt vmcnt(0)
    v_readfirstlane_b32 s38, v251
    s_nop 0
    s_add_u32 s38, s38, 0x9e3779b9
    s_cmp_lg_u32 s64, 0
    s_cbranch_scc1 L_skip_5
    v_mov_b32 v252, s38
    s_mov_b32 exec_lo, 1
    s_mov_b32 exec_hi, 0
    buffer_store_dword v252, off, s[16:19], s77 sc1
    s_mov_b32 exec_lo, -1
    s_mov_b32 exec_hi, -1
L_skip_5:
    buffer_load_dword v239, v255, s[20:23], s96 offen
    buffer_load_dword v239, v255, s[20:23], s97 offen
    buffer_load_dword v239, v255, s[20:23], s98 offen
    buffer_load_dword v239, v255, s[20:23], s99 offen
    buffer_load_dword v239, v255, s[20:23], s100 offen
    buffer_load_dword v239, v255, s[20:23], s101 offen
    buffer_load_dword v239, v255, s[20:23], s32 offen
    buffer_load_dword v239, v255, s[24:27], s33 offen
    buffer_load_dword v239, v255, s[24:27], s34 offen
    s_add_u32 m0, s4, 49152
    s_mov_b32 s72, 98304
    buffer_load_dwordx4 v240, s[20:23], s72 offen lds
    buffer_load_dwordx4 v241, s[20:23], s72 offen offset:1024 lds
    buffer_load_dwordx4 v242, s[20:23], s72 offen offset:2048 lds
    buffer_load_dwordx4 v243, s[20:23], s72 offen offset:3072 lds
    s_add_u32 m0, s4, 0
    s_mov_b32 s72, 0
    buffer_load_dwordx4 v240, s[20:23], s72 offen lds
    buffer_load_dwordx4 v241, s[20:23], s72 offen offset:1024 lds
    buffer_load_dwordx4 v242, s[20:23], s72 offen offset:2048 lds
    buffer_load_dwordx4 v243, s[20:23], s72 offen offset:3072 lds
    s_add_u32 m0, s4, 65536
    s_mov_b32 s72, 393216
    buffer_load_dwordx4 v240, s[20:23], s72 offen lds
    buffer_load_dwordx4 v241, s[20:23], s72 offen offset:1024 lds
    buffer_load_dwordx4 v242, s[20:23], s72 offen offset:2048 lds
    buffer_load_dwordx4 v243, s[20:23], s72 offen offset:3072 lds
    s_waitcnt vmcnt(8)
    ds_read_b64_tr_b16 a[144:145], v232 offset:49152
    ds_read_b64_tr_b16 a[146:147], v232 offset:51200
    ds_read_b64_tr_b16 a[148:149], v233 offset:49152
    ds_read_b64_tr_b16 a[150:151], v233 offset:51200
    ds_read_b64_tr_b16 a[152:153], v234 offset:49152
    ds_read_b64_tr_b16 a[154:155], v234 offset:51200
    ds_read_b64_tr_b16 a[156:157], v235 offset:49152
    ds_read_b64_tr_b16 a[158:159], v235 offset:51200
    s_waitcnt lgkmcnt(0)
    s_add_u32 m0, s4, 49152
    s_mov_b32 s72, 229376
    buffer_load_dwordx4 v240, s[20:23], s72 offen lds
    buffer_load_dwordx4 v241, s[20:23], s72 offen offset:1024 lds
    buffer_load_dwordx4 v242, s[20:23], s72 offen offset:2048 lds
    buffer_load_dwordx4 v243, s[20:23], s72 offen offset:3072 lds
    s_add_u32 m0, s4, 114688
    s_mov_b32 s72, 32768
    buffer_load_dwordx4 v244, s[24:27], s72 offen lds
    buffer_load_dwordx4 v245, s[24:27], s72 offen offset:1024 lds
    buffer_load_dwordx4 v246, s[24:27], s72 offen offset:2048 lds
    buffer_load_dwordx4 v247, s[24:27], s72 offen offset:3072 lds
    s_add_u32 m0, s4, 16384
    s_mov_b32 s72, 32768
    buffer_load_dwordx4 v240, s[20:23], s72 offen lds
    buffer_load_dwordx4 v241, s[20:23], s72 offen offset:1024 lds
    buffer_load_dwordx4 v242, s[20:23], s72 offen offset:2048 lds
    buffer_load_dwordx4 v243, s[20:23], s72 offen offset:3072 lds
    s_add_u32 m0, s4, 32768
    s_mov_b32 s72, 65536
    buffer_load_dwordx4 v240, s[20:23], s72 offen lds
    buffer_load_dwordx4 v241, s[20:23], s72 offen offset:1024 lds
    buffer_load_dwordx4 v242, s[20:23], s72 offen offset:2048 lds
    buffer_load_dwordx4 v243, s[20:23], s72 offen offset:3072 lds
    s_waitcnt vmcnt(20)
    ds_read_b64_tr_b16 a[96:97], v232
    ds_read_b64_tr_b16 a[98:99], v232 offset:2048
    ds_read_b64_tr_b16 a[100:101], v233
    ds_read_b64_tr_b16 a[102:103], v233 offset:2048
    ds_read_b64_tr_b16 a[104:105], v234
    ds_read_b64_tr_b16 a[106:107], v234 offset:2048
    ds_read_b64_tr_b16 a[108:109], v235
    ds_read_b64_tr_b16 a[110:111], v235 offset:2048
    s_waitcnt lgkmcnt(0)
    s_add_u32 m0, s4, 0
    s_mov_b32 s72, 131072
    buffer_load_dwordx4 v240, s[20:23], s72 offen lds
    buffer_load_dwordx4 v241, s[20:23], s72 offen offset:1024 lds
    buffer_load_dwordx4 v242, s[20:23], s72 offen offset:2048 lds
    buffer_load_dwordx4 v243, s[20:23], s72 offen offset:3072 lds
    s_add_u32 m0, s4, 81920
    s_mov_b32 s72, 425984
    buffer_load_dwordx4 v240, s[20:23], s72 offen lds
    buffer_load_dwordx4 v241, s[20:23], s72 offen offset:1024 lds
    buffer_load_dwordx4 v242, s[20:23], s72 offen offset:2048 lds
    buffer_load_dwordx4 v243, s[20:23], s72 offen offset:3072 lds
    s_waitcnt vmcnt(12)
    ds_read_b64_tr_b16 a[112:113], v232 offset:16384
    ds_read_b64_tr_b16 a[114:115], v232 offset:18432
    ds_read_b64_tr_b16 a[116:117], v233 offset:16384
    ds_read_b64_tr_b16 a[118:119], v233 offset:18432
    ds_read_b64_tr_b16 a[120:121], v234 offset:16384
    ds_read_b64_tr_b16 a[122:123], v234 offset:18432
    ds_read_b64_tr_b16 a[124:125], v235 offset:16384
    ds_read_b64_tr_b16 a[126:127], v235 offset:18432
    s_waitcnt lgkmcnt(0)
    s_add_u32 m0, s4, 16384
    s_mov_b32 s72, 163840
    buffer_load_dwordx4 v240, s[20:23], s72 offen lds
    buffer_load_dwordx4 v241, s[20:23], s72 offen offset:1024 lds
    buffer_load_dwordx4 v242, s[20:23], s72 offen offset:2048 lds
    buffer_load_dwordx4 v243, s[20:23], s72 offen offset:3072 lds
    s_waitcnt vmcnt(12)
    ds_read_b64_tr_b16 a[128:129], v232 offset:32768
    ds_read_b64_tr_b16 a[130:131], v232 offset:34816
    ds_read_b64_tr_b16 a[132:133], v233 offset:32768
    ds_read_b64_tr_b16 a[134:135], v233 offset:34816
    ds_read_b64_tr_b16 a[136:137], v234 offset:32768
    ds_read_b64_tr_b16 a[138:139], v234 offset:34816
    ds_read_b64_tr_b16 a[140:141], v235 offset:32768
    ds_read_b64_tr_b16 a[142:143], v235 offset:34816
    s_waitcnt lgkmcnt(0)
    s_add_u32 m0, s4, 32768
    s_mov_b32 s72, 196608
    buffer_load_dwordx4 v240, s[20:23], s72 offen lds
    buffer_load_dwordx4 v241, s[20:23], s72 offen offset:1024 lds
    buffer_load_dwordx4 v242, s[20:23], s72 offen offset:2048 lds
    buffer_load_dwordx4 v243, s[20:23], s72 offen offset:3072 lds
    ds_read_b64_tr_b16 a[208:209], v232 offset:49152
    ds_read_b64_tr_b16 a[210:211], v232 offset:51200
    ds_read_b64_tr_b16 a[212:213], v233 offset:49152
    ds_read_b64_tr_b16 a[214:215], v233 offset:51200
    ds_read_b64_tr_b16 a[216:217], v234 offset:49152
    ds_read_b64_tr_b16 a[218:219], v234 offset:51200
    ds_read_b64_tr_b16 a[220:221], v235 offset:49152
    ds_read_b64_tr_b16 a[222:223], v235 offset:51200
    s_add_u32 m0, s4, 98304
    s_mov_b32 s72, 0
    buffer_load_dwordx4 v244, s[24:27], s72 offen lds
    buffer_load_dwordx4 v245, s[24:27], s72 offen offset:1024 lds
    buffer_load_dwordx4 v246, s[24:27], s72 offen offset:2048 lds
    buffer_load_dwordx4 v247, s[24:27], s72 offen offset:3072 lds
    s_waitcnt vmcnt(16)
    ds_read_b64_tr_b16 a[160:161], v232
    ds_read_b64_tr_b16 a[162:163], v232 offset:2048
    ds_read_b64_tr_b16 a[164:165], v233
    ds_read_b64_tr_b16 a[166:167], v233 offset:2048
    ds_read_b64_tr_b16 a[168:169], v234
    ds_read_b64_tr_b16 a[170:171], v234 offset:2048
    ds_read_b64_tr_b16 a[172:173], v235
    s_waitcnt lgkmcnt(14)
    ds_read_b64_tr_b16 a[174:175], v235 offset:2048
    s_add_u32 m0, s4, 131072
    s_mov_b32 s72, 65536
    buffer_load_dwordx4 v244, s[24:27], s72 offen lds
    buffer_load_dwordx4 v245, s[24:27], s72 offen offset:1024 lds
    buffer_load_dwordx4 v246, s[24:27], s72 offen offset:2048 lds
    buffer_load_dwordx4 v247, s[24:27], s72 offen offset:3072 lds
    s_waitcnt lgkmcnt(8)
    s_add_u32 m0, s4, 49152
    s_mov_b32 s72, 360448
    buffer_load_dwordx4 v240, s[20:23], s72 offen lds
    buffer_load_dwordx4 v241, s[20:23], s72 offen offset:1024 lds
    buffer_load_dwordx4 v242, s[20:23], s72 offen offset:2048 lds
    buffer_load_dwordx4 v243, s[20:23], s72 offen offset:3072 lds
    s_waitcnt vmcnt(16)
    ds_read_b64_tr_b16 a[176:177], v232 offset:16384
    ds_read_b64_tr_b16 a[178:179], v232 offset:18432
    ds_read_b64_tr_b16 a[180:181], v233 offset:16384
    ds_read_b64_tr_b16 a[182:183], v233 offset:18432
    ds_read_b64_tr_b16 a[184:185], v234 offset:16384
    ds_read_b64_tr_b16 a[186:187], v234 offset:18432
    ds_read_b64_tr_b16 a[188:189], v235 offset:16384
    s_waitcnt lgkmcnt(14)
    ds_read_b64_tr_b16 a[190:191], v235 offset:18432
    s_waitcnt lgkmcnt(8)
    s_add_u32 m0, s4, 0
    s_mov_b32 s72, 262144
    buffer_load_dwordx4 v240, s[20:23], s72 offen lds
    buffer_load_dwordx4 v241, s[20:23], s72 offen offset:1024 lds
    buffer_load_dwordx4 v242, s[20:23], s72 offen offset:2048 lds
    buffer_load_dwordx4 v243, s[20:23], s72 offen offset:3072 lds
    s_waitcnt vmcnt(16)
    ds_read_b64_tr_b16 a[192:193], v232 offset:32768
    ds_read_b64_tr_b16 a[194:195], v232 offset:34816
    ds_read_b64_tr_b16 a[196:197], v233 offset:32768
    ds_read_b64_tr_b16 a[198:199], v233 offset:34816
    ds_read_b64_tr_b16 a[200:201], v234 offset:32768
    ds_read_b64_tr_b16 a[202:203], v234 offset:34816
    ds_read_b64_tr_b16 a[204:205], v235 offset:32768
    s_waitcnt lgkmcnt(14)
    ds_read_b64_tr_b16 a[206:207], v235 offset:34816
    s_waitcnt lgkmcnt(8)
    s_add_u32 m0, s4, 16384
    s_mov_b32 s72, 294912
    buffer_load_dwordx4 v240, s[20:23], s72 offen lds
    buffer_load_dwordx4 v241, s[20:23], s72 offen offset:1024 lds
    buffer_load_dwordx4 v242, s[20:23], s72 offen offset:2048 lds
    buffer_load_dwordx4 v243, s[20:23], s72 offen offset:3072 lds
    s_waitcnt lgkmcnt(0)
    s_add_u32 m0, s4, 32768
    s_mov_b32 s72, 327680
    buffer_load_dwordx4 v240, s[20:23], s72 offen lds
    buffer_load_dwordx4 v241, s[20:23], s72 offen offset:1024 lds
    buffer_load_dwordx4 v242, s[20:23], s72 offen offset:2048 lds
    buffer_load_dwordx4 v243, s[20:23], s72 offen offset:3072 lds
    s_add_u32 m0, s4, 147456
    s_mov_b32 s72, 98304
    buffer_load_dwordx4 v244, s[24:27], s72 offen lds
    buffer_load_dwordx4 v245, s[24:27], s72 offen offset:1024 lds
    buffer_load_dwordx4 v246, s[24:27], s72 offen offset:2048 lds
    buffer_load_dwordx4 v247, s[24:27], s72 offen offset:3072 lds
    v_lshlrev_b32 v184, 4, v254
    v_add_u32 v185, 57344, v184
    v_add_u32 v186, 114688, v184
    v_add_u32 v187, 172032, v184
    s_lshl_b32 s74, s67, 6
    s_mul_hi_u32 s75, s74, 0x1555556
    s_add_u32 s73, s74, 63
    s_mul_hi_u32 s73, s73, 0x1555556
    s_lshl_b32 s75, s75, 7
    s_lshl_b32 s73, s73, 7
    v_mov_b32 v140, s75
    v_mov_b32 v141, s73
    s_mov_b32 s80, 0xffff0000
    s_mov_b32 s81, 0
    v_cndmask_b32 v188, v140, v141, s[80:81]
    s_mul_hi_u32 s75, s74, 0x1745d18
    s_add_u32 s73, s74, 63
    s_mul_hi_u32 s73, s73, 0x1745d18
    s_lshl_b32 s75, s75, 7
    s_lshl_b32 s73, s73, 7
    s_add_u32 s75, s75, 4096
    s_add_u32 s73, s73, 4096
    v_mov_b32 v140, s75
    v_mov_b32 v141, s73
    s_mov_b32 s80, 0
    s_mov_b32 s81, 0x0000ffff
    v_cndmask_b32 v188, v188, v140, s[80:81]
    s_mov_b32 s81, 0xffff0000
    v_cndmask_b32 v188, v188, v141, s[80:81]
    v_and_b32 v140, 15, v254
    v_lshl_add_u32 v188, v140, 2, v188
    v_add_u32 v188, 13631488, v188
    s_mul_i32 s69, s67, 224
    s_mul_i32 s74, s64, 14
    s_add_u32 s69, s69, s74
    s_lshl_b32 s69, s69, 10
    s_lshl_b32 s70, s67, 6
    s_lshl_b32 s74, s64, 2
    s_add_u32 s70, s70, s74
    s_lshl_b32 s70, s70, 10
    s_add_u32 s70, s70, 8388608
    s_mul_i32 s74, s64, 7
    s_lshr_b32 s74, s74, 1
    s_lshl_b32 s80, 0x000f000f, s74
    s_mov_b32 s81, 0
    s_mov_b32 s5, 0
L_hpoll_6:
    buffer_load_dword v189, v188, s[16:19], 0 offen sc1
    s_waitcnt vmcnt(0)
    v_cmp_eq_u32 vcc, s38, v189
    s_nop 0
    s_and_b64 s[82:83], vcc, s[80:81]
    s_cmp_eq_u64 s[82:83], s[80:81]
    s_cbranch_scc1 L_hpoll_ok_7
    s_add_u32 s5, s5, 1
    s_cmp_lt_u32 s5, 131072
    s_cbranch_scc1 L_hpoll_6
L_hpoll_ok_7:
    s_add_u32 s71, s69, 0
    buffer_load_dwordx4 a[0:3], v184, s[16:19], s71 offen
    buffer_load_dwordx4 a[4:7], v185, s[16:19], s71 offen
    buffer_load_dwordx4 a[8:11], v186, s[16:19], s71 offen
    buffer_load_dwordx4 a[12:15], v187, s[16:19], s71 offen
    buffer_load_dwordx4 a[16:19], v184, s[16:19], s71 offen offset:1024
    buffer_load_dwordx4 a[20:23], v185, s[16:19], s71 offen offset:1024
    buffer_load_dwordx4 a[24:27], v186, s[16:19], s71 offen offset:1024
    buffer_load_dwordx4 a[28:31], v187, s[16:19], s71 offen offset:1024
    buffer_load_dwordx4 a[32:35], v184, s[16:19], s71 offen offset:2048
    buffer_load_dwordx4 a[36:39], v185, s[16:19], s71 offen offset:2048
    buffer_load_dwordx4 a[40:43], v186, s[16:19], s71 offen offset:2048
    buffer_load_dwordx4 a[44:47], v187, s[16:19], s71 offen offset:2048
    s_mov_b32 s77, 0
    v_writelane_b32 v238, s86, 0
    s_branch L_phase2
L_qkv_a:
    s_sub_u32 s65, s73, 5
    s_lshl_b32 s65, s65, 2
    s_lshr_b32 s74, s76, 3
    s_add_u32 s65, s65, s74
    s_and_b32 s66, s76, 7
L_qkv:
    s_mul_i32 s74, s64, 44
    s_mul_i32 s75, s65, 176
    v_lshrrev_b32 v212, 3, v254
    v_add_u32 v212, s74, v212
    v_and_b32 v213, 7, v254
    v_bfe_u32 v214, v212, 1, 3
    v_xor_b32 v213, v213, v214
    v_xor_b32 v214, 4, v213
    v_add_u32 v212, s75, v212
    v_lshlrev_b32 v212, 10, v212
    v_lshl_add_u32 v180, v213, 4, v212
    v_lshl_add_u32 v181, v214, 4, v212
    v_add_u32 v181, 7168, v181
    v_lshl_add_u32 v182, v213, 4, v212
    v_add_u32 v182, 14336, v182
    v_lshl_add_u32 v183, v214, 4, v212
    v_add_u32 v183, 21504, v183
    v_lshl_add_u32 v184, v213, 4, v212
    v_add_u32 v184, 32768, v184
    v_lshl_add_u32 v185, v214, 4, v212
    v_add_u32 v185, 39936, v185
    s_mul_i32 s69, s64, 5632
    s_lshl_b32 s74, s64, 4
    s_lshl_b32 s75, s66, 7
    s_mov_b32 s73, 3072
    v_lshrrev_b32 v212, 4, v254
    v_bfe_u32 v213, v254, 1, 3
    v_xor_b32 v213, v213, v212
    v_add_u32 v212, s74, v212
    v_mul_lo_u32 v212, v212, s73
    v_and_b32 v214, 1, v254
    v_lshlrev_b32 v214, 4, v214
    v_add3_u32 v212, v212, v214, s75
    v_lshrrev_b32 v214, 2, v213
    v_and_b32 v213, 3, v213
    v_lshl_add_u32 v212, v213, 5, v212
    v_lshlrev_b32 v214, 10, v214
    v_xor_b32 v215, 1024, v214
    v_add_u32 v186, v212, v214
    v_add_u32 v186, 1024, v186
    v_add_u32 v187, v212, v214
    v_add_u32 v187, 12288, v187
    v_add_u32 v188, v212, v215
    v_add_u32 v188, 23552, v188
    v_add_u32 v189, v212, v215
    v_add_u32 v189, 34816, v189
    s_lshl_b32 s70, s64, 12
    s_add_u32 s70, s70, 73728
    v_lshrrev_b32 v212, 3, v254
    v_bfe_u32 v213, v254, 1, 2
    v_bfe_u32 v214, v254, 4, 1
    v_xor_b32 v213, v213, v214
    v_add_u32 v212, s74, v212
    v_mul_lo_u32 v212, v212, s73
    v_and_b32 v214, 1, v254
    v_lshlrev_b32 v214, 4, v214
    v_add3_u32 v212, v212, v214, s75
    v_lshl_add_u32 v190, v213, 5, v212
    v_xor_b32 v213, 2, v213
    v_lshl_add_u32 v191, v213, 5, v212
    v_add_u32 v191, 23552, v191
    s_lshl_b32 s71, s64, 11
    s_add_u32 s71, s71, 122880
    s_waitcnt lgkmcnt(0)
    s_mov_b32 s8, s40
    s_mov_b32 s9, s41
    s_mov_b32 s10, 2097152
    s_mov_b32 s11, 0x20000
    s_mov_b32 s12, s42
    s_mov_b32 s13, s43
    s_mov_b32 s14, 1572864
    s_mov_b32 s15, 0x20000
    s_add_u32 s74, s39, 0
    s_and_b32 s74, s74, 7
    s_mul_i32 s40, s74, 128
    s_add_u32 s74, s39, 0
    s_and_b32 s74, s74, 7
    s_mul_i32 s48, s74, 196608
    s_add_u32 s74, s39, 1
    s_and_b32 s74, s74, 7
    s_mul_i32 s41, s74, 128
    s_add_u32 s74, s39, 1
    s_and_b32 s74, s74, 7
    s_mul_i32 s49, s74, 196608
    s_add_u32 m0, s69, 0
    s_nop 0
    buffer_load_dwordx4 v180, s[8:11], s40 offen lds
    buffer_load_dwordx4 v181, s[8:11], s40 offen offset:1024 lds
    buffer_load_dwordx4 v182, s[8:11], s40 offen offset:2048 lds
    buffer_load_dwordx4 v183, s[8:11], s40 offen offset:3072 lds
    s_add_u32 m0, s69, 4096
    s_nop 0
    buffer_load_dwordx4 v184, s[8:11], s40 offen lds
    s_mov_b32 exec_hi, 0
    buffer_load_dwordx4 v185, s[8:11], s40 offen offset:1024 lds
    s_mov_b32 exec_hi, -1
    s_add_u32 m0, s70, 0
    s_nop 0
    buffer_load_dwordx4 v186, s[12:15], s48 offen lds
    buffer_load_dwordx4 v187, s[12:15], s48 offen offset:1024 lds
    buffer_load_dwordx4 v188, s[12:15], s48 offen offset:2048 lds
    buffer_load_dwordx4 v189, s[12:15], s48 offen offset:3072 lds
    s_add_u32 m0, s71, 0
    s_nop 0
    buffer_load_dwordx4 v190, s[12:15], s48 offen lds
    buffer_load_dwordx4 v191, s[12:15], s48 offen offset:1024 lds
    s_add_u32 m0, s69, 22528
    s_nop 0
    buffer_load_dwordx4 v180, s[8:11], s41 offen lds
    buffer_load_dwordx4 v181, s[8:11], s41 offen offset:1024 lds
    buffer_load_dwordx4 v182, s[8:11], s41 offen offset:2048 lds
    buffer_load_dwordx4 v183, s[8:11], s41 offen offset:3072 lds
    s_add_u32 m0, s69, 26624
    s_nop 0
    buffer_load_dwordx4 v184, s[8:11], s41 offen lds
    s_mov_b32 exec_hi, 0
    buffer_load_dwordx4 v185, s[8:11], s41 offen offset:1024 lds
    s_mov_b32 exec_hi, -1
    s_add_u32 m0, s70, 16384
    s_nop 0
    buffer_load_dwordx4 v186, s[12:15], s49 offen lds
    buffer_load_dwordx4 v187, s[12:15], s49 offen offset:1024 lds
    buffer_load_dwordx4 v188, s[12:15], s49 offen offset:2048 lds
    buffer_load_dwordx4 v189, s[12:15], s49 offen offset:3072 lds
    s_add_u32 m0, s71, 8192
    s_nop 0
    buffer_load_dwordx4 v190, s[12:15], s49 offen lds
    buffer_load_dwordx4 v191, s[12:15], s49 offen offset:1024 lds
    s_lshr_b32 s74, s2, 3
    s_lshl_b32 s74, s74, 2
    s_add_u32 s74, s74, s64
    s_mul_i32 s75, s39, 192
    s_add_u32 s75, s75, 576
    s_mul_i32 s74, s74, 8
    s_add_u32 s75, s75, s74
    v_add_u32 v212, s75, v254
    v_subrev_u32 v213, 1536, v212
    v_min_u32 v212, v212, v213
    s_sub_u32 s75, 384, s42
    s_and_b32 s75, s75, 896
    v_lshlrev_b32 v212, 10, v212
    s_mov_b32 exec_lo, 255
    s_mov_b32 exec_hi, 0
    buffer_load_dword v239, v212, s[12:15], s75 offen
    s_mov_b32 exec_lo, -1
    s_mov_b32 exec_hi, -1
    s_mov_b32 s88, s56
    s_mov_b32 s89, s57
    s_mov_b32 s90, 1024
    s_mov_b32 s91, 0x20000
    s_mov_b32 s92, s44
    s_mov_b32 s93, s45
    s_mov_b32 s94, 16384
    s_mov_b32 s95, 0x20000
    s_mov_b32 s16, s62
    s_mov_b32 s17, s63
    s_mov_b32 s18, 14680064
    s_mov_b32 s19, 0x20000
    s_mov_b32 s20, s54
    s_mov_b32 s21, s55
    s_mov_b32 s22, 1835008
    s_mov_b32 s23, 0x20000
    s_mov_b32 s24, s46
    s_mov_b32 s25, s47
    s_mov_b32 s26, 524288
    s_mov_b32 s27, 0x20000
    s_mov_b32 s28, s58
    s_mov_b32 s29, s59
    s_mov_b32 s30, 2097152
    s_mov_b32 s31, 0x20000
    s_add_u32 s74, s39, 2
    s_and_b32 s74, s74, 7
    s_mul_i32 s42, s74, 128
    s_add_u32 s74, s39, 2
    s_and_b32 s74, s74, 7
    s_mul_i32 s50, s74, 196608
    s_add_u32 s74, s39, 3
    s_and_b32 s74, s74, 7
    s_mul_i32 s43, s74, 128
    s_add_u32 s74, s39, 3
    s_and_b32 s74, s74, 7
    s_mul_i32 s51, s74, 196608
    s_add_u32 s74, s39, 4
    s_and_b32 s74, s74, 7
    s_mul_i32 s44, s74, 128
    s_add_u32 s74, s39, 4
    s_and_b32 s74, s74, 7
    s_mul_i32 s52, s74, 196608
    s_add_u32 s74, s39, 5
    s_and_b32 s74, s74, 7
    s_mul_i32 s45, s74, 128
    s_add_u32 s74, s39, 5
    s_and_b32 s74, s74, 7
    s_mul_i32 s53, s74, 196608
    s_add_u32 s74, s39, 6
    s_and_b32 s74, s74, 7
    s_mul_i32 s46, s74, 128
    s_add_u32 s74, s39, 6
    s_and_b32 s74, s74, 7
    s_mul_i32 s54, s74, 196608
    s_add_u32 s74, s39, 7
    s_and_b32 s74, s74, 7
    s_mul_i32 s47, s74, 128
    s_add_u32 s74, s39, 7
    s_and_b32 s74, s74, 7
    s_mul_i32 s55, s74, 196608
    s_lshl_b32 s77, s65, 7
    s_lshl_b32 s74, s66, 2
    s_add_u32 s77, s77, s74
    s_add_u32 s77, s77, 13635584
    s_lshl_b32 s76, s66, 7
    s_lshl_b32 s74, s65, 2
    s_add_u32 s76, s76, s74
    s_add_u32 s76, s76, 13639680
    v_and_b32 v212, 15, v254
    v_lshrrev_b32 v213, 4, v254
    v_lshrrev_b32 v214, 1, v212
    v_add_u32 v215, 0, v213
    v_xor_b32 v215, v215, v214
    v_lshlrev_b32 v215, 4, v215
    v_lshl_add_u32 v192, v212, 7, v215
    v_add_u32 v193, 65536, v192
    v_add_u32 v215, 4, v213
    v_xor_b32 v215, v215, v214
    v_lshlrev_b32 v215, 4, v215
    v_lshl_add_u32 v194, v212, 7, v215
    v_add_u32 v195, 65536, v194
    v_bfe_u32 v212, v254, 2, 2
    v_lshl_add_u32 v214, v213, 3, v212
    v_and_b32 v213, 1, v213
    v_lshl_or_b32 v215, v213, 2, v212
    v_and_b32 v216, 3, v254
    v_xor_b32 v217, s64, v215
    v_lshlrev_b32 v217, 5, v217
    v_lshl_add_u32 v217, v214, 8, v217
    v_lshl_add_u32 v196, v216, 3, v217
    v_add_u32 v196, 73728, v196
    v_xor_b32 v217, 128, v217
    v_and_b32 v199, 1, v254
    v_lshl_add_u32 v217, v199, 4, v217
    v_bfe_u32 v199, v254, 1, 1
    v_lshl_add_u32 v217, v199, 3, v217
    v_add_u32 v197, 73728, v217
    v_lshrrev_b32 v215, 1, v212
    v_lshl_or_b32 v215, v213, 1, v215
    v_xor_b32 v217, s64, v215
    v_lshlrev_b32 v217, 5, v217
    v_lshl_add_u32 v217, v214, 7, v217
    v_lshl_add_u32 v217, v216, 3, v217
    v_add_u32 v198, 122880, v217
    s_mov_b32 s78, 0x3fb8aa3b
    s_mov_b32 s79, 0xbfb8aa3b
    s_mul_i32 s74, s65, 11
    s_sub_u32 s3, 128, s74
    s_min_u32 s3, s3, 11
    s_lshl_b32 s4, s64, 12
    v_bfe_u32 v251, v254, 1, 2
    v_lshrrev_b32 v252, 4, v254
    v_xor_b32 v251, v251, v252
    v_lshlrev_b32 v251, 5, v251
    v_and_b32 v252, 1, v254
    v_lshl_add_u32 v251, v252, 4, v251
    s_lshl_b32 s74, s68, 7
    v_add_u32 v251, s74, v251
    v_lshrrev_b32 v252, 3, v254
    s_mul_i32 s74, s64, 458752
    v_lshl_add_u32 v253, v252, 10, v251
    v_add_u32 v240, s74, v253
    v_add_u32 v241, 7168, v240
    v_add_u32 v242, 14336, v240
    v_add_u32 v243, 21504, v240
    v_lshrrev_b32 v253, 2, v252
    v_lshlrev_b32 v253, 3, v253
    v_and_b32 v252, 3, v252
    v_add_u32 v252, v252, v253
    s_mul_i32 s74, s64, 131072
    v_lshl_add_u32 v253, v252, 10, v251
    v_add_u32 v244, s74, v253
    v_add_u32 v245, 15360, v244
    v_add_u32 v246, 2048, v244
    v_add_u32 v247, 17408, v244
    v_lshlrev_b32 v255, 7, v254
    s_mov_b32 s80, 0xffff0000
    s_mov_b32 s81, -1
    v_mov_b32 v253, 0x7f000000
    v_cndmask_b32 v255, v255, v253, s[80:81]
    s_lshr_b32 s74, s2, 3
    s_lshl_b32 s74, s74, 2
    s_add_u32 s74, s74, s64
    s_lshr_b32 s75, s74, 5
    s_and_b32 s74, s74, 31
    s_lshl_b32 s74, s74, 11
    s_mul_i32 s96, s75, 458752
    s_add_u32 s96, s96, s74
    s_lshl_b32 s33, s75, 17
    s_add_u32 s33, s33, s74
    s_mov_b32 s75, s96
    s_and_b32 s74, s2, 7
    s_cmp_ge_u32 s74, 7
    s_cselect_b32 s73, 7, 0
    s_sub_u32 s74, s74, s73
    s_lshl_b32 s73, s74, 16
    s_add_u32 s96, s75, s73
    s_add_u32 s74, s74, 1
    s_cmp_ge_u32 s74, 7
    s_cselect_b32 s73, 7, 0
    s_sub_u32 s74, s74, s73
    s_lshl_b32 s73, s74, 16
    s_add_u32 s97, s75, s73
    s_add_u32 s74, s74, 1
    s_cmp_ge_u32 s74, 7
    s_cselect_b32 s73, 7, 0
    s_sub_u32 s74, s74, s73
    s_lshl_b32 s73, s74, 16
    s_add_u32 s98, s75, s73
    s_add_u32 s74, s74, 1
    s_cmp_ge_u32 s74, 7
    s_cselect_b32 s73, 7, 0
    s_sub_u32 s74, s74, s73
    s_lshl_b32 s73, s74, 16
    s_add_u32 s99, s75, s73
    s_add_u32 s74, s74, 1
    s_cmp_ge_u32 s74, 7
    s_cselect_b32 s73, 7, 0
    s_sub_u32 s74, s74, s73
    s_lshl_b32 s73, s74, 16
    s_add_u32 s100, s75, s73
    s_add_u32 s74, s74, 1
    s_cmp_ge_u32 s74, 7
    s_cselect_b32 s73, 7, 0
    s_sub_u32 s74, s74, s73
    s_lshl_b32 s73, s74, 16
    s_add_u32 s101, s75, s73
    s_add_u32 s74, s74, 1
    s_cmp_ge_u32 s74, 7
    s_cselect_b32 s73, 7, 0
    s_sub_u32 s74, s74, s73
    s_lshl_b32 s73, s74, 16
    s_add_u32 s32, s75, s73
    s_add_u32 s34, s33, 65536
    v_bfe_u32 v212, v254, 2, 2
    v_lshrrev_b32 v213, 4, v254
    v_lshl_add_u32 v214, v213, 2, v212
    v_bfe_u32 v215, v214, 1, 2
    v_lshlrev_b32 v214, 7, v214
    v_and_b32 v212, 3, v254
    v_lshl_add_u32 v214, v212, 3, v214
    s_add_u32 s74, s4, 0
    v_add_u32 v214, s74, v214
    v_xor_b32 v212, 0, v215
    v_lshl_add_u32 v232, v212, 5, v214
    v_xor_b32 v212, 1, v215
    v_lshl_add_u32 v233, v212, 5, v214
    v_xor_b32 v212, 2, v215
    v_lshl_add_u32 v234, v212, 5, v214
    v_xor_b32 v212, 3, v215
    v_lshl_add_u32 v235, v212, 5, v214
    s_waitcnt vmcnt(13)
    s_barrier
    ds_read_b64_tr_b16 a[32:33], v196
    ds_read_b64_tr_b16 a[34:35], v196 offset:1024
    ds_read_b64_tr_b16 a[36:37], v197
    ds_read_b64_tr_b16 a[38:39], v197 offset:1024
    ds_read_b64_tr_b16 a[40:41], v198
    ds_read_b64_tr_b16 a[42:43], v198 offset:512
    ds_read_b128 a[0:3], v192
    ds_read_b128 a[4:7], v192 offset:2048
    ds_read_b128 a[8:11], v192 offset:4096
    ds_read_b128 a[12:15], v192 offset:6144
    ds_read_b128 a[16:19], v192 offset:8192
    s_waitcnt lgkmcnt(4)
    v_mfma_f32_16x16x32_bf16 v[0:3], a[32:35], a[0:3], 0
    ds_read_b128 a[20:23], v192 offset:10240
    s_add_u32 m0, s69, 45056
    v_mfma_f32_16x16x32_bf16 v[48:51], a[0:3], a[36:39], 0
    buffer_load_dwordx4 v180, s[8:11], s42 offen lds
    v_mfma_f32_16x16x32_bf16 v[96:99], a[40:43], a[0:3], 0
    s_waitcnt lgkmcnt(4)
    v_mfma_f32_16x16x32_bf16 v[4:7], a[32:35], a[4:7], 0
    ds_read_b128 a[24:27], v192 offset:12288
    v_mfma_f32_16x16x32_bf16 v[52:55], a[4:7], a[36:39], 0
    v_mfma_f32_16x16x32_bf16 v[100:103], a[40:43], a[4:7], 0
    s_waitcnt lgkmcnt(4)
    v_mfma_f32_16x16x32_bf16 v[8:11], a[32:35], a[8:11], 0
    ds_read_b128 a[0:3], v192 offset:14336
    v_mfma_f32_16x16x32_bf16 v[56:59], a[8:11], a[36:39], 0
    buffer_load_dwordx4 v181, s[8:11], s42 offen offset:1024 lds
    v_mfma_f32_16x16x32_bf16 v[104:107], a[40:43], a[8:11], 0
    s_waitcnt lgkmcnt(4)
    v_mfma_f32_16x16x32_bf16 v[12:15], a[32:35], a[12:15], 0
    ds_read_b128 a[4:7], v192 offset:16384
    v_mfma_f32_16x16x32_bf16 v[60:63], a[12:15], a[36:39], 0
    buffer_load_dwordx4 v182, s[8:11], s42 offen offset:2048 lds
    v_mfma_f32_16x16x32_bf16 v[108:111], a[40:43], a[12:15], 0
    ds_read_b64_tr_b16 a[44:45], v196 offset:8192
    s_waitcnt lgkmcnt(5)
    v_mfma_f32_16x16x32_bf16 v[16:19], a[32:35], a[16:19], 0
    ds_read_b128 a[8:11], v192 offset:18432
    v_mfma_f32_16x16x32_bf16 v[64:67], a[16:19], a[36:39], 0
    v_mfma_f32_16x16x32_bf16 v[112:115], a[40:43], a[16:19], 0
    ds_read_b64_tr_b16 a[46:47], v196 offset:9216
    s_waitcnt lgkmcnt(6)
    v_mfma_f32_16x16x32_bf16 v[20:23], a[32:35], a[20:23], 0
    ds_read_b128 a[12:15], v192 offset:20480
    v_mfma_f32_16x16x32_bf16 v[68:71], a[20:23], a[36:39], 0
    buffer_load_dwordx4 v183, s[8:11], s42 offen offset:3072 lds
    v_mfma_f32_16x16x32_bf16 v[116:119], a[40:43], a[20:23], 0
    ds_read_b64_tr_b16 a[48:49], v197 offset:8192
    s_waitcnt lgkmcnt(7)
    v_mfma_f32_16x16x32_bf16 v[24:27], a[32:35], a[24:27], 0
    ds_read_b128 a[16:19], v194
    s_add_u32 m0, s69, 49152
    v_mfma_f32_16x16x32_bf16 v[72:75], a[24:27], a[36:39], 0
    buffer_load_dwordx4 v184, s[8:11], s42 offen lds
    v_mfma_f32_16x16x32_bf16 v[120:123], a[40:43], a[24:27], 0
    ds_read_b64_tr_b16 a[50:51], v197 offset:9216
    s_waitcnt lgkmcnt(8)
    v_mfma_f32_16x16x32_bf16 v[28:31], a[32:35], a[0:3], 0
    ds_read_b128 a[20:23], v194 offset:2048
    v_mfma_f32_16x16x32_bf16 v[76:79], a[0:3], a[36:39], 0
    v_mfma_f32_16x16x32_bf16 v[124:127], a[40:43], a[0:3], 0
    ds_read_b64_tr_b16 a[52:53], v198 offset:4096
    s_waitcnt lgkmcnt(9)
    v_mfma_f32_16x16x32_bf16 v[32:35], a[32:35], a[4:7], 0
    ds_read_b128 a[24:27], v194 offset:4096
    v_mfma_f32_16x16x32_bf16 v[80:83], a[4:7], a[36:39], 0
    s_mov_b32 exec_hi, 0
    buffer_load_dwordx4 v185, s[8:11], s42 offen offset:1024 lds
    s_mov_b32 exec_hi, -1
    v_mfma_f32_16x16x32_bf16 v[128:131], a[40:43], a[4:7], 0
    ds_read_b64_tr_b16 a[54:55], v198 offset:4608
    s_waitcnt lgkmcnt(9)
    v_mfma_f32_16x16x32_bf16 v[36:39], a[32:35], a[8:11], 0
    ds_read_b128 a[0:3], v194 offset:6144
    s_add_u32 m0, s70, 32768
    v_mfma_f32_16x16x32_bf16 v[84:87], a[8:11], a[36:39], 0
    buffer_load_dwordx4 v186, s[12:15], s50 offen lds
    v_mfma_f32_16x16x32_bf16 v[132:135], a[40:43], a[8:11], 0
    s_waitcnt lgkmcnt(8)
    v_mfma_f32_16x16x32_bf16 v[40:43], a[32:35], a[12:15], 0
    ds_read_b128 a[4:7], v194 offset:8192
    v_mfma_f32_16x16x32_bf16 v[88:91], a[12:15], a[36:39], 0
    buffer_load_dwordx4 v187, s[12:15], s50 offen offset:1024 lds
    v_mfma_f32_16x16x32_bf16 v[136:139], a[40:43], a[12:15], 0
    s_waitcnt lgkmcnt(7)
    v_mfma_f32_16x16x32_bf16 v[0:3], a[44:47], a[16:19], v[0:3]
    ds_read_b128 a[8:11], v194 offset:10240
    s_waitcnt lgkmcnt(7)
    v_mfma_f32_16x16x32_bf16 v[48:51], a[16:19], a[48:51], v[48:51]
    buffer_load_dwordx4 v188, s[12:15], s50 offen offset:2048 lds
    s_waitcnt lgkmcnt(3)
    v_mfma_f32_16x16x32_bf16 v[96:99], a[52:55], a[16:19], v[96:99]
    v_mfma_f32_16x16x32_bf16 v[4:7], a[44:47], a[20:23], v[4:7]
    ds_read_b128 a[12:15], v194 offset:12288
    v_mfma_f32_16x16x32_bf16 v[52:55], a[20:23], a[48:51], v[52:55]
    v_mfma_f32_16x16x32_bf16 v[100:103], a[52:55], a[20:23], v[100:103]
    v_mfma_f32_16x16x32_bf16 v[8:11], a[44:47], a[24:27], v[8:11]
    ds_read_b128 a[16:19], v194 offset:14336
    v_mfma_f32_16x16x32_bf16 v[56:59], a[24:27], a[48:51], v[56:59]
    buffer_load_dwordx4 v189, s[12:15], s50 offen offset:3072 lds
    v_mfma_f32_16x16x32_bf16 v[104:107], a[52:55], a[24:27], v[104:107]
    s_waitcnt lgkmcnt(4)
    v_mfma_f32_16x16x32_bf16 v[12:15], a[44:47], a[0:3], v[12:15]
    ds_read_b128 a[20:23], v194 offset:16384
    v_mfma_f32_16x16x32_bf16 v[60:63], a[0:3], a[48:51], v[60:63]
    v_mfma_f32_16x16x32_bf16 v[108:111], a[52:55], a[0:3], v[108:111]
    s_waitcnt lgkmcnt(4)
    v_mfma_f32_16x16x32_bf16 v[16:19], a[44:47], a[4:7], v[16:19]
    ds_read_b128 a[24:27], v194 offset:18432
    s_add_u32 m0, s71, 16384
    v_mfma_f32_16x16x32_bf16 v[64:67], a[4:7], a[48:51], v[64:67]
    buffer_load_dwordx4 v190, s[12:15], s50 offen lds
    v_mfma_f32_16x16x32_bf16 v[112:115], a[52:55], a[4:7], v[112:115]
    s_waitcnt lgkmcnt(4)
    v_mfma_f32_16x16x32_bf16 v[20:23], a[44:47], a[8:11], v[20:23]
    ds_read_b128 a[0:3], v194 offset:20480
    v_mfma_f32_16x16x32_bf16 v[68:71], a[8:11], a[48:51], v[68:71]
    buffer_load_dwordx4 v191, s[12:15], s50 offen offset:1024 lds
    v_mfma_f32_16x16x32_bf16 v[116:119], a[52:55], a[8:11], v[116:119]
    s_waitcnt lgkmcnt(4)
    v_mfma_f32_16x16x32_bf16 v[24:27], a[44:47], a[12:15], v[24:27]
    v_mfma_f32_16x16x32_bf16 v[72:75], a[12:15], a[48:51], v[72:75]
    s_waitcnt vmcnt(13)
    s_waitcnt lgkmcnt(0)
    s_barrier
    v_mfma_f32_16x16x32_bf16 v[120:123], a[52:55], a[12:15], v[120:123]
    ds_read_b64_tr_b16 a[32:33], v196 offset:16384
    v_mfma_f32_16x16x32_bf16 v[28:31], a[44:47], a[16:19], v[28:31]
    ds_read_b64_tr_b16 a[34:35], v196 offset:17408
    v_mfma_f32_16x16x32_bf16 v[76:79], a[16:19], a[48:51], v[76:79]
    ds_read_b64_tr_b16 a[36:37], v197 offset:16384
    v_mfma_f32_16x16x32_bf16 v[124:127], a[52:55], a[16:19], v[124:127]
    ds_read_b64_tr_b16 a[38:39], v197 offset:17408
    v_mfma_f32_16x16x32_bf16 v[32:35], a[44:47], a[20:23], v[32:35]
    ds_read_b64_tr_b16 a[40:41], v198 offset:8192
    v_mfma_f32_16x16x32_bf16 v[80:83], a[20:23], a[48:51], v[80:83]
    ds_read_b64_tr_b16 a[42:43], v198 offset:8704
    v_mfma_f32_16x16x32_bf16 v[128:131], a[52:55], a[20:23], v[128:131]
    ds_read_b128 a[4:7], v192 offset:22528
    v_mfma_f32_16x16x32_bf16 v[36:39], a[44:47], a[24:27], v[36:39]
    ds_read_b128 a[8:11], v192 offset:24576
    v_mfma_f32_16x16x32_bf16 v[84:87], a[24:27], a[48:51], v[84:87]
    ds_read_b128 a[12:15], v192 offset:26624
    v_mfma_f32_16x16x32_bf16 v[132:135], a[52:55], a[24:27], v[132:135]
    ds_read_b128 a[16:19], v192 offset:28672
    v_mfma_f32_16x16x32_bf16 v[40:43], a[44:47], a[0:3], v[40:43]
    ds_read_b128 a[20:23], v192 offset:30720
    s_add_u32 m0, s69, 0
    v_mfma_f32_16x16x32_bf16 v[88:91], a[0:3], a[48:51], v[88:91]
    buffer_load_dwordx4 v180, s[8:11], s43 offen lds
    v_mfma_f32_16x16x32_bf16 v[136:139], a[52:55], a[0:3], v[136:139]
    s_waitcnt lgkmcnt(4)
    v_mfma_f32_16x16x32_bf16 v[0:3], a[32:35], a[4:7], v[0:3]
    ds_read_b128 a[24:27], v192 offset:32768
    v_mfma_f32_16x16x32_bf16 v[48:51], a[4:7], a[36:39], v[48:51]
    buffer_load_dwordx4 v181, s[8:11], s43 offen offset:1024 lds
    v_mfma_f32_16x16x32_bf16 v[96:99], a[40:43], a[4:7], v[96:99]
    s_waitcnt lgkmcnt(4)
    v_mfma_f32_16x16x32_bf16 v[4:7], a[32:35], a[8:11], v[4:7]
    ds_read_b128 a[0:3], v192 offset:34816
    v_mfma_f32_16x16x32_bf16 v[52:55], a[8:11], a[36:39], v[52:55]
    v_mfma_f32_16x16x32_bf16 v[100:103], a[40:43], a[8:11], v[100:103]
    s_waitcnt lgkmcnt(4)
    v_mfma_f32_16x16x32_bf16 v[8:11], a[32:35], a[12:15], v[8:11]
    ds_read_b128 a[4:7], v192 offset:36864
    v_mfma_f32_16x16x32_bf16 v[56:59], a[12:15], a[36:39], v[56:59]
    buffer_load_dwordx4 v182, s[8:11], s43 offen offset:2048 lds
    v_mfma_f32_16x16x32_bf16 v[104:107], a[40:43], a[12:15], v[104:107]
    s_waitcnt lgkmcnt(4)
    v_mfma_f32_16x16x32_bf16 v[12:15], a[32:35], a[16:19], v[12:15]
    ds_read_b128 a[8:11], v192 offset:38912
    v_mfma_f32_16x16x32_bf16 v[60:63], a[16:19], a[36:39], v[60:63]
    buffer_load_dwordx4 v183, s[8:11], s43 offen offset:3072 lds
    v_mfma_f32_16x16x32_bf16 v[108:111], a[40:43], a[16:19], v[108:111]
    ds_read_b64_tr_b16 a[44:45], v196 offset:24576
    s_waitcnt lgkmcnt(5)
    v_mfma_f32_16x16x32_bf16 v[16:19], a[32:35], a[20:23], v[16:19]
    ds_read_b128 a[12:15], v192 offset:40960
    v_mfma_f32_16x16x32_bf16 v[64:67], a[20:23], a[36:39], v[64:67]
    v_mfma_f32_16x16x32_bf16 v[112:115], a[40:43], a[20:23], v[112:115]
    ds_read_b64_tr_b16 a[46:47], v196 offset:25600
    s_waitcnt lgkmcnt(6)
    v_mfma_f32_16x16x32_bf16 v[20:23], a[32:35], a[24:27], v[20:23]
    ds_read_b128 a[16:19], v192 offset:43008
    s_add_u32 m0, s69, 4096
    v_mfma_f32_16x16x32_bf16 v[68:71], a[24:27], a[36:39], v[68:71]
    buffer_load_dwordx4 v184, s[8:11], s43 offen lds
    v_mfma_f32_16x16x32_bf16 v[116:119], a[40:43], a[24:27], v[116:119]
    ds_read_b64_tr_b16 a[48:49], v197 offset:24576
    s_waitcnt lgkmcnt(7)
    v_mfma_f32_16x16x32_bf16 v[24:27], a[32:35], a[0:3], v[24:27]
    ds_read_b128 a[20:23], v194 offset:22528
    v_mfma_f32_16x16x32_bf16 v[72:75], a[0:3], a[36:39], v[72:75]
    s_mov_b32 exec_hi, 0
    buffer_load_dwordx4 v185, s[8:11], s43 offen offset:1024 lds
    s_mov_b32 exec_hi, -1
    v_mfma_f32_16x16x32_bf16 v[120:123], a[40:43], a[0:3], v[120:123]
    ds_read_b64_tr_b16 a[50:51], v197 offset:25600
    s_waitcnt lgkmcnt(8)
    v_mfma_f32_16x16x32_bf16 v[28:31], a[32:35], a[4:7], v[28:31]
    ds_read_b128 a[24:27], v194 offset:24576
    v_mfma_f32_16x16x32_bf16 v[76:79], a[4:7], a[36:39], v[76:79]
    v_mfma_f32_16x16x32_bf16 v[124:127], a[40:43], a[4:7], v[124:127]
    ds_read_b64_tr_b16 a[52:53], v198 offset:12288
    s_waitcnt lgkmcnt(9)
    v_mfma_f32_16x16x32_bf16 v[32:35], a[32:35], a[8:11], v[32:35]
    ds_read_b128 a[0:3], v194 offset:26624
    s_add_u32 m0, s70, 0
    v_mfma_f32_16x16x32_bf16 v[80:83], a[8:11], a[36:39], v[80:83]
    buffer_load_dwordx4 v186, s[12:15], s51 offen lds
    v_mfma_f32_16x16x32_bf16 v[128:131], a[40:43], a[8:11], v[128:131]
    ds_read_b64_tr_b16 a[54:55], v198 offset:12800
    s_waitcnt lgkmcnt(9)
    v_mfma_f32_16x16x32_bf16 v[36:39], a[32:35], a[12:15], v[36:39]
    ds_read_b128 a[4:7], v194 offset:28672
    v_mfma_f32_16x16x32_bf16 v[84:87], a[12:15], a[36:39], v[84:87]
    buffer_load_dwordx4 v187, s[12:15], s51 offen offset:1024 lds
    v_mfma_f32_16x16x32_bf16 v[132:135], a[40:43], a[12:15], v[132:135]
    s_waitcnt lgkmcnt(8)
    v_mfma_f32_16x16x32_bf16 v[40:43], a[32:35], a[16:19], v[40:43]
    ds_read_b128 a[8:11], v194 offset:30720
    v_mfma_f32_16x16x32_bf16 v[88:91], a[16:19], a[36:39], v[88:91]
    buffer_load_dwordx4 v188, s[12:15], s51 offen offset:2048 lds
    v_mfma_f32_16x16x32_bf16 v[136:139], a[40:43], a[16:19], v[136:139]
    s_waitcnt lgkmcnt(7)
    v_mfma_f32_16x16x32_bf16 v[0:3], a[44:47], a[20:23], v[0:3]
    ds_read_b128 a[12:15], v194 offset:32768
    s_waitcnt lgkmcnt(7)
    v_mfma_f32_16x16x32_bf16 v[48:51], a[20:23], a[48:51], v[48:51]
    buffer_load_dwordx4 v189, s[12:15], s51 offen offset:3072 lds
    s_waitcnt lgkmcnt(3)
    v_mfma_f32_16x16x32_bf16 v[96:99], a[52:55], a[20:23], v[96:99]
    v_mfma_f32_16x16x32_bf16 v[4:7], a[44:47], a[24:27], v[4:7]
    ds_read_b128 a[16:19], v194 offset:34816
    v_mfma_f32_16x16x32_bf16 v[52:55], a[24:27], a[48:51], v[52:55]
    v_lshlrev_b32 v212, 4, v254
    buffer_load_dwordx4 v[172:175], v212, s[88:91], 0 offen
    s_lshl_b32 s74, s66, 2
    s_add_u32 s74, s74, s64
    s_lshl_b32 s74, s74, 9
    buffer_load_dwordx4 a[56:59], v212, s[92:95], s74 offen
    s_lshl_b32 s74, s65, 5
    s_lshl_b32 s75, s66, 2
    s_add_u32 s74, s74, s75
    s_add_u32 s74, s74, s64
    s_mul_i32 s75, s64, 6
    s_min_u32 s75, s75, 16
    s_mul_i32 s73, s66, 22
    s_add_u32 s75, s75, s73
    s_mul_i32 s73, s65, 176
    s_add_u32 s75, s75, s73
    s_lshl_b32 s75, s75, 10
    v_add_u32 v213, 4096, v212
    buffer_load_dwordx4 v[148:151], v212, s[8:11], s75 offen
    buffer_load_dwordx4 v[152:155], v212, s[8:11], s75 offen offset:1024
    buffer_load_dwordx4 v[156:159], v212, s[8:11], s75 offen offset:2048
    buffer_load_dwordx4 v[160:163], v212, s[8:11], s75 offen offset:3072
    buffer_load_dwordx4 v[164:167], v213, s[8:11], s75 offen
    buffer_load_dwordx4 v[168:171], v213, s[8:11], s75 offen offset:1024
    s_lshl_b32 s74, s74, 8
    s_add_u32 s74, s74, 11534336
    v_lshlrev_b32 v176, 2, v254
    v_add_u32 v176, s74, v176
    v_mfma_f32_16x16x32_bf16 v[100:103], a[52:55], a[24:27], v[100:103]
    v_mfma_f32_16x16x32_bf16 v[8:11], a[44:47], a[0:3], v[8:11]
    ds_read_b128 a[20:23], v194 offset:36864
    s_add_u32 m0, s71, 0
    v_mfma_f32_16x16x32_bf16 v[56:59], a[0:3], a[48:51], v[56:59]
    buffer_load_dwordx4 v190, s[12:15], s51 offen lds
    v_mfma_f32_16x16x32_bf16 v[104:107], a[52:55], a[0:3], v[104:107]
    s_waitcnt lgkmcnt(4)
    v_mfma_f32_16x16x32_bf16 v[12:15], a[44:47], a[4:7], v[12:15]
    ds_read_b128 a[24:27], v194 offset:38912
    v_mfma_f32_16x16x32_bf16 v[60:63], a[4:7], a[48:51], v[60:63]
    v_mfma_f32_16x16x32_bf16 v[108:111], a[52:55], a[4:7], v[108:111]
    s_waitcnt lgkmcnt(4)
    v_mfma_f32_16x16x32_bf16 v[16:19], a[44:47], a[8:11], v[16:19]
    ds_read_b128 a[0:3], v194 offset:40960
    v_mfma_f32_16x16x32_bf16 v[64:67], a[8:11], a[48:51], v[64:67]
    buffer_load_dwordx4 v191, s[12:15], s51 offen offset:1024 lds
    v_mfma_f32_16x16x32_bf16 v[112:115], a[52:55], a[8:11], v[112:115]
    s_waitcnt lgkmcnt(4)
    v_mfma_f32_16x16x32_bf16 v[20:23], a[44:47], a[12:15], v[20:23]
    ds_read_b128 a[4:7], v194 offset:43008
    v_mfma_f32_16x16x32_bf16 v[68:71], a[12:15], a[48:51], v[68:71]
    v_mfma_f32_16x16x32_bf16 v[116:119], a[52:55], a[12:15], v[116:119]
    s_waitcnt lgkmcnt(4)
    v_mfma_f32_16x16x32_bf16 v[24:27], a[44:47], a[16:19], v[24:27]
    v_mfma_f32_16x16x32_bf16 v[72:75], a[16:19], a[48:51], v[72:75]
    s_waitcnt vmcnt(20)
    s_waitcnt lgkmcnt(0)
    s_barrier
    v_mfma_f32_16x16x32_bf16 v[120:123], a[52:55], a[16:19], v[120:123]
    ds_read_b64_tr_b16 a[32:33], v196 offset:32768
    v_mfma_f32_16x16x32_bf16 v[28:31], a[44:47], a[20:23], v[28:31]
    ds_read_b64_tr_b16 a[34:35], v196 offset:33792
    v_mfma_f32_16x16x32_bf16 v[76:79], a[20:23], a[48:51], v[76:79]
    ds_read_b64_tr_b16 a[36:37], v197 offset:32768
    v_mfma_f32_16x16x32_bf16 v[124:127], a[52:55], a[20:23], v[124:127]
    ds_read_b64_tr_b16 a[38:39], v197 offset:33792
    v_mfma_f32_16x16x32_bf16 v[32:35], a[44:47], a[24:27], v[32:35]
    ds_read_b64_tr_b16 a[40:41], v198 offset:16384
    v_mfma_f32_16x16x32_bf16 v[80:83], a[24:27], a[48:51], v[80:83]
    ds_read_b64_tr_b16 a[42:43], v198 offset:16896
    v_mfma_f32_16x16x32_bf16 v[128:131], a[52:55], a[24:27], v[128:131]
    ds_read_b128 a[8:11], v192 offset:45056
    v_mfma_f32_16x16x32_bf16 v[36:39], a[44:47], a[0:3], v[36:39]
    ds_read_b128 a[12:15], v192 offset:47104
    v_mfma_f32_16x16x32_bf16 v[84:87], a[0:3], a[48:51], v[84:87]
    ds_read_b128 a[16:19], v192 offset:49152
    v_mfma_f32_16x16x32_bf16 v[132:135], a[52:55], a[0:3], v[132:135]
    ds_read_b128 a[20:23], v192 offset:51200
    v_mfma_f32_16x16x32_bf16 v[40:43], a[44:47], a[4:7], v[40:43]
    ds_read_b128 a[24:27], v192 offset:53248
    s_add_u32 m0, s69, 22528
    v_mfma_f32_16x16x32_bf16 v[88:91], a[4:7], a[48:51], v[88:91]
    buffer_load_dwordx4 v180, s[8:11], s44 offen lds
    v_mfma_f32_16x16x32_bf16 v[136:139], a[52:55], a[4:7], v[136:139]
    s_waitcnt lgkmcnt(4)
    v_mfma_f32_16x16x32_bf16 v[0:3], a[32:35], a[8:11], v[0:3]
    ds_read_b128 a[0:3], v192 offset:55296
    v_mfma_f32_16x16x32_bf16 v[48:51], a[8:11], a[36:39], v[48:51]
    buffer_load_dwordx4 v181, s[8:11], s44 offen offset:1024 lds
    v_mfma_f32_16x16x32_bf16 v[96:99], a[40:43], a[8:11], v[96:99]
    s_waitcnt lgkmcnt(4)
    v_mfma_f32_16x16x32_bf16 v[4:7], a[32:35], a[12:15], v[4:7]
    ds_read_b128 a[4:7], v192 offset:57344
    v_mfma_f32_16x16x32_bf16 v[52:55], a[12:15], a[36:39], v[52:55]
    v_mfma_f32_16x16x32_bf16 v[100:103], a[40:43], a[12:15], v[100:103]
    s_waitcnt lgkmcnt(4)
    v_mfma_f32_16x16x32_bf16 v[8:11], a[32:35], a[16:19], v[8:11]
    ds_read_b128 a[8:11], v192 offset:59392
    v_mfma_f32_16x16x32_bf16 v[56:59], a[16:19], a[36:39], v[56:59]
    buffer_load_dwordx4 v182, s[8:11], s44 offen offset:2048 lds
    v_mfma_f32_16x16x32_bf16 v[104:107], a[40:43], a[16:19], v[104:107]
    s_waitcnt lgkmcnt(4)
    v_mfma_f32_16x16x32_bf16 v[12:15], a[32:35], a[20:23], v[12:15]
    ds_read_b128 a[12:15], v192 offset:61440
    v_mfma_f32_16x16x32_bf16 v[60:63], a[20:23], a[36:39], v[60:63]
    buffer_load_dwordx4 v183, s[8:11], s44 offen offset:3072 lds
    v_mfma_f32_16x16x32_bf16 v[108:111], a[40:43], a[20:23], v[108:111]
    ds_read_b64_tr_b16 a[44:45], v196 offset:40960
    s_waitcnt lgkmcnt(5)
    v_mfma_f32_16x16x32_bf16 v[16:19], a[32:35], a[24:27], v[16:19]
    ds_read_b128 a[16:19], v192 offset:63488
    v_mfma_f32_16x16x32_bf16 v[64:67], a[24:27], a[36:39], v[64:67]
    v_mfma_f32_16x16x32_bf16 v[112:115], a[40:43], a[24:27], v[112:115]
    ds_read_b64_tr_b16 a[46:47], v196 offset:41984
    s_waitcnt lgkmcnt(6)
    v_mfma_f32_16x16x32_bf16 v[20:23], a[32:35], a[0:3], v[20:23]
    ds_read_b128 a[20:23], v193
    s_add_u32 m0, s69, 26624
    v_mfma_f32_16x16x32_bf16 v[68:71], a[0:3], a[36:39], v[68:71]
    buffer_load_dwordx4 v184, s[8:11], s44 offen lds
    v_mfma_f32_16x16x32_bf16 v[116:119], a[40:43], a[0:3], v[116:119]
    ds_read_b64_tr_b16 a[48:49], v197 offset:40960
    s_waitcnt lgkmcnt(7)
    v_mfma_f32_16x16x32_bf16 v[24:27], a[32:35], a[4:7], v[24:27]
    ds_read_b128 a[24:27], v194 offset:45056
    v_mfma_f32_16x16x32_bf16 v[72:75], a[4:7], a[36:39], v[72:75]
    s_mov_b32 exec_hi, 0
    buffer_load_dwordx4 v185, s[8:11], s44 offen offset:1024 lds
    s_mov_b32 exec_hi, -1
    v_mfma_f32_16x16x32_bf16 v[120:123], a[40:43], a[4:7], v[120:123]
    ds_read_b64_tr_b16 a[50:51], v197 offset:41984
    s_waitcnt lgkmcnt(8)
    v_mfma_f32_16x16x32_bf16 v[28:31], a[32:35], a[8:11], v[28:31]
    ds_read_b128 a[0:3], v194 offset:47104
    v_mfma_f32_16x16x32_bf16 v[76:79], a[8:11], a[36:39], v[76:79]
    v_mfma_f32_16x16x32_bf16 v[124:127], a[40:43], a[8:11], v[124:127]
    ds_read_b64_tr_b16 a[52:53], v198 offset:20480
    s_waitcnt lgkmcnt(9)
    v_mfma_f32_16x16x32_bf16 v[32:35], a[32:35], a[12:15], v[32:35]
    ds_read_b128 a[4:7], v194 offset:49152
    s_add_u32 m0, s70, 16384
    v_mfma_f32_16x16x32_bf16 v[80:83], a[12:15], a[36:39], v[80:83]
    buffer_load_dwordx4 v186, s[12:15], s52 offen lds
    v_mfma_f32_16x16x32_bf16 v[128:131], a[40:43], a[12:15], v[128:131]
    ds_read_b64_tr_b16 a[54:55], v198 offset:20992
    s_waitcnt lgkmcnt(9)
    v_mfma_f32_16x16x32_bf16 v[36:39], a[32:35], a[16:19], v[36:39]
    ds_read_b128 a[8:11], v194 offset:51200
    v_mfma_f32_16x16x32_bf16 v[84:87], a[16:19], a[36:39], v[84:87]
    buffer_load_dwordx4 v187, s[12:15], s52 offen offset:1024 lds
    v_mfma_f32_16x16x32_bf16 v[132:135], a[40:43], a[16:19], v[132:135]
    s_waitcnt lgkmcnt(8)
    v_mfma_f32_16x16x32_bf16 v[40:43], a[32:35], a[20:23], v[40:43]
    ds_read_b128 a[12:15], v194 offset:53248
    v_mfma_f32_16x16x32_bf16 v[88:91], a[20:23], a[36:39], v[88:91]
    buffer_load_dwordx4 v188, s[12:15], s52 offen offset:2048 lds
    v_mfma_f32_16x16x32_bf16 v[136:139], a[40:43], a[20:23], v[136:139]
    s_waitcnt lgkmcnt(7)
    v_mfma_f32_16x16x32_bf16 v[0:3], a[44:47], a[24:27], v[0:3]
    ds_read_b128 a[16:19], v194 offset:55296
    s_waitcnt lgkmcnt(7)
    v_mfma_f32_16x16x32_bf16 v[48:51], a[24:27], a[48:51], v[48:51]
    buffer_load_dwordx4 v189, s[12:15], s52 offen offset:3072 lds
    s_waitcnt lgkmcnt(3)
    v_mfma_f32_16x16x32_bf16 v[96:99], a[52:55], a[24:27], v[96:99]
    v_mfma_f32_16x16x32_bf16 v[4:7], a[44:47], a[0:3], v[4:7]
    ds_read_b128 a[20:23], v194 offset:57344
    v_mfma_f32_16x16x32_bf16 v[52:55], a[0:3], a[48:51], v[52:55]
    v_mfma_f32_16x16x32_bf16 v[100:103], a[52:55], a[0:3], v[100:103]
    v_mfma_f32_16x16x32_bf16 v[8:11], a[44:47], a[4:7], v[8:11]
    ds_read_b128 a[24:27], v194 offset:59392
    s_add_u32 m0, s71, 8192
    v_mfma_f32_16x16x32_bf16 v[56:59], a[4:7], a[48:51], v[56:59]
    buffer_load_dwordx4 v190, s[12:15], s52 offen lds
    v_mfma_f32_16x16x32_bf16 v[104:107], a[52:55], a[4:7], v[104:107]
    s_waitcnt lgkmcnt(4)
    v_mfma_f32_16x16x32_bf16 v[12:15], a[44:47], a[8:11], v[12:15]
    ds_read_b128 a[0:3], v194 offset:61440
    v_mfma_f32_16x16x32_bf16 v[60:63], a[8:11], a[48:51], v[60:63]
    v_mfma_f32_16x16x32_bf16 v[108:111], a[52:55], a[8:11], v[108:111]
    s_waitcnt lgkmcnt(4)
    v_mfma_f32_16x16x32_bf16 v[16:19], a[44:47], a[12:15], v[16:19]
    ds_read_b128 a[4:7], v194 offset:63488
    v_mfma_f32_16x16x32_bf16 v[64:67], a[12:15], a[48:51], v[64:67]
    buffer_load_dwordx4 v191, s[12:15], s52 offen offset:1024 lds
    v_mfma_f32_16x16x32_bf16 v[112:115], a[52:55], a[12:15], v[112:115]
    s_waitcnt lgkmcnt(4)
    v_mfma_f32_16x16x32_bf16 v[20:23], a[44:47], a[16:19], v[20:23]
    ds_read_b128 a[8:11], v195
    v_mfma_f32_16x16x32_bf16 v[68:71], a[16:19], a[48:51], v[68:71]
    v_mfma_f32_16x16x32_bf16 v[116:119], a[52:55], a[16:19], v[116:119]
    s_waitcnt lgkmcnt(4)
    v_mfma_f32_16x16x32_bf16 v[24:27], a[44:47], a[20:23], v[24:27]
    v_mfma_f32_16x16x32_bf16 v[72:75], a[20:23], a[48:51], v[72:75]
    s_waitcnt vmcnt(12)
    s_waitcnt lgkmcnt(0)
    s_barrier
    v_mfma_f32_16x16x32_bf16 v[120:123], a[52:55], a[20:23], v[120:123]
    ds_read_b64_tr_b16 a[32:33], v196
    v_mfma_f32_16x16x32_bf16 v[28:31], a[44:47], a[24:27], v[28:31]
    ds_read_b64_tr_b16 a[34:35], v196 offset:1024
    v_mfma_f32_16x16x32_bf16 v[76:79], a[24:27], a[48:51], v[76:79]
    ds_read_b64_tr_b16 a[36:37], v197
    v_mfma_f32_16x16x32_bf16 v[124:127], a[52:55], a[24:27], v[124:127]
    ds_read_b64_tr_b16 a[38:39], v197 offset:1024
    v_mfma_f32_16x16x32_bf16 v[32:35], a[44:47], a[0:3], v[32:35]
    ds_read_b64_tr_b16 a[40:41], v198
    v_mfma_f32_16x16x32_bf16 v[80:83], a[0:3], a[48:51], v[80:83]
    ds_read_b64_tr_b16 a[42:43], v198 offset:512
    v_mfma_f32_16x16x32_bf16 v[128:131], a[52:55], a[0:3], v[128:131]
    ds_read_b128 a[12:15], v192
    v_mfma_f32_16x16x32_bf16 v[36:39], a[44:47], a[4:7], v[36:39]
    ds_read_b128 a[16:19], v192 offset:2048
    v_mfma_f32_16x16x32_bf16 v[84:87], a[4:7], a[48:51], v[84:87]
    ds_read_b128 a[20:23], v192 offset:4096
    v_mfma_f32_16x16x32_bf16 v[132:135], a[52:55], a[4:7], v[132:135]
    ds_read_b128 a[24:27], v192 offset:6144
    v_mfma_f32_16x16x32_bf16 v[40:43], a[44:47], a[8:11], v[40:43]
    ds_read_b128 a[0:3], v192 offset:8192
    s_add_u32 m0, s69, 45056
    v_mfma_f32_16x16x32_bf16 v[88:91], a[8:11], a[48:51], v[88:91]
    buffer_load_dwordx4 v180, s[8:11], s45 offen lds
    v_mfma_f32_16x16x32_bf16 v[136:139], a[52:55], a[8:11], v[136:139]
    s_waitcnt lgkmcnt(4)
    v_mfma_f32_16x16x32_bf16 v[0:3], a[32:35], a[12:15], v[0:3]
    ds_read_b128 a[4:7], v192 offset:10240
    v_mfma_f32_16x16x32_bf16 v[48:51], a[12:15], a[36:39], v[48:51]
    buffer_load_dwordx4 v181, s[8:11], s45 offen offset:1024 lds
    v_mfma_f32_16x16x32_bf16 v[96:99], a[40:43], a[12:15], v[96:99]
    s_waitcnt lgkmcnt(4)
    v_mfma_f32_16x16x32_bf16 v[4:7], a[32:35], a[16:19], v[4:7]
    ds_read_b128 a[8:11], v192 offset:12288
    v_mfma_f32_16x16x32_bf16 v[52:55], a[16:19], a[36:39], v[52:55]
    v_mfma_f32_16x16x32_bf16 v[100:103], a[40:43], a[16:19], v[100:103]
    s_waitcnt lgkmcnt(4)
    v_mfma_f32_16x16x32_bf16 v[8:11], a[32:35], a[20:23], v[8:11]
    ds_read_b128 a[12:15], v192 offset:14336
    v_mfma_f32_16x16x32_bf16 v[56:59], a[20:23], a[36:39], v[56:59]
    buffer_load_dwordx4 v182, s[8:11], s45 offen offset:2048 lds
    v_mfma_f32_16x16x32_bf16 v[104:107], a[40:43], a[20:23], v[104:107]
    s_waitcnt lgkmcnt(4)
    v_mfma_f32_16x16x32_bf16 v[12:15], a[32:35], a[24:27], v[12:15]
    ds_read_b128 a[16:19], v192 offset:16384
    v_mfma_f32_16x16x32_bf16 v[60:63], a[24:27], a[36:39], v[60:63]
    buffer_load_dwordx4 v183, s[8:11], s45 offen offset:3072 lds
    v_mfma_f32_16x16x32_bf16 v[108:111], a[40:43], a[24:27], v[108:111]
    ds_read_b64_tr_b16 a[44:45], v196 offset:8192
    s_waitcnt lgkmcnt(5)
    v_mfma_f32_16x16x32_bf16 v[16:19], a[32:35], a[0:3], v[16:19]
    ds_read_b128 a[20:23], v192 offset:18432
    v_mfma_f32_16x16x32_bf16 v[64:67], a[0:3], a[36:39], v[64:67]
    v_mfma_f32_16x16x32_bf16 v[112:115], a[40:43], a[0:3], v[112:115]
    ds_read_b64_tr_b16 a[46:47], v196 offset:9216
    s_waitcnt lgkmcnt(6)
    v_mfma_f32_16x16x32_bf16 v[20:23], a[32:35], a[4:7], v[20:23]
    ds_read_b128 a[24:27], v192 offset:20480
    s_add_u32 m0, s69, 49152
    v_mfma_f32_16x16x32_bf16 v[68:71], a[4:7], a[36:39], v[68:71]
    buffer_load_dwordx4 v184, s[8:11], s45 offen lds
    v_mfma_f32_16x16x32_bf16 v[116:119], a[40:43], a[4:7], v[116:119]
    ds_read_b64_tr_b16 a[48:49], v197 offset:8192
    s_waitcnt lgkmcnt(7)
    v_mfma_f32_16x16x32_bf16 v[24:27], a[32:35], a[8:11], v[24:27]
    ds_read_b128 a[0:3], v194
    v_mfma_f32_16x16x32_bf16 v[72:75], a[8:11], a[36:39], v[72:75]
    s_mov_b32 exec_hi, 0
    buffer_load_dwordx4 v185, s[8:11], s45 offen offset:1024 lds
    s_mov_b32 exec_hi, -1
    v_mfma_f32_16x16x32_bf16 v[120:123], a[40:43], a[8:11], v[120:123]
    ds_read_b64_tr_b16 a[50:51], v197 offset:9216
    s_waitcnt lgkmcnt(8)
    v_mfma_f32_16x16x32_bf16 v[28:31], a[32:35], a[12:15], v[28:31]
    ds_read_b128 a[4:7], v194 offset:2048
    buffer_load_dword v239, v255, s[20:23], s96 offen
    v_mfma_f32_16x16x32_bf16 v[76:79], a[12:15], a[36:39], v[76:79]
    v_mfma_f32_16x16x32_bf16 v[124:127], a[40:43], a[12:15], v[124:127]
    ds_read_b64_tr_b16 a[52:53], v198 offset:4096
    s_waitcnt lgkmcnt(9)
    v_mfma_f32_16x16x32_bf16 v[32:35], a[32:35], a[16:19], v[32:35]
    ds_read_b128 a[8:11], v194 offset:4096
    s_add_u32 m0, s70, 32768
    v_mfma_f32_16x16x32_bf16 v[80:83], a[16:19], a[36:39], v[80:83]
    buffer_load_dwordx4 v186, s[12:15], s53 offen lds
    v_mfma_f32_16x16x32_bf16 v[128:131], a[40:43], a[16:19], v[128:131]
    ds_read_b64_tr_b16 a[54:55], v198 offset:4608
    s_waitcnt lgkmcnt(9)
    v_mfma_f32_16x16x32_bf16 v[36:39], a[32:35], a[20:23], v[36:39]
    ds_read_b128 a[12:15], v194 offset:6144
    v_mfma_f32_16x16x32_bf16 v[84:87], a[20:23], a[36:39], v[84:87]
    buffer_load_dwordx4 v187, s[12:15], s53 offen offset:1024 lds
    v_mfma_f32_16x16x32_bf16 v[132:135], a[40:43], a[20:23], v[132:135]
    s_waitcnt lgkmcnt(8)
    v_mfma_f32_16x16x32_bf16 v[40:43], a[32:35], a[24:27], v[40:43]
    ds_read_b128 a[16:19], v194 offset:8192
    v_mfma_f32_16x16x32_bf16 v[88:91], a[24:27], a[36:39], v[88:91]
    buffer_load_dwordx4 v188, s[12:15], s53 offen offset:2048 lds
    v_mfma_f32_16x16x32_bf16 v[136:139], a[40:43], a[24:27], v[136:139]
    v_dot2_f32_bf16 v212, v148, v172, 0
    s_waitcnt lgkmcnt(7)
    v_mfma_f32_16x16x32_bf16 v[0:3], a[44:47], a[0:3], v[0:3]
    ds_read_b128 a[20:23], v194 offset:10240
    s_waitcnt lgkmcnt(7)
    v_mfma_f32_16x16x32_bf16 v[48:51], a[0:3], a[48:51], v[48:51]
    buffer_load_dwordx4 v189, s[12:15], s53 offen offset:3072 lds
    s_waitcnt lgkmcnt(3)
    v_mfma_f32_16x16x32_bf16 v[96:99], a[52:55], a[0:3], v[96:99]
    v_dot2_f32_bf16 v213, v152, v172, 0
    v_mfma_f32_16x16x32_bf16 v[4:7], a[44:47], a[4:7], v[4:7]
    ds_read_b128 a[24:27], v194 offset:12288
    v_mfma_f32_16x16x32_bf16 v[52:55], a[4:7], a[48:51], v[52:55]
    v_dot2_f32_bf16 v214, v156, v172, 0
    v_mfma_f32_16x16x32_bf16 v[100:103], a[52:55], a[4:7], v[100:103]
    v_dot2_f32_bf16 v215, v160, v172, 0
    v_mfma_f32_16x16x32_bf16 v[8:11], a[44:47], a[8:11], v[8:11]
    ds_read_b128 a[0:3], v194 offset:14336
    s_add_u32 m0, s71, 16384
    v_mfma_f32_16x16x32_bf16 v[56:59], a[8:11], a[48:51], v[56:59]
    buffer_load_dwordx4 v190, s[12:15], s53 offen lds
    v_mfma_f32_16x16x32_bf16 v[104:107], a[52:55], a[8:11], v[104:107]
    v_dot2_f32_bf16 v216, v164, v172, 0
    s_waitcnt lgkmcnt(4)
    v_mfma_f32_16x16x32_bf16 v[12:15], a[44:47], a[12:15], v[12:15]
    ds_read_b128 a[4:7], v194 offset:16384
    v_mfma_f32_16x16x32_bf16 v[60:63], a[12:15], a[48:51], v[60:63]
    v_dot2_f32_bf16 v217, v168, v172, 0
    v_mfma_f32_16x16x32_bf16 v[108:111], a[52:55], a[12:15], v[108:111]
    v_dot2_f32_bf16 v212, v149, v173, v212
    s_waitcnt lgkmcnt(4)
    v_mfma_f32_16x16x32_bf16 v[16:19], a[44:47], a[16:19], v[16:19]
    ds_read_b128 a[8:11], v194 offset:18432
    v_mfma_f32_16x16x32_bf16 v[64:67], a[16:19], a[48:51], v[64:67]
    buffer_load_dwordx4 v191, s[12:15], s53 offen offset:1024 lds
    v_mfma_f32_16x16x32_bf16 v[112:115], a[52:55], a[16:19], v[112:115]
    v_dot2_f32_bf16 v213, v153, v173, v213
    s_waitcnt lgkmcnt(4)
    v_mfma_f32_16x16x32_bf16 v[20:23], a[44:47], a[20:23], v[20:23]
    ds_read_b128 a[12:15], v194 offset:20480
    v_mfma_f32_16x16x32_bf16 v[68:71], a[20:23], a[48:51], v[68:71]
    v_dot2_f32_bf16 v214, v157, v173, v214
    v_mfma_f32_16x16x32_bf16 v[116:119], a[52:55], a[20:23], v[116:119]
    v_dot2_f32_bf16 v215, v161, v173, v215
    s_waitcnt lgkmcnt(4)
    v_mfma_f32_16x16x32_bf16 v[24:27], a[44:47], a[24:27], v[24:27]
    v_dot2_f32_bf16 v216, v165, v173, v216
    v_mfma_f32_16x16x32_bf16 v[72:75], a[24:27], a[48:51], v[72:75]
    s_waitcnt vmcnt(13)
    s_waitcnt lgkmcnt(0)
    s_barrier
    v_mfma_f32_16x16x32_bf16 v[120:123], a[52:55], a[24:27], v[120:123]
    ds_read_b64_tr_b16 a[32:33], v196 offset:16384
    v_mfma_f32_16x16x32_bf16 v[28:31], a[44:47], a[0:3], v[28:31]
    ds_read_b64_tr_b16 a[34:35], v196 offset:17408
    v_mfma_f32_16x16x32_bf16 v[76:79], a[0:3], a[48:51], v[76:79]
    ds_read_b64_tr_b16 a[36:37], v197 offset:16384
    v_mfma_f32_16x16x32_bf16 v[124:127], a[52:55], a[0:3], v[124:127]
    ds_read_b64_tr_b16 a[38:39], v197 offset:17408
    v_mfma_f32_16x16x32_bf16 v[32:35], a[44:47], a[4:7], v[32:35]
    ds_read_b64_tr_b16 a[40:41], v198 offset:8192
    v_mfma_f32_16x16x32_bf16 v[80:83], a[4:7], a[48:51], v[80:83]
    ds_read_b64_tr_b16 a[42:43], v198 offset:8704
    v_mfma_f32_16x16x32_bf16 v[128:131], a[52:55], a[4:7], v[128:131]
    ds_read_b128 a[16:19], v192 offset:22528
    v_mfma_f32_16x16x32_bf16 v[36:39], a[44:47], a[8:11], v[36:39]
    ds_read_b128 a[20:23], v192 offset:24576
    v_mfma_f32_16x16x32_bf16 v[84:87], a[8:11], a[48:51], v[84:87]
    ds_read_b128 a[24:27], v192 offset:26624
    buffer_load_dword v239, v255, s[20:23], s97 offen
    v_mfma_f32_16x16x32_bf16 v[132:135], a[52:55], a[8:11], v[132:135]
    ds_read_b128 a[0:3], v192 offset:28672
    v_mfma_f32_16x16x32_bf16 v[40:43], a[44:47], a[12:15], v[40:43]
    ds_read_b128 a[4:7], v192 offset:30720
    s_add_u32 m0, s69, 0
    v_mfma_f32_16x16x32_bf16 v[88:91], a[12:15], a[48:51], v[88:91]
    buffer_load_dwordx4 v180, s[8:11], s46 offen lds
    v_mfma_f32_16x16x32_bf16 v[136:139], a[52:55], a[12:15], v[136:139]
    v_dot2_f32_bf16 v217, v169, v173, v217
    s_waitcnt lgkmcnt(4)
    v_mfma_f32_16x16x32_bf16 v[0:3], a[32:35], a[16:19], v[0:3]
    ds_read_b128 a[8:11], v192 offset:32768
    v_mfma_f32_16x16x32_bf16 v[48:51], a[16:19], a[36:39], v[48:51]
    buffer_load_dwordx4 v181, s[8:11], s46 offen offset:1024 lds
    v_mfma_f32_16x16x32_bf16 v[96:99], a[40:43], a[16:19], v[96:99]
    v_dot2_f32_bf16 v212, v150, v174, v212
    s_waitcnt lgkmcnt(4)
    v_mfma_f32_16x16x32_bf16 v[4:7], a[32:35], a[20:23], v[4:7]
    ds_read_b128 a[12:15], v192 offset:34816
    v_mfma_f32_16x16x32_bf16 v[52:55], a[20:23], a[36:39], v[52:55]
    v_dot2_f32_bf16 v213, v154, v174, v213
    v_mfma_f32_16x16x32_bf16 v[100:103], a[40:43], a[20:23], v[100:103]
    v_dot2_f32_bf16 v214, v158, v174, v214
    s_waitcnt lgkmcnt(4)
    v_mfma_f32_16x16x32_bf16 v[8:11], a[32:35], a[24:27], v[8:11]
    ds_read_b128 a[16:19], v192 offset:36864
    v_mfma_f32_16x16x32_bf16 v[56:59], a[24:27], a[36:39], v[56:59]
    buffer_load_dwordx4 v182, s[8:11], s46 offen offset:2048 lds
    v_mfma_f32_16x16x32_bf16 v[104:107], a[40:43], a[24:27], v[104:107]
    v_dot2_f32_bf16 v215, v162, v174, v215
    s_waitcnt lgkmcnt(4)
    v_mfma_f32_16x16x32_bf16 v[12:15], a[32:35], a[0:3], v[12:15]
    ds_read_b128 a[20:23], v192 offset:38912
    v_mfma_f32_16x16x32_bf16 v[60:63], a[0:3], a[36:39], v[60:63]
    buffer_load_dwordx4 v183, s[8:11], s46 offen offset:3072 lds
    v_mfma_f32_16x16x32_bf16 v[108:111], a[40:43], a[0:3], v[108:111]
    ds_read_b64_tr_b16 a[44:45], v196 offset:24576
    s_waitcnt lgkmcnt(5)
    v_mfma_f32_16x16x32_bf16 v[16:19], a[32:35], a[4:7], v[16:19]
    ds_read_b128 a[24:27], v192 offset:40960
    v_mfma_f32_16x16x32_bf16 v[64:67], a[4:7], a[36:39], v[64:67]
    v_dot2_f32_bf16 v216, v166, v174, v216
    v_mfma_f32_16x16x32_bf16 v[112:115], a[40:43], a[4:7], v[112:115]
    ds_read_b64_tr_b16 a[46:47], v196 offset:25600
    s_waitcnt lgkmcnt(6)
    v_mfma_f32_16x16x32_bf16 v[20:23], a[32:35], a[8:11], v[20:23]
    ds_read_b128 a[0:3], v192 offset:43008
    s_add_u32 m0, s69, 4096
    v_mfma_f32_16x16x32_bf16 v[68:71], a[8:11], a[36:39], v[68:71]
    buffer_load_dwordx4 v184, s[8:11], s46 offen lds
    v_mfma_f32_16x16x32_bf16 v[116:119], a[40:43], a[8:11], v[116:119]
    ds_read_b64_tr_b16 a[48:49], v197 offset:24576
    s_waitcnt lgkmcnt(7)
    v_mfma_f32_16x16x32_bf16 v[24:27], a[32:35], a[12:15], v[24:27]
    ds_read_b128 a[4:7], v194 offset:22528
    v_mfma_f32_16x16x32_bf16 v[72:75], a[12:15], a[36:39], v[72:75]
    s_mov_b32 exec_hi, 0
    buffer_load_dwordx4 v185, s[8:11], s46 offen offset:1024 lds
    s_mov_b32 exec_hi, -1
    v_mfma_f32_16x16x32_bf16 v[120:123], a[40:43], a[12:15], v[120:123]
    ds_read_b64_tr_b16 a[50:51], v197 offset:25600
    s_waitcnt lgkmcnt(8)
    v_mfma_f32_16x16x32_bf16 v[28:31], a[32:35], a[16:19], v[28:31]
    ds_read_b128 a[8:11], v194 offset:24576
    v_mfma_f32_16x16x32_bf16 v[76:79], a[16:19], a[36:39], v[76:79]
    v_dot2_f32_bf16 v217, v170, v174, v217
    v_mfma_f32_16x16x32_bf16 v[124:127], a[40:43], a[16:19], v[124:127]
    ds_read_b64_tr_b16 a[52:53], v198 offset:12288
    s_waitcnt lgkmcnt(9)
    v_mfma_f32_16x16x32_bf16 v[32:35], a[32:35], a[20:23], v[32:35]
    ds_read_b128 a[12:15], v194 offset:26624
    s_add_u32 m0, s70, 0
    v_mfma_f32_16x16x32_bf16 v[80:83], a[20:23], a[36:39], v[80:83]
    buffer_load_dwordx4 v186, s[12:15], s54 offen lds
    v_mfma_f32_16x16x32_bf16 v[128:131], a[40:43], a[20:23], v[128:131]
    ds_read_b64_tr_b16 a[54:55], v198 offset:12800
    s_waitcnt lgkmcnt(9)
    v_mfma_f32_16x16x32_bf16 v[36:39], a[32:35], a[24:27], v[36:39]
    ds_read_b128 a[16:19], v194 offset:28672
    v_mfma_f32_16x16x32_bf16 v[84:87], a[24:27], a[36:39], v[84:87]
    buffer_load_dwordx4 v187, s[12:15], s54 offen offset:1024 lds
    v_mfma_f32_16x16x32_bf16 v[132:135], a[40:43], a[24:27], v[132:135]
    v_dot2_f32_bf16 v212, v151, v175, v212
    s_waitcnt lgkmcnt(8)
    v_mfma_f32_16x16x32_bf16 v[40:43], a[32:35], a[0:3], v[40:43]
    ds_read_b128 a[20:23], v194 offset:30720
    v_mfma_f32_16x16x32_bf16 v[88:91], a[0:3], a[36:39], v[88:91]
    buffer_load_dwordx4 v188, s[12:15], s54 offen offset:2048 lds
    v_mfma_f32_16x16x32_bf16 v[136:139], a[40:43], a[0:3], v[136:139]
    v_dot2_f32_bf16 v213, v155, v175, v213
    s_waitcnt lgkmcnt(7)
    v_mfma_f32_16x16x32_bf16 v[0:3], a[44:47], a[4:7], v[0:3]
    ds_read_b128 a[24:27], v194 offset:32768
    s_waitcnt lgkmcnt(7)
    v_mfma_f32_16x16x32_bf16 v[48:51], a[4:7], a[48:51], v[48:51]
    buffer_load_dwordx4 v189, s[12:15], s54 offen offset:3072 lds
    s_waitcnt lgkmcnt(3)
    v_mfma_f32_16x16x32_bf16 v[96:99], a[52:55], a[4:7], v[96:99]
    buffer_load_dword v239, v255, s[20:23], s98 offen
    v_mfma_f32_16x16x32_bf16 v[4:7], a[44:47], a[8:11], v[4:7]
    ds_read_b128 a[0:3], v194 offset:34816
    v_mfma_f32_16x16x32_bf16 v[52:55], a[8:11], a[48:51], v[52:55]
    v_dot2_f32_bf16 v214, v159, v175, v214
    v_mfma_f32_16x16x32_bf16 v[100:103], a[52:55], a[8:11], v[100:103]
    v_dot2_f32_bf16 v215, v163, v175, v215
    v_mfma_f32_16x16x32_bf16 v[8:11], a[44:47], a[12:15], v[8:11]
    ds_read_b128 a[4:7], v194 offset:36864
    s_add_u32 m0, s71, 0
    v_mfma_f32_16x16x32_bf16 v[56:59], a[12:15], a[48:51], v[56:59]
    buffer_load_dwordx4 v190, s[12:15], s54 offen lds
    v_mfma_f32_16x16x32_bf16 v[104:107], a[52:55], a[12:15], v[104:107]
    v_dot2_f32_bf16 v216, v167, v175, v216
    s_waitcnt lgkmcnt(4)
    v_mfma_f32_16x16x32_bf16 v[12:15], a[44:47], a[16:19], v[12:15]
    ds_read_b128 a[8:11], v194 offset:38912
    v_mfma_f32_16x16x32_bf16 v[60:63], a[16:19], a[48:51], v[60:63]
    v_dot2_f32_bf16 v217, v171, v175, v217
    v_mfma_f32_16x16x32_bf16 v[108:111], a[52:55], a[16:19], v[108:111]
    v_permlane32_swap_b32 v212, v213
    s_waitcnt lgkmcnt(4)
    v_mfma_f32_16x16x32_bf16 v[16:19], a[44:47], a[20:23], v[16:19]
    ds_read_b128 a[12:15], v194 offset:40960
    v_mfma_f32_16x16x32_bf16 v[64:67], a[20:23], a[48:51], v[64:67]
    buffer_load_dwordx4 v191, s[12:15], s54 offen offset:1024 lds
    v_mfma_f32_16x16x32_bf16 v[112:115], a[52:55], a[20:23], v[112:115]
    v_permlane32_swap_b32 v214, v215
    s_waitcnt lgkmcnt(4)
    v_mfma_f32_16x16x32_bf16 v[20:23], a[44:47], a[24:27], v[20:23]
    ds_read_b128 a[16:19], v194 offset:43008
    v_mfma_f32_16x16x32_bf16 v[68:71], a[24:27], a[48:51], v[68:71]
    v_permlane32_swap_b32 v216, v217
    v_mfma_f32_16x16x32_bf16 v[116:119], a[52:55], a[24:27], v[116:119]
    v_add_f32 v212, v212, v213
    s_waitcnt lgkmcnt(4)
    v_mfma_f32_16x16x32_bf16 v[24:27], a[44:47], a[0:3], v[24:27]
    v_add_f32 v214, v214, v215
    v_mfma_f32_16x16x32_bf16 v[72:75], a[0:3], a[48:51], v[72:75]
    s_waitcnt vmcnt(14)
    s_waitcnt lgkmcnt(0)
    s_barrier
    v_mfma_f32_16x16x32_bf16 v[120:123], a[52:55], a[0:3], v[120:123]
    ds_read_b64_tr_b16 a[32:33], v196 offset:32768
    v_mfma_f32_16x16x32_bf16 v[28:31], a[44:47], a[4:7], v[28:31]
    ds_read_b64_tr_b16 a[34:35], v196 offset:33792
    v_mfma_f32_16x16x32_bf16 v[76:79], a[4:7], a[48:51], v[76:79]
    ds_read_b64_tr_b16 a[36:37], v197 offset:32768
    v_mfma_f32_16x16x32_bf16 v[124:127], a[52:55], a[4:7], v[124:127]
    ds_read_b64_tr_b16 a[38:39], v197 offset:33792
    v_mfma_f32_16x16x32_bf16 v[32:35], a[44:47], a[8:11], v[32:35]
    ds_read_b64_tr_b16 a[40:41], v198 offset:16384
    v_mfma_f32_16x16x32_bf16 v[80:83], a[8:11], a[48:51], v[80:83]
    ds_read_b64_tr_b16 a[42:43], v198 offset:16896
    v_mfma_f32_16x16x32_bf16 v[128:131], a[52:55], a[8:11], v[128:131]
    ds_read_b128 a[20:23], v192 offset:45056
    v_mfma_f32_16x16x32_bf16 v[36:39], a[44:47], a[12:15], v[36:39]
    ds_read_b128 a[24:27], v192 offset:47104
    v_mfma_f32_16x16x32_bf16 v[84:87], a[12:15], a[48:51], v[84:87]
    ds_read_b128 a[0:3], v192 offset:49152
    v_mfma_f32_16x16x32_bf16 v[132:135], a[52:55], a[12:15], v[132:135]
    ds_read_b128 a[4:7], v192 offset:51200
    v_mfma_f32_16x16x32_bf16 v[40:43], a[44:47], a[16:19], v[40:43]
    ds_read_b128 a[8:11], v192 offset:53248
    s_add_u32 m0, s69, 22528
    v_mfma_f32_16x16x32_bf16 v[88:91], a[16:19], a[48:51], v[88:91]
    buffer_load_dwordx4 v180, s[8:11], s47 offen lds
    v_mfma_f32_16x16x32_bf16 v[136:139], a[52:55], a[16:19], v[136:139]
    v_add_f32 v216, v216, v217
    s_waitcnt lgkmcnt(4)
    v_mfma_f32_16x16x32_bf16 v[0:3], a[32:35], a[20:23], v[0:3]
    ds_read_b128 a[12:15], v192 offset:55296
    v_mfma_f32_16x16x32_bf16 v[48:51], a[20:23], a[36:39], v[48:51]
    buffer_load_dwordx4 v181, s[8:11], s47 offen offset:1024 lds
    v_mfma_f32_16x16x32_bf16 v[96:99], a[40:43], a[20:23], v[96:99]
    v_mov_b32 v217, v216
    s_waitcnt lgkmcnt(4)
    v_mfma_f32_16x16x32_bf16 v[4:7], a[32:35], a[24:27], v[4:7]
    ds_read_b128 a[16:19], v192 offset:57344
    v_mfma_f32_16x16x32_bf16 v[52:55], a[24:27], a[36:39], v[52:55]
    v_permlane16_swap_b32 v212, v214
    v_mfma_f32_16x16x32_bf16 v[100:103], a[40:43], a[24:27], v[100:103]
    v_permlane16_swap_b32 v216, v217
    s_waitcnt lgkmcnt(4)
    v_mfma_f32_16x16x32_bf16 v[8:11], a[32:35], a[0:3], v[8:11]
    ds_read_b128 a[20:23], v192 offset:59392
    v_mfma_f32_16x16x32_bf16 v[56:59], a[0:3], a[36:39], v[56:59]
    buffer_load_dwordx4 v182, s[8:11], s47 offen offset:2048 lds
    v_mfma_f32_16x16x32_bf16 v[104:107], a[40:43], a[0:3], v[104:107]
    v_add_f32 v212, v212, v214
    s_waitcnt lgkmcnt(4)
    v_mfma_f32_16x16x32_bf16 v[12:15], a[32:35], a[4:7], v[12:15]
    ds_read_b128 a[24:27], v192 offset:61440
    buffer_load_dword v239, v255, s[20:23], s99 offen
    v_mfma_f32_16x16x32_bf16 v[60:63], a[4:7], a[36:39], v[60:63]
    buffer_load_dwordx4 v183, s[8:11], s47 offen offset:3072 lds
    v_mfma_f32_16x16x32_bf16 v[108:111], a[40:43], a[4:7], v[108:111]
    ds_read_b64_tr_b16 a[44:45], v196 offset:40960
    s_waitcnt lgkmcnt(5)
    v_mfma_f32_16x16x32_bf16 v[16:19], a[32:35], a[8:11], v[16:19]
    ds_read_b128 a[0:3], v192 offset:63488
    v_mfma_f32_16x16x32_bf16 v[64:67], a[8:11], a[36:39], v[64:67]
    v_add_f32 v216, v216, v217
    v_mfma_f32_16x16x32_bf16 v[112:115], a[40:43], a[8:11], v[112:115]
    ds_read_b64_tr_b16 a[46:47], v196 offset:41984
    s_waitcnt lgkmcnt(6)
    v_mfma_f32_16x16x32_bf16 v[20:23], a[32:35], a[12:15], v[20:23]
    ds_read_b128 a[4:7], v193
    s_add_u32 m0, s69, 26624
    v_mfma_f32_16x16x32_bf16 v[68:71], a[12:15], a[36:39], v[68:71]
    buffer_load_dwordx4 v184, s[8:11], s47 offen lds
    v_mfma_f32_16x16x32_bf16 v[116:119], a[40:43], a[12:15], v[116:119]
    ds_read_b64_tr_b16 a[48:49], v197 offset:40960
    s_waitcnt lgkmcnt(7)
    v_mfma_f32_16x16x32_bf16 v[24:27], a[32:35], a[16:19], v[24:27]
    ds_read_b128 a[8:11], v194 offset:45056
    v_mfma_f32_16x16x32_bf16 v[72:75], a[16:19], a[36:39], v[72:75]
    s_mov_b32 exec_hi, 0
    buffer_load_dwordx4 v185, s[8:11], s47 offen offset:1024 lds
    s_mov_b32 exec_hi, -1
    v_mfma_f32_16x16x32_bf16 v[120:123], a[40:43], a[16:19], v[120:123]
    ds_read_b64_tr_b16 a[50:51], v197 offset:41984
    s_waitcnt lgkmcnt(8)
    v_mfma_f32_16x16x32_bf16 v[28:31], a[32:35], a[20:23], v[28:31]
    ds_read_b128 a[12:15], v194 offset:47104
    v_mfma_f32_16x16x32_bf16 v[76:79], a[20:23], a[36:39], v[76:79]
    v_add_f32_dpp v212, v212, v212 row_ror:8 row_mask:0xf bank_mask:0xf
    v_mfma_f32_16x16x32_bf16 v[124:127], a[40:43], a[20:23], v[124:127]
    ds_read_b64_tr_b16 a[52:53], v198 offset:20480
    s_waitcnt lgkmcnt(9)
    v_mfma_f32_16x16x32_bf16 v[32:35], a[32:35], a[24:27], v[32:35]
    ds_read_b128 a[16:19], v194 offset:49152
    s_add_u32 m0, s70, 16384
    v_mfma_f32_16x16x32_bf16 v[80:83], a[24:27], a[36:39], v[80:83]
    buffer_load_dwordx4 v186, s[12:15], s55 offen lds
    v_mfma_f32_16x16x32_bf16 v[128:131], a[40:43], a[24:27], v[128:131]
    ds_read_b64_tr_b16 a[54:55], v198 offset:20992
    s_waitcnt lgkmcnt(9)
    v_mfma_f32_16x16x32_bf16 v[36:39], a[32:35], a[0:3], v[36:39]
    ds_read_b128 a[20:23], v194 offset:51200
    v_mfma_f32_16x16x32_bf16 v[84:87], a[0:3], a[36:39], v[84:87]
    buffer_load_dwordx4 v187, s[12:15], s55 offen offset:1024 lds
    v_mfma_f32_16x16x32_bf16 v[132:135], a[40:43], a[0:3], v[132:135]
    v_add_f32_dpp v216, v216, v216 row_ror:8 row_mask:0xf bank_mask:0xf
    s_waitcnt lgkmcnt(8)
    v_mfma_f32_16x16x32_bf16 v[40:43], a[32:35], a[4:7], v[40:43]
    ds_read_b128 a[24:27], v194 offset:53248
    v_mfma_f32_16x16x32_bf16 v[88:91], a[4:7], a[36:39], v[88:91]
    buffer_load_dwordx4 v188, s[12:15], s55 offen offset:2048 lds
    v_mfma_f32_16x16x32_bf16 v[136:139], a[40:43], a[4:7], v[136:139]
    v_add_f32_dpp v212, v212, v212 row_ror:4 row_mask:0xf bank_mask:0xf
    s_waitcnt lgkmcnt(7)
    v_mfma_f32_16x16x32_bf16 v[0:3], a[44:47], a[8:11], v[0:3]
    ds_read_b128 a[0:3], v194 offset:55296
    s_waitcnt lgkmcnt(7)
    v_mfma_f32_16x16x32_bf16 v[48:51], a[8:11], a[48:51], v[48:51]
    buffer_load_dwordx4 v189, s[12:15], s55 offen offset:3072 lds
    s_waitcnt lgkmcnt(3)
    v_mfma_f32_16x16x32_bf16 v[96:99], a[52:55], a[8:11], v[96:99]
    v_add_f32_dpp v216, v216, v216 row_ror:4 row_mask:0xf bank_mask:0xf
    v_mfma_f32_16x16x32_bf16 v[4:7], a[44:47], a[12:15], v[4:7]
    ds_read_b128 a[4:7], v194 offset:57344
    v_mfma_f32_16x16x32_bf16 v[52:55], a[12:15], a[48:51], v[52:55]
    v_add_f32_dpp v212, v212, v212 row_ror:2 row_mask:0xf bank_mask:0xf
    v_mfma_f32_16x16x32_bf16 v[100:103], a[52:55], a[12:15], v[100:103]
    v_add_f32_dpp v216, v216, v216 row_ror:2 row_mask:0xf bank_mask:0xf
    v_mfma_f32_16x16x32_bf16 v[8:11], a[44:47], a[16:19], v[8:11]
    ds_read_b128 a[8:11], v194 offset:59392
    s_add_u32 m0, s71, 8192
    v_mfma_f32_16x16x32_bf16 v[56:59], a[16:19], a[48:51], v[56:59]
    buffer_load_dwordx4 v190, s[12:15], s55 offen lds
    v_mfma_f32_16x16x32_bf16 v[104:107], a[52:55], a[16:19], v[104:107]
    v_add_f32_dpp v212, v212, v212 row_ror:1 row_mask:0xf bank_mask:0xf
    s_waitcnt lgkmcnt(4)
    v_mfma_f32_16x16x32_bf16 v[12:15], a[44:47], a[20:23], v[12:15]
    ds_read_b128 a[12:15], v194 offset:61440
    v_mfma_f32_16x16x32_bf16 v[60:63], a[20:23], a[48:51], v[60:63]
    v_add_f32_dpp v216, v216, v216 row_ror:1 row_mask:0xf bank_mask:0xf
    v_mfma_f32_16x16x32_bf16 v[108:111], a[52:55], a[20:23], v[108:111]
    s_mov_b32 s80, 0x00020002
    s_mov_b32 s81, 0x00020002
    v_cndmask_b32 v212, v212, v216, s[80:81]
    s_waitcnt lgkmcnt(4)
    v_mfma_f32_16x16x32_bf16 v[16:19], a[44:47], a[24:27], v[16:19]
    ds_read_b128 a[16:19], v194 offset:63488
    v_mfma_f32_16x16x32_bf16 v[64:67], a[24:27], a[48:51], v[64:67]
    buffer_load_dwordx4 v191, s[12:15], s55 offen offset:1024 lds
    v_mfma_f32_16x16x32_bf16 v[112:115], a[52:55], a[24:27], v[112:115]
    v_mul_f32 v212, s79, v212
    s_waitcnt lgkmcnt(4)
    v_mfma_f32_16x16x32_bf16 v[20:23], a[44:47], a[0:3], v[20:23]
    ds_read_b128 a[20:23], v195
    v_mfma_f32_16x16x32_bf16 v[68:71], a[0:3], a[48:51], v[68:71]
    buffer_load_dword v239, v255, s[20:23], s100 offen
    v_mfma_f32_16x16x32_bf16 v[116:119], a[52:55], a[0:3], v[116:119]
    v_exp_f32 v212, v212
    s_waitcnt lgkmcnt(4)
    v_mfma_f32_16x16x32_bf16 v[24:27], a[44:47], a[4:7], v[24:27]
    v_add_f32 v212, 1.0, v212
    v_mfma_f32_16x16x32_bf16 v[72:75], a[4:7], a[48:51], v[72:75]
    s_waitcnt vmcnt(14)
    s_waitcnt lgkmcnt(0)
    s_barrier
    v_mfma_f32_16x16x32_bf16 v[120:123], a[52:55], a[4:7], v[120:123]
    ds_read_b64_tr_b16 a[32:33], v196
    v_mfma_f32_16x16x32_bf16 v[28:31], a[44:47], a[8:11], v[28:31]
    ds_read_b64_tr_b16 a[34:35], v196 offset:1024
    v_mfma_f32_16x16x32_bf16 v[76:79], a[8:11], a[48:51], v[76:79]
    ds_read_b64_tr_b16 a[36:37], v197
    v_mfma_f32_16x16x32_bf16 v[124:127], a[52:55], a[8:11], v[124:127]
    ds_read_b64_tr_b16 a[38:39], v197 offset:1024
    v_mfma_f32_16x16x32_bf16 v[32:35], a[44:47], a[12:15], v[32:35]
    ds_read_b64_tr_b16 a[40:41], v198
    v_mfma_f32_16x16x32_bf16 v[80:83], a[12:15], a[48:51], v[80:83]
    ds_read_b64_tr_b16 a[42:43], v198 offset:512
    v_mfma_f32_16x16x32_bf16 v[128:131], a[52:55], a[12:15], v[128:131]
    ds_read_b128 a[24:27], v192
    v_mfma_f32_16x16x32_bf16 v[36:39], a[44:47], a[16:19], v[36:39]
    ds_read_b128 a[0:3], v192 offset:2048
    v_mfma_f32_16x16x32_bf16 v[84:87], a[16:19], a[48:51], v[84:87]
    ds_read_b128 a[4:7], v192 offset:4096
    v_mfma_f32_16x16x32_bf16 v[132:135], a[52:55], a[16:19], v[132:135]
    ds_read_b128 a[8:11], v192 offset:6144
    v_mfma_f32_16x16x32_bf16 v[40:43], a[44:47], a[20:23], v[40:43]
    ds_read_b128 a[12:15], v192 offset:8192
    v_mfma_f32_16x16x32_bf16 v[88:91], a[20:23], a[48:51], v[88:91]
    s_add_u32 m0, s4, 49152
    s_mov_b32 s72, 98304
    buffer_load_dwordx4 v240, s[20:23], s72 offen lds
    v_mfma_f32_16x16x32_bf16 v[136:139], a[52:55], a[20:23], v[136:139]
    v_rcp_f32 v212, v212
    s_waitcnt lgkmcnt(4)
    v_mfma_f32_16x16x32_bf16 v[0:3], a[32:35], a[24:27], v[0:3]
    ds_read_b128 a[16:19], v192 offset:10240
    v_mfma_f32_16x16x32_bf16 v[48:51], a[24:27], a[36:39], v[48:51]
    buffer_load_dwordx4 v241, s[20:23], s72 offen offset:1024 lds
    v_mfma_f32_16x16x32_bf16 v[96:99], a[40:43], a[24:27], v[96:99]
    buffer_store_dword v212, v176, s[16:19], 0 offen sc1
    s_waitcnt lgkmcnt(4)
    v_mfma_f32_16x16x32_bf16 v[4:7], a[32:35], a[0:3], v[4:7]
    ds_read_b128 a[20:23], v192 offset:12288
    v_mfma_f32_16x16x32_bf16 v[52:55], a[0:3], a[36:39], v[52:55]
    s_lshl_b32 s37, s64, 12
    v_mfma_f32_16x16x32_bf16 v[100:103], a[40:43], a[0:3], v[100:103]
    s_add_u32 s37, s37, 147456
    s_waitcnt lgkmcnt(4)
    v_mfma_f32_16x16x32_bf16 v[8:11], a[32:35], a[4:7], v[8:11]
    ds_read_b128 a[24:27], v192 offset:14336
    v_mfma_f32_16x16x32_bf16 v[56:59], a[4:7], a[36:39], v[56:59]
    buffer_load_dwordx4 v242, s[20:23], s72 offen offset:2048 lds
    v_mfma_f32_16x16x32_bf16 v[104:107], a[40:43], a[4:7], v[104:107]
    v_lshlrev_b32 v212, 4, v254
    s_waitcnt lgkmcnt(4)
    v_mfma_f32_16x16x32_bf16 v[12:15], a[32:35], a[8:11], v[12:15]
    ds_read_b128 a[0:3], v192 offset:16384
    v_mfma_f32_16x16x32_bf16 v[60:63], a[8:11], a[36:39], v[60:63]
    buffer_load_dwordx4 v243, s[20:23], s72 offen offset:3072 lds
    v_mfma_f32_16x16x32_bf16 v[108:111], a[40:43], a[8:11], v[108:111]
    ds_read_b64_tr_b16 a[44:45], v196 offset:8192
    s_waitcnt lgkmcnt(5)
    v_mfma_f32_16x16x32_bf16 v[16:19], a[32:35], a[12:15], v[16:19]
    ds_read_b128 a[4:7], v192 offset:18432
    v_mfma_f32_16x16x32_bf16 v[64:67], a[12:15], a[36:39], v[64:67]
    v_add_u32 v220, s37, v212
    v_mfma_f32_16x16x32_bf16 v[112:115], a[40:43], a[12:15], v[112:115]
    ds_read_b64_tr_b16 a[46:47], v196 offset:9216
    s_waitcnt lgkmcnt(6)
    v_mfma_f32_16x16x32_bf16 v[20:23], a[32:35], a[16:19], v[20:23]
    ds_read_b128 a[8:11], v192 offset:20480
    v_mfma_f32_16x16x32_bf16 v[68:71], a[16:19], a[36:39], v[68:71]
    ds_write_b128 v220, a[56:59]
    v_mfma_f32_16x16x32_bf16 v[116:119], a[40:43], a[16:19], v[116:119]
    ds_read_b64_tr_b16 a[48:49], v197 offset:8192
    s_waitcnt lgkmcnt(8)
    v_mfma_f32_16x16x32_bf16 v[24:27], a[32:35], a[20:23], v[24:27]
    ds_read_b128 a[12:15], v194
    v_mfma_f32_16x16x32_bf16 v[72:75], a[20:23], a[36:39], v[72:75]
    v_bfe_u32 v212, v254, 2, 2
    v_mfma_f32_16x16x32_bf16 v[120:123], a[40:43], a[20:23], v[120:123]
    ds_read_b64_tr_b16 a[50:51], v197 offset:9216
    s_waitcnt lgkmcnt(9)
    v_mfma_f32_16x16x32_bf16 v[28:31], a[32:35], a[24:27], v[28:31]
    ds_read_b128 a[16:19], v194 offset:2048
    v_mfma_f32_16x16x32_bf16 v[76:79], a[24:27], a[36:39], v[76:79]
    v_lshrrev_b32 v213, 5, v254
    v_mfma_f32_16x16x32_bf16 v[124:127], a[40:43], a[24:27], v[124:127]
    ds_read_b64_tr_b16 a[52:53], v198 offset:4096
    buffer_load_dword v239, v255, s[20:23], s101 offen
    s_waitcnt lgkmcnt(10)
    v_mfma_f32_16x16x32_bf16 v[32:35], a[32:35], a[0:3], v[32:35]
    ds_read_b128 a[20:23], v194 offset:4096
    v_mfma_f32_16x16x32_bf16 v[80:83], a[0:3], a[36:39], v[80:83]
    v_lshl_add_u32 v214, v213, 3, v212
    v_mfma_f32_16x16x32_bf16 v[128:131], a[40:43], a[0:3], v[128:131]
    ds_read_b64_tr_b16 a[54:55], v198 offset:4608
    s_waitcnt lgkmcnt(10)
    v_mfma_f32_16x16x32_bf16 v[36:39], a[32:35], a[4:7], v[36:39]
    ds_read_b128 a[24:27], v194 offset:6144
    v_mfma_f32_16x16x32_bf16 v[84:87], a[4:7], a[36:39], v[84:87]
    v_lshlrev_b32 v215, 5, v214
    v_mfma_f32_16x16x32_bf16 v[132:135], a[40:43], a[4:7], v[132:135]
    v_bfe_u32 v216, v254, 4, 1
    s_waitcnt lgkmcnt(9)
    v_mfma_f32_16x16x32_bf16 v[40:43], a[32:35], a[8:11], v[40:43]
    ds_read_b128 a[0:3], v194 offset:8192
    v_mfma_f32_16x16x32_bf16 v[88:91], a[8:11], a[36:39], v[88:91]
    v_lshl_add_u32 v215, v216, 4, v215
    v_mfma_f32_16x16x32_bf16 v[136:139], a[40:43], a[8:11], v[136:139]
    v_bfe_u32 v217, v254, 1, 1
    s_waitcnt lgkmcnt(7)
    v_mfma_f32_16x16x32_bf16 v[0:3], a[44:47], a[12:15], v[0:3]
    ds_read_b128 a[4:7], v194 offset:10240
    s_waitcnt lgkmcnt(7)
    v_mfma_f32_16x16x32_bf16 v[48:51], a[12:15], a[48:51], v[48:51]
    v_lshl_add_u32 v215, v217, 3, v215
    s_waitcnt lgkmcnt(3)
    v_mfma_f32_16x16x32_bf16 v[96:99], a[52:55], a[12:15], v[96:99]
    v_add_u32 v215, s37, v215
    v_mfma_f32_16x16x32_bf16 v[4:7], a[44:47], a[16:19], v[4:7]
    ds_read_b128 a[8:11], v194 offset:12288
    v_mfma_f32_16x16x32_bf16 v[52:55], a[16:19], a[48:51], v[52:55]
    ds_read_b64_tr_b16 v[144:145], v215
    v_mfma_f32_16x16x32_bf16 v[100:103], a[52:55], a[16:19], v[100:103]
    ds_read_b64_tr_b16 v[146:147], v215 offset:128
    v_mfma_f32_16x16x32_bf16 v[8:11], a[44:47], a[20:23], v[8:11]
    ds_read_b128 a[12:15], v194 offset:14336
    v_mfma_f32_16x16x32_bf16 v[56:59], a[20:23], a[48:51], v[56:59]
    v_and_b32 v218, 1, v254
    v_mfma_f32_16x16x32_bf16 v[104:107], a[52:55], a[20:23], v[104:107]
    v_lshl_or_b32 v218, v218, 1, v216
    s_waitcnt lgkmcnt(6)
    v_mfma_f32_16x16x32_bf16 v[12:15], a[44:47], a[24:27], v[12:15]
    ds_read_b128 a[16:19], v194 offset:16384
    v_mfma_f32_16x16x32_bf16 v[60:63], a[24:27], a[48:51], v[60:63]
    v_lshrrev_b32 v212, 1, v212
    v_mfma_f32_16x16x32_bf16 v[108:111], a[52:55], a[24:27], v[108:111]
    v_xor_b32 v218, v218, v212
    s_waitcnt lgkmcnt(6)
    v_mfma_f32_16x16x32_bf16 v[16:19], a[44:47], a[0:3], v[16:19]
    ds_read_b128 a[20:23], v194 offset:18432
    v_mfma_f32_16x16x32_bf16 v[64:67], a[0:3], a[48:51], v[64:67]
    v_lshlrev_b32 v218, 4, v218
    v_mfma_f32_16x16x32_bf16 v[112:115], a[52:55], a[0:3], v[112:115]
    v_lshl_add_u32 v218, v217, 3, v218
    s_waitcnt lgkmcnt(6)
    v_mfma_f32_16x16x32_bf16 v[20:23], a[44:47], a[4:7], v[20:23]
    ds_read_b128 a[24:27], v194 offset:20480
    v_mfma_f32_16x16x32_bf16 v[68:71], a[4:7], a[48:51], v[68:71]
    v_lshl_add_u32 v218, v214, 6, v218
    v_mfma_f32_16x16x32_bf16 v[116:119], a[52:55], a[4:7], v[116:119]
    v_add_u32 v223, s37, v218
    s_waitcnt lgkmcnt(6)
    v_mfma_f32_16x16x32_bf16 v[24:27], a[44:47], a[8:11], v[24:27]
    v_xor_b32 v224, 32, v223
    v_mfma_f32_16x16x32_bf16 v[72:75], a[8:11], a[48:51], v[72:75]
    s_waitcnt vmcnt(7)
    s_waitcnt lgkmcnt(0)
    s_barrier
    v_mfma_f32_16x16x32_bf16 v[120:123], a[52:55], a[8:11], v[120:123]
    ds_read_b64_tr_b16 a[32:33], v196 offset:16384
    v_mfma_f32_16x16x32_bf16 v[28:31], a[44:47], a[12:15], v[28:31]
    ds_read_b64_tr_b16 a[34:35], v196 offset:17408
    v_mfma_f32_16x16x32_bf16 v[76:79], a[12:15], a[48:51], v[76:79]
    ds_read_b64_tr_b16 a[36:37], v197 offset:16384
    v_mfma_f32_16x16x32_bf16 v[124:127], a[52:55], a[12:15], v[124:127]
    ds_read_b64_tr_b16 a[38:39], v197 offset:17408
    v_mfma_f32_16x16x32_bf16 v[32:35], a[44:47], a[16:19], v[32:35]
    ds_read_b64_tr_b16 a[40:41], v198 offset:8192
    v_mfma_f32_16x16x32_bf16 v[80:83], a[16:19], a[48:51], v[80:83]
    ds_read_b64_tr_b16 a[42:43], v198 offset:8704
    v_mfma_f32_16x16x32_bf16 v[128:131], a[52:55], a[16:19], v[128:131]
    ds_read_b128 a[0:3], v192 offset:22528
    v_mfma_f32_16x16x32_bf16 v[36:39], a[44:47], a[20:23], v[36:39]
    ds_read_b128 a[4:7], v192 offset:24576
    v_mfma_f32_16x16x32_bf16 v[84:87], a[20:23], a[48:51], v[84:87]
    ds_read_b128 a[8:11], v192 offset:26624
    v_mfma_f32_16x16x32_bf16 v[132:135], a[52:55], a[20:23], v[132:135]
    ds_read_b128 a[12:15], v192 offset:28672
    v_mfma_f32_16x16x32_bf16 v[40:43], a[44:47], a[24:27], v[40:43]
    ds_read_b128 a[16:19], v192 offset:30720
    buffer_load_dword v239, v255, s[20:23], s32 offen
    v_mfma_f32_16x16x32_bf16 v[88:91], a[24:27], a[48:51], v[88:91]
    s_add_u32 m0, s4, 0
    s_mov_b32 s72, 0
    buffer_load_dwordx4 v240, s[20:23], s72 offen lds
    v_mfma_f32_16x16x32_bf16 v[136:139], a[52:55], a[24:27], v[136:139]
    v_bfe_u32 v212, v254, 1, 2
    s_waitcnt lgkmcnt(4)
    v_mfma_f32_16x16x32_bf16 v[0:3], a[32:35], a[0:3], v[0:3]
    ds_read_b128 a[20:23], v192 offset:32768
    v_mfma_f32_16x16x32_bf16 v[48:51], a[0:3], a[36:39], v[48:51]
    buffer_load_dwordx4 v241, s[20:23], s72 offen offset:1024 lds
    v_mfma_f32_16x16x32_bf16 v[96:99], a[40:43], a[0:3], v[96:99]
    v_lshlrev_b32 v214, 1, v213
    s_waitcnt lgkmcnt(4)
    v_mfma_f32_16x16x32_bf16 v[4:7], a[32:35], a[4:7], v[4:7]
    ds_read_b128 a[24:27], v192 offset:34816
    v_mfma_f32_16x16x32_bf16 v[52:55], a[4:7], a[36:39], v[52:55]
    buffer_load_dword v239, off, s[16:19], s77 sc1
    buffer_load_dword v239, off, s[16:19], s76 sc1
    s_mov_b32 s74, 13643776
    buffer_load_dword v251, off, s[16:19], s74 sc1
    v_mfma_f32_16x16x32_bf16 v[100:103], a[40:43], a[4:7], v[100:103]
    v_xor_b32 v212, v212, v214
    s_waitcnt lgkmcnt(4)
    v_mfma_f32_16x16x32_bf16 v[8:11], a[32:35], a[8:11], v[8:11]
    ds_read_b128 a[0:3], v192 offset:36864
    v_mfma_f32_16x16x32_bf16 v[56:59], a[8:11], a[36:39], v[56:59]
    buffer_load_dwordx4 v242, s[20:23], s72 offen offset:2048 lds
    v_mfma_f32_16x16x32_bf16 v[104:107], a[40:43], a[8:11], v[104:107]
    v_lshlrev_b32 v212, 4, v212
    s_waitcnt lgkmcnt(4)
    v_mfma_f32_16x16x32_bf16 v[12:15], a[32:35], a[12:15], v[12:15]
    ds_read_b128 a[4:7], v192 offset:38912
    v_mfma_f32_16x16x32_bf16 v[60:63], a[12:15], a[36:39], v[60:63]
    buffer_load_dwordx4 v243, s[20:23], s72 offen offset:3072 lds
    v_mfma_f32_16x16x32_bf16 v[108:111], a[40:43], a[12:15], v[108:111]
    ds_read_b64_tr_b16 a[44:45], v196 offset:24576
    s_waitcnt lgkmcnt(5)
    v_mfma_f32_16x16x32_bf16 v[16:19], a[32:35], a[16:19], v[16:19]
    ds_read_b128 a[8:11], v192 offset:40960
    v_mfma_f32_16x16x32_bf16 v[64:67], a[16:19], a[36:39], v[64:67]
    v_and_b32 v214, 31, v254
    v_mfma_f32_16x16x32_bf16 v[112:115], a[40:43], a[16:19], v[112:115]
    ds_read_b64_tr_b16 a[46:47], v196 offset:25600
    s_waitcnt lgkmcnt(6)
    v_mfma_f32_16x16x32_bf16 v[20:23], a[32:35], a[20:23], v[20:23]
    ds_read_b128 a[12:15], v192 offset:43008
    v_mfma_f32_16x16x32_bf16 v[68:71], a[20:23], a[36:39], v[68:71]
    s_add_u32 m0, s4, 65536
    s_mov_b32 s72, 393216
    buffer_load_dwordx4 v240, s[20:23], s72 offen lds
    v_mfma_f32_16x16x32_bf16 v[116:119], a[40:43], a[20:23], v[116:119]
    ds_read_b64_tr_b16 a[48:49], v197 offset:24576
    s_waitcnt lgkmcnt(7)
    v_mfma_f32_16x16x32_bf16 v[24:27], a[32:35], a[24:27], v[24:27]
    ds_read_b128 a[16:19], v194 offset:22528
    v_mfma_f32_16x16x32_bf16 v[72:75], a[24:27], a[36:39], v[72:75]
    buffer_load_dwordx4 v241, s[20:23], s72 offen offset:1024 lds
    v_mfma_f32_16x16x32_bf16 v[120:123], a[40:43], a[24:27], v[120:123]
    ds_read_b64_tr_b16 a[50:51], v197 offset:25600
    s_waitcnt lgkmcnt(8)
    v_mfma_f32_16x16x32_bf16 v[28:31], a[32:35], a[0:3], v[28:31]
    ds_read_b128 a[20:23], v194 offset:24576
    v_mfma_f32_16x16x32_bf16 v[76:79], a[0:3], a[36:39], v[76:79]
    v_lshl_add_u32 v212, v214, 6, v212
    v_mfma_f32_16x16x32_bf16 v[124:127], a[40:43], a[0:3], v[124:127]
    ds_read_b64_tr_b16 a[52:53], v198 offset:12288
    s_waitcnt lgkmcnt(9)
    v_mfma_f32_16x16x32_bf16 v[32:35], a[32:35], a[4:7], v[32:35]
    ds_read_b128 a[24:27], v194 offset:26624
    v_mfma_f32_16x16x32_bf16 v[80:83], a[4:7], a[36:39], v[80:83]
    buffer_load_dwordx4 v242, s[20:23], s72 offen offset:2048 lds
    v_mfma_f32_16x16x32_bf16 v[128:131], a[40:43], a[4:7], v[128:131]
    ds_read_b64_tr_b16 a[54:55], v198 offset:12800
    s_waitcnt lgkmcnt(9)
    v_mfma_f32_16x16x32_bf16 v[36:39], a[32:35], a[8:11], v[36:39]
    ds_read_b128 a[0:3], v194 offset:28672
    v_mfma_f32_16x16x32_bf16 v[84:87], a[8:11], a[36:39], v[84:87]
    buffer_load_dwordx4 v243, s[20:23], s72 offen offset:3072 lds
    v_mfma_f32_16x16x32_bf16 v[132:135], a[40:43], a[8:11], v[132:135]
    v_add_u32 v221, s37, v212
    s_waitcnt lgkmcnt(8)
    v_mfma_f32_16x16x32_bf16 v[40:43], a[32:35], a[12:15], v[40:43]
    ds_read_b128 a[4:7], v194 offset:30720
    v_mfma_f32_16x16x32_bf16 v[88:91], a[12:15], a[36:39], v[88:91]
    v_xor_b32 v222, 16, v221
    v_mfma_f32_16x16x32_bf16 v[136:139], a[40:43], a[12:15], v[136:139]
    v_bfe_u32 v212, v254, 2, 1
    s_waitcnt lgkmcnt(7)
    v_mfma_f32_16x16x32_bf16 v[0:3], a[44:47], a[16:19], v[0:3]
    ds_read_b128 a[8:11], v194 offset:32768
    s_waitcnt lgkmcnt(7)
    v_mfma_f32_16x16x32_bf16 v[48:51], a[16:19], a[48:51], v[48:51]
    v_sub_u32 v212, 0, v212
    s_waitcnt lgkmcnt(3)
    v_mfma_f32_16x16x32_bf16 v[96:99], a[52:55], a[16:19], v[96:99]
    v_and_b32 v212, 0x80008000, v212
    v_mfma_f32_16x16x32_bf16 v[4:7], a[44:47], a[20:23], v[4:7]
    ds_read_b128 a[12:15], v194 offset:34816
    v_mfma_f32_16x16x32_bf16 v[52:55], a[20:23], a[48:51], v[52:55]
    buffer_load_dword v239, v255, s[24:27], s33 offen
    v_mfma_f32_16x16x32_bf16 v[100:103], a[52:55], a[20:23], v[100:103]
    v_xor_b32 v144, v144, v212
    v_mfma_f32_16x16x32_bf16 v[8:11], a[44:47], a[24:27], v[8:11]
    ds_read_b128 a[16:19], v194 offset:36864
    v_mfma_f32_16x16x32_bf16 v[56:59], a[24:27], a[48:51], v[56:59]
    s_waitcnt vmcnt(14)
    ds_read_b64_tr_b16 a[144:145], v232 offset:49152
    ds_read_b64_tr_b16 a[146:147], v232 offset:51200
    ds_read_b64_tr_b16 a[148:149], v233 offset:49152
    ds_read_b64_tr_b16 a[150:151], v233 offset:51200
    v_mfma_f32_16x16x32_bf16 v[104:107], a[52:55], a[24:27], v[104:107]
    v_xor_b32 v145, v145, v212
    s_waitcnt lgkmcnt(8)
    v_mfma_f32_16x16x32_bf16 v[12:15], a[44:47], a[0:3], v[12:15]
    ds_read_b128 a[20:23], v194 offset:38912
    v_mfma_f32_16x16x32_bf16 v[60:63], a[0:3], a[48:51], v[60:63]
    v_xor_b32 v146, v146, v212
    v_mfma_f32_16x16x32_bf16 v[108:111], a[52:55], a[0:3], v[108:111]
    v_xor_b32 v147, v147, v212
    s_waitcnt lgkmcnt(8)
    v_mfma_f32_16x16x32_bf16 v[16:19], a[44:47], a[4:7], v[16:19]
    ds_read_b128 a[24:27], v194 offset:40960
    v_mfma_f32_16x16x32_bf16 v[64:67], a[4:7], a[48:51], v[64:67]
    ds_read_b64_tr_b16 a[152:153], v234 offset:49152
    ds_read_b64_tr_b16 a[154:155], v234 offset:51200
    ds_read_b64_tr_b16 a[156:157], v235 offset:49152
    ds_read_b64_tr_b16 a[158:159], v235 offset:51200
    v_mfma_f32_16x16x32_bf16 v[112:115], a[52:55], a[4:7], v[112:115]
    v_min_u32 v214, 19, v214
    s_waitcnt lgkmcnt(12)
    v_mfma_f32_16x16x32_bf16 v[20:23], a[44:47], a[8:11], v[20:23]
    ds_read_b128 a[0:3], v194 offset:43008
    v_mfma_f32_16x16x32_bf16 v[68:71], a[8:11], a[48:51], v[68:71]
    s_waitcnt lgkmcnt(1)
    s_add_u32 m0, s4, 49152
    s_mov_b32 s72, 229376
    buffer_load_dwordx4 v240, s[20:23], s72 offen lds
    v_mfma_f32_16x16x32_bf16 v[116:119], a[52:55], a[8:11], v[116:119]
    v_mul_u32_u24 v213, 20, v213
    v_mfma_f32_16x16x32_bf16 v[24:27], a[44:47], a[12:15], v[24:27]
    v_add_u32 v214, v214, v213
    v_mfma_f32_16x16x32_bf16 v[72:75], a[12:15], a[48:51], v[72:75]
    s_waitcnt lgkmcnt(0)
    s_barrier
    v_mfma_f32_16x16x32_bf16 v[120:123], a[52:55], a[12:15], v[120:123]
    s_lshl_b32 s74, s66, 2
    s_add_u32 s74, s74, s64
    s_mul_i32 s74, s74, 15360
    s_add_u32 s74, s74, 12582912
    v_lshlrev_b32 v214, 4, v214
    v_add_u32 v225, s74, v214
    v_mfma_f32_16x16x32_bf16 v[28:31], a[44:47], a[16:19], v[28:31]
    v_and_b32 v226, 15, v254
    v_mfma_f32_16x16x32_bf16 v[76:79], a[16:19], a[48:51], v[76:79]
    v_lshlrev_b32 v226, 2, v226
    v_mfma_f32_16x16x32_bf16 v[124:127], a[52:55], a[16:19], v[124:127]
    v_mfma_f32_16x16x32_bf16 v[32:35], a[44:47], a[20:23], v[32:35]
    buffer_load_dword v239, v255, s[24:27], s34 offen
    v_mfma_f32_16x16x32_bf16 v[80:83], a[20:23], a[48:51], v[80:83]
    v_mfma_f32_16x16x32_bf16 v[128:131], a[52:55], a[20:23], v[128:131]
    v_mfma_f32_16x16x32_bf16 v[36:39], a[44:47], a[24:27], v[36:39]
    v_mfma_f32_16x16x32_bf16 v[84:87], a[24:27], a[48:51], v[84:87]
    v_mfma_f32_16x16x32_bf16 v[132:135], a[52:55], a[24:27], v[132:135]
    v_mfma_f32_16x16x32_bf16 v[40:43], a[44:47], a[0:3], v[40:43]
    v_mfma_f32_16x16x32_bf16 v[88:91], a[0:3], a[48:51], v[88:91]
    buffer_load_dwordx4 v241, s[20:23], s72 offen offset:1024 lds
    v_mfma_f32_16x16x32_bf16 v[136:139], a[52:55], a[0:3], v[136:139]
    v_mov_b32 v44, 0
    v_mov_b32 v45, 0
    v_mov_b32 v46, 0
    v_mov_b32 v47, 0
    v_mov_b32 v92, 0
    v_mov_b32 v93, 0
    v_mov_b32 v94, 0
    v_mov_b32 v95, 0
    v_mov_b32 v140, 0
    v_mov_b32 v141, 0
    v_mov_b32 v142, 0
    v_mov_b32 v143, 0
    v_cvt_pk_bf16_f32 v180, v0, v1
    v_cvt_pk_bf16_f32 v181, v2, v3
    v_cvt_pk_bf16_f32 v182, v4, v5
    v_cvt_pk_bf16_f32 v183, v6, v7
    v_cvt_pk_bf16_f32 v184, v8, v9
    v_cvt_pk_bf16_f32 v185, v10, v11
    v_cvt_pk_bf16_f32 v186, v12, v13
    v_cvt_pk_bf16_f32 v187, v14, v15
    v_permlane16_swap_b32 v180, v182
    v_permlane16_swap_b32 v181, v183
    v_permlane16_swap_b32 v184, v186
    v_permlane16_swap_b32 v185, v187
    v_mfma_f32_32x32x16_bf16 v[148:163], v[144:147], v[180:183], 0
    s_nop 0
    v_mfma_f32_32x32x16_bf16 v[164:179], v[144:147], v[184:187], 0
    s_nop 9
    v_max3_f32 v212, v148, v149, v150
    s_nop 0
    v_max3_f32 v214, v164, v165, v166
    v_max3_f32 v212, v212, v151, v152
    v_max3_f32 v214, v214, v167, v168
    v_max3_f32 v212, v212, v153, v154
    v_max3_f32 v214, v214, v169, v170
    v_max3_f32 v212, v212, v155, v156
    v_max3_f32 v214, v214, v171, v172
    v_max3_f32 v212, v212, v157, v158
    v_max3_f32 v214, v214, v173, v174
    v_max3_f32 v212, v212, v159, v160
    v_max3_f32 v214, v214, v175, v176
    v_max3_f32 v212, v212, v161, v162
    v_max3_f32 v214, v214, v177, v178
    v_max_f32 v212, v212, v163
    v_max_f32 v214, v214, v179
    v_mul_f32 v212, s79, v212
    v_mul_f32 v214, s79, v214
    v_pk_fma_f32 v[148:149], v[148:149], s[78:79], v[212:213] op_sel_hi:[1,0,0]
    v_pk_fma_f32 v[164:165], v[164:165], s[78:79], v[214:215] op_sel_hi:[1,0,0]
    v_exp_f32 v148, v148
    v_exp_f32 v149, v149
    v_exp_f32 v164, v164
    v_exp_f32 v165, v165
    buffer_load_dwordx4 v242, s[20:23], s72 offen offset:2048 lds
    v_pk_fma_f32 v[150:151], v[150:151], s[78:79], v[212:213] op_sel_hi:[1,0,0]
    v_pk_fma_f32 v[166:167], v[166:167], s[78:79], v[214:215] op_sel_hi:[1,0,0]
    v_exp_f32 v150, v150
    v_exp_f32 v151, v151
    v_exp_f32 v166, v166
    v_exp_f32 v167, v167
    buffer_load_dwordx4 v243, s[20:23], s72 offen offset:3072 lds
    v_pk_fma_f32 v[152:153], v[152:153], s[78:79], v[212:213] op_sel_hi:[1,0,0]
    v_pk_fma_f32 v[168:169], v[168:169], s[78:79], v[214:215] op_sel_hi:[1,0,0]
    v_exp_f32 v152, v152
    v_exp_f32 v153, v153
    v_exp_f32 v168, v168
    v_exp_f32 v169, v169
    s_add_u32 m0, s4, 114688
    s_mov_b32 s72, 32768
    buffer_load_dwordx4 v244, s[24:27], s72 offen lds
    v_pk_fma_f32 v[154:155], v[154:155], s[78:79], v[212:213] op_sel_hi:[1,0,0]
    v_pk_fma_f32 v[170:171], v[170:171], s[78:79], v[214:215] op_sel_hi:[1,0,0]
    v_exp_f32 v154, v154
    v_exp_f32 v155, v155
    v_exp_f32 v170, v170
    v_exp_f32 v171, v171
    v_pk_fma_f32 v[156:157], v[156:157], s[78:79], v[212:213] op_sel_hi:[1,0,0]
    v_pk_fma_f32 v[172:173], v[172:173], s[78:79], v[214:215] op_sel_hi:[1,0,0]
    v_exp_f32 v156, v156
    v_exp_f32 v157, v157
    v_exp_f32 v172, v172
    v_exp_f32 v173, v173
    buffer_load_dwordx4 v245, s[24:27], s72 offen offset:1024 lds
    v_pk_fma_f32 v[158:159], v[158:159], s[78:79], v[212:213] op_sel_hi:[1,0,0]
    v_pk_fma_f32 v[174:175], v[174:175], s[78:79], v[214:215] op_sel_hi:[1,0,0]
    v_exp_f32 v158, v158
    v_exp_f32 v159, v159
    v_exp_f32 v174, v174
    v_exp_f32 v175, v175
    buffer_load_dwordx4 v246, s[24:27], s72 offen offset:2048 lds
    v_pk_fma_f32 v[160:161], v[160:161], s[78:79], v[212:213] op_sel_hi:[1,0,0]
    v_pk_fma_f32 v[176:177], v[176:177], s[78:79], v[214:215] op_sel_hi:[1,0,0]
    v_exp_f32 v160, v160
    v_exp_f32 v161, v161
    v_exp_f32 v176, v176
    v_exp_f32 v177, v177
    buffer_load_dwordx4 v247, s[24:27], s72 offen offset:3072 lds
    v_pk_fma_f32 v[162:163], v[162:163], s[78:79], v[212:213] op_sel_hi:[1,0,0]
    v_pk_fma_f32 v[178:179], v[178:179], s[78:79], v[214:215] op_sel_hi:[1,0,0]
    v_exp_f32 v162, v162
    v_exp_f32 v163, v163
    v_exp_f32 v178, v178
    v_exp_f32 v179, v179
    v_pk_add_f32 v[216:217], v[148:149], v[150:151]
    v_pk_add_f32 v[218:219], v[164:165], v[166:167]
    v_pk_add_f32 v[216:217], v[216:217], v[152:153]
    v_pk_add_f32 v[218:219], v[218:219], v[168:169]
    v_pk_add_f32 v[216:217], v[216:217], v[154:155]
    v_pk_add_f32 v[218:219], v[218:219], v[170:171]
    v_pk_add_f32 v[216:217], v[216:217], v[156:157]
    v_pk_add_f32 v[218:219], v[218:219], v[172:173]
    v_pk_add_f32 v[216:217], v[216:217], v[158:159]
    v_pk_add_f32 v[218:219], v[218:219], v[174:175]
    v_pk_add_f32 v[216:217], v[216:217], v[160:161]
    v_pk_add_f32 v[218:219], v[218:219], v[176:177]
    v_pk_add_f32 v[216:217], v[216:217], v[162:163]
    v_pk_add_f32 v[218:219], v[218:219], v[178:179]
    v_add_f32 v216, v216, v217
    v_add_f32 v218, v218, v219
    v_rcp_f32 v216, v216
    v_rcp_f32 v218, v218
    v_pk_mul_f32 v[148:149], v[148:149], v[216:217] op_sel_hi:[1,0]
    v_pk_mul_f32 v[164:165], v[164:165], v[218:219] op_sel_hi:[1,0]
    v_cvt_pk_bf16_f32 v180, v148, v149
    v_cvt_pk_bf16_f32 v188, v164, v165
    v_pk_mul_f32 v[150:151], v[150:151], v[216:217] op_sel_hi:[1,0]
    v_pk_mul_f32 v[166:167], v[166:167], v[218:219] op_sel_hi:[1,0]
    v_cvt_pk_bf16_f32 v181, v150, v151
    v_cvt_pk_bf16_f32 v189, v166, v167
    v_pk_mul_f32 v[152:153], v[152:153], v[216:217] op_sel_hi:[1,0]
    v_pk_mul_f32 v[168:169], v[168:169], v[218:219] op_sel_hi:[1,0]
    v_cvt_pk_bf16_f32 v182, v152, v153
    v_cvt_pk_bf16_f32 v190, v168, v169
    v_pk_mul_f32 v[154:155], v[154:155], v[216:217] op_sel_hi:[1,0]
    v_pk_mul_f32 v[170:171], v[170:171], v[218:219] op_sel_hi:[1,0]
    v_cvt_pk_bf16_f32 v183, v154, v155
    v_cvt_pk_bf16_f32 v191, v170, v171
    v_pk_mul_f32 v[156:157], v[156:157], v[216:217] op_sel_hi:[1,0]
    v_pk_mul_f32 v[172:173], v[172:173], v[218:219] op_sel_hi:[1,0]
    v_cvt_pk_bf16_f32 v184, v156, v157
    v_cvt_pk_bf16_f32 v192, v172, v173
    v_pk_mul_f32 v[158:159], v[158:159], v[216:217] op_sel_hi:[1,0]
    v_pk_mul_f32 v[174:175], v[174:175], v[218:219] op_sel_hi:[1,0]
    v_cvt_pk_bf16_f32 v185, v158, v159
    v_cvt_pk_bf16_f32 v193, v174, v175
    v_pk_mul_f32 v[160:161], v[160:161], v[216:217] op_sel_hi:[1,0]
    v_pk_mul_f32 v[176:177], v[176:177], v[218:219] op_sel_hi:[1,0]
    v_cvt_pk_bf16_f32 v186, v160, v161
    v_cvt_pk_bf16_f32 v194, v176, v177
    v_pk_mul_f32 v[162:163], v[162:163], v[216:217] op_sel_hi:[1,0]
    v_pk_mul_f32 v[178:179], v[178:179], v[218:219] op_sel_hi:[1,0]
    v_cvt_pk_bf16_f32 v187, v162, v163
    v_cvt_pk_bf16_f32 v195, v178, v179
    ds_write_b128 v221, v[180:183]
    ds_write_b128 v222, v[184:187]
    ds_write_b128 v221, v[188:191] offset:2048
    ds_write_b128 v222, v[192:195] offset:2048
    s_cmp_gt_u32 s3, 0
    s_cselect_b32 s74, 0x3f803f80, 0
    v_cvt_pk_bf16_f32 v196, v48, v49
    v_mov_b32 v198, s74
    v_cvt_pk_bf16_f32 v197, v50, v51
    v_mov_b32 v199, s74
    s_cmp_gt_u32 s3, 1
    s_cselect_b32 s74, 0x3f803f80, 0
    v_cvt_pk_bf16_f32 v200, v52, v53
    v_mov_b32 v202, s74
    v_cvt_pk_bf16_f32 v201, v54, v55
    v_mov_b32 v203, s74
    s_cmp_gt_u32 s3, 2
    s_cselect_b32 s74, 0x3f803f80, 0
    v_cvt_pk_bf16_f32 v204, v56, v57
    v_mov_b32 v206, s74
    v_cvt_pk_bf16_f32 v205, v58, v59
    v_mov_b32 v207, s74
    s_cmp_gt_u32 s3, 3
    s_cselect_b32 s74, 0x3f803f80, 0
    v_cvt_pk_bf16_f32 v208, v60, v61
    v_mov_b32 v210, s74
    v_cvt_pk_bf16_f32 v209, v62, v63
    v_mov_b32 v211, s74
    v_permlane16_swap_b32 v196, v198
    v_permlane16_swap_b32 v197, v199
    v_permlane16_swap_b32 v200, v202
    v_permlane16_swap_b32 v201, v203
    v_permlane16_swap_b32 v204, v206
    v_permlane16_swap_b32 v205, v207
    v_permlane16_swap_b32 v208, v210
    v_permlane16_swap_b32 v209, v211
    ds_read_b64_tr_b16 a[16:17], v223
    ds_read_b64_tr_b16 a[18:19], v224 offset:256
    ds_read_b64_tr_b16 a[20:21], v223 offset:1024
    ds_read_b64_tr_b16 a[22:23], v224 offset:1280
    ds_read_b64_tr_b16 a[24:25], v223 offset:2048
    ds_read_b64_tr_b16 a[26:27], v224 offset:2304
    ds_read_b64_tr_b16 a[28:29], v223 offset:3072
    ds_read_b64_tr_b16 a[30:31], v224 offset:3328
    v_cvt_pk_bf16_f32 v180, v16, v17
    v_cvt_pk_bf16_f32 v181, v18, v19
    v_cvt_pk_bf16_f32 v182, v20, v21
    v_cvt_pk_bf16_f32 v183, v22, v23
    v_cvt_pk_bf16_f32 v184, v24, v25
    v_cvt_pk_bf16_f32 v185, v26, v27
    v_cvt_pk_bf16_f32 v186, v28, v29
    v_cvt_pk_bf16_f32 v187, v30, v31
    v_permlane16_swap_b32 v180, v182
    v_permlane16_swap_b32 v181, v183
    v_permlane16_swap_b32 v184, v186
    v_permlane16_swap_b32 v185, v187
    v_mfma_f32_32x32x16_bf16 v[148:163], v[144:147], v[180:183], 0
    s_nop 0
    v_mfma_f32_32x32x16_bf16 v[164:179], v[144:147], v[184:187], 0
    s_waitcnt lgkmcnt(6)
    v_mfma_f32_32x32x16_bf16 a[0:15], a[16:19], v[196:199], 0
    s_waitcnt lgkmcnt(4)
    v_mfma_f32_32x32x16_bf16 a[0:15], a[20:23], v[200:203], a[0:15]
    s_waitcnt lgkmcnt(2)
    v_mfma_f32_32x32x16_bf16 a[0:15], a[24:27], v[204:207], a[0:15]
    s_waitcnt lgkmcnt(0)
    v_mfma_f32_32x32x16_bf16 a[0:15], a[28:31], v[208:211], a[0:15]
    s_nop 1
    v_max3_f32 v212, v148, v149, v150
    s_nop 0
    v_max3_f32 v214, v164, v165, v166
    v_max3_f32 v212, v212, v151, v152
    v_max3_f32 v214, v214, v167, v168
    v_max3_f32 v212, v212, v153, v154
    v_max3_f32 v214, v214, v169, v170
    v_max3_f32 v212, v212, v155, v156
    v_max3_f32 v214, v214, v171, v172
    v_max3_f32 v212, v212, v157, v158
    v_max3_f32 v214, v214, v173, v174
    v_max3_f32 v212, v212, v159, v160
    v_max3_f32 v214, v214, v175, v176
    v_max3_f32 v212, v212, v161, v162
    v_max3_f32 v214, v214, v177, v178
    v_max_f32 v212, v212, v163
    v_max_f32 v214, v214, v179
    v_mul_f32 v212, s79, v212
    v_mul_f32 v214, s79, v214
    v_pk_fma_f32 v[148:149], v[148:149], s[78:79], v[212:213] op_sel_hi:[1,0,0]
    v_pk_fma_f32 v[164:165], v[164:165], s[78:79], v[214:215] op_sel_hi:[1,0,0]
    v_exp_f32 v148, v148
    v_exp_f32 v149, v149
    v_exp_f32 v164, v164
    v_exp_f32 v165, v165
    s_add_u32 m0, s4, 16384
    s_mov_b32 s72, 32768
    buffer_load_dwordx4 v240, s[20:23], s72 offen lds
    v_pk_fma_f32 v[150:151], v[150:151], s[78:79], v[212:213] op_sel_hi:[1,0,0]
    v_pk_fma_f32 v[166:167], v[166:167], s[78:79], v[214:215] op_sel_hi:[1,0,0]
    v_exp_f32 v150, v150
    v_exp_f32 v151, v151
    v_exp_f32 v166, v166
    v_exp_f32 v167, v167
    buffer_load_dwordx4 v241, s[20:23], s72 offen offset:1024 lds
    v_pk_fma_f32 v[152:153], v[152:153], s[78:79], v[212:213] op_sel_hi:[1,0,0]
    v_pk_fma_f32 v[168:169], v[168:169], s[78:79], v[214:215] op_sel_hi:[1,0,0]
    v_exp_f32 v152, v152
    v_exp_f32 v153, v153
    v_exp_f32 v168, v168
    v_exp_f32 v169, v169
    buffer_load_dwordx4 v242, s[20:23], s72 offen offset:2048 lds
    v_pk_fma_f32 v[154:155], v[154:155], s[78:79], v[212:213] op_sel_hi:[1,0,0]
    v_pk_fma_f32 v[170:171], v[170:171], s[78:79], v[214:215] op_sel_hi:[1,0,0]
    v_exp_f32 v154, v154
    v_exp_f32 v155, v155
    v_exp_f32 v170, v170
    v_exp_f32 v171, v171
    v_pk_fma_f32 v[156:157], v[156:157], s[78:79], v[212:213] op_sel_hi:[1,0,0]
    v_pk_fma_f32 v[172:173], v[172:173], s[78:79], v[214:215] op_sel_hi:[1,0,0]
    v_exp_f32 v156, v156
    v_exp_f32 v157, v157
    v_exp_f32 v172, v172
    v_exp_f32 v173, v173
    buffer_load_dwordx4 v243, s[20:23], s72 offen offset:3072 lds
    v_pk_fma_f32 v[158:159], v[158:159], s[78:79], v[212:213] op_sel_hi:[1,0,0]
    v_pk_fma_f32 v[174:175], v[174:175], s[78:79], v[214:215] op_sel_hi:[1,0,0]
    v_exp_f32 v158, v158
    v_exp_f32 v159, v159
    v_exp_f32 v174, v174
    v_exp_f32 v175, v175
    s_add_u32 m0, s4, 32768
    s_mov_b32 s72, 65536
    buffer_load_dwordx4 v240, s[20:23], s72 offen lds
    v_pk_fma_f32 v[160:161], v[160:161], s[78:79], v[212:213] op_sel_hi:[1,0,0]
    v_pk_fma_f32 v[176:177], v[176:177], s[78:79], v[214:215] op_sel_hi:[1,0,0]
    v_exp_f32 v160, v160
    v_exp_f32 v161, v161
    v_exp_f32 v176, v176
    v_exp_f32 v177, v177
    buffer_load_dwordx4 v241, s[20:23], s72 offen offset:1024 lds
    v_pk_fma_f32 v[162:163], v[162:163], s[78:79], v[212:213] op_sel_hi:[1,0,0]
    v_pk_fma_f32 v[178:179], v[178:179], s[78:79], v[214:215] op_sel_hi:[1,0,0]
    v_exp_f32 v162, v162
    v_exp_f32 v163, v163
    v_exp_f32 v178, v178
    v_exp_f32 v179, v179
    v_pk_add_f32 v[216:217], v[148:149], v[150:151]
    v_pk_add_f32 v[218:219], v[164:165], v[166:167]
    v_pk_add_f32 v[216:217], v[216:217], v[152:153]
    v_pk_add_f32 v[218:219], v[218:219], v[168:169]
    v_pk_add_f32 v[216:217], v[216:217], v[154:155]
    v_pk_add_f32 v[218:219], v[218:219], v[170:171]
    v_pk_add_f32 v[216:217], v[216:217], v[156:157]
    v_pk_add_f32 v[218:219], v[218:219], v[172:173]
    v_pk_add_f32 v[216:217], v[216:217], v[158:159]
    v_pk_add_f32 v[218:219], v[218:219], v[174:175]
    v_pk_add_f32 v[216:217], v[216:217], v[160:161]
    v_pk_add_f32 v[218:219], v[218:219], v[176:177]
    v_pk_add_f32 v[216:217], v[216:217], v[162:163]
    v_pk_add_f32 v[218:219], v[218:219], v[178:179]
    v_add_f32 v216, v216, v217
    v_add_f32 v218, v218, v219
    v_rcp_f32 v216, v216
    v_rcp_f32 v218, v218
    v_pk_mul_f32 v[148:149], v[148:149], v[216:217] op_sel_hi:[1,0]
    v_pk_mul_f32 v[164:165], v[164:165], v[218:219] op_sel_hi:[1,0]
    v_cvt_pk_bf16_f32 v180, v148, v149
    v_cvt_pk_bf16_f32 v188, v164, v165
    v_pk_mul_f32 v[150:151], v[150:151], v[216:217] op_sel_hi:[1,0]
    v_pk_mul_f32 v[166:167], v[166:167], v[218:219] op_sel_hi:[1,0]
    v_cvt_pk_bf16_f32 v181, v150, v151
    v_cvt_pk_bf16_f32 v189, v166, v167
    v_pk_mul_f32 v[152:153], v[152:153], v[216:217] op_sel_hi:[1,0]
    v_pk_mul_f32 v[168:169], v[168:169], v[218:219] op_sel_hi:[1,0]
    v_cvt_pk_bf16_f32 v182, v152, v153
    v_cvt_pk_bf16_f32 v190, v168, v169
    v_pk_mul_f32 v[154:155], v[154:155], v[216:217] op_sel_hi:[1,0]
    v_pk_mul_f32 v[170:171], v[170:171], v[218:219] op_sel_hi:[1,0]
    v_cvt_pk_bf16_f32 v183, v154, v155
    v_cvt_pk_bf16_f32 v191, v170, v171
    v_pk_mul_f32 v[156:157], v[156:157], v[216:217] op_sel_hi:[1,0]
    v_pk_mul_f32 v[172:173], v[172:173], v[218:219] op_sel_hi:[1,0]
    v_cvt_pk_bf16_f32 v184, v156, v157
    v_cvt_pk_bf16_f32 v192, v172, v173
    v_pk_mul_f32 v[158:159], v[158:159], v[216:217] op_sel_hi:[1,0]
    v_pk_mul_f32 v[174:175], v[174:175], v[218:219] op_sel_hi:[1,0]
    v_cvt_pk_bf16_f32 v185, v158, v159
    v_cvt_pk_bf16_f32 v193, v174, v175
    v_pk_mul_f32 v[160:161], v[160:161], v[216:217] op_sel_hi:[1,0]
    v_pk_mul_f32 v[176:177], v[176:177], v[218:219] op_sel_hi:[1,0]
    v_cvt_pk_bf16_f32 v186, v160, v161
    v_cvt_pk_bf16_f32 v194, v176, v177
    v_pk_mul_f32 v[162:163], v[162:163], v[216:217] op_sel_hi:[1,0]
    v_pk_mul_f32 v[178:179], v[178:179], v[218:219] op_sel_hi:[1,0]
    v_cvt_pk_bf16_f32 v187, v162, v163
    v_cvt_pk_bf16_f32 v195, v178, v179
    ds_write_b128 v221, v[180:183]
    ds_write_b128 v222, v[184:187]
    ds_write_b128 v221, v[188:191] offset:2048
    ds_write_b128 v222, v[192:195] offset:2048
    s_cmp_gt_u32 s3, 4
    s_cselect_b32 s74, 0x3f803f80, 0
    v_cvt_pk_bf16_f32 v196, v64, v65
    v_mov_b32 v198, s74
    v_cvt_pk_bf16_f32 v197, v66, v67
    v_mov_b32 v199, s74
    s_cmp_gt_u32 s3, 5
    s_cselect_b32 s74, 0x3f803f80, 0
    v_cvt_pk_bf16_f32 v200, v68, v69
    v_mov_b32 v202, s74
    v_cvt_pk_bf16_f32 v201, v70, v71
    v_mov_b32 v203, s74
    s_cmp_gt_u32 s3, 6
    s_cselect_b32 s74, 0x3f803f80, 0
    v_cvt_pk_bf16_f32 v204, v72, v73
    v_mov_b32 v206, s74
    v_cvt_pk_bf16_f32 v205, v74, v75
    v_mov_b32 v207, s74
    s_cmp_gt_u32 s3, 7
    s_cselect_b32 s74, 0x3f803f80, 0
    v_cvt_pk_bf16_f32 v208, v76, v77
    v_mov_b32 v210, s74
    v_cvt_pk_bf16_f32 v209, v78, v79
    v_mov_b32 v211, s74
    v_permlane16_swap_b32 v196, v198
    v_permlane16_swap_b32 v197, v199
    v_permlane16_swap_b32 v200, v202
    v_permlane16_swap_b32 v201, v203
    v_permlane16_swap_b32 v204, v206
    v_permlane16_swap_b32 v205, v207
    v_permlane16_swap_b32 v208, v210
    v_permlane16_swap_b32 v209, v211
    ds_read_b64_tr_b16 a[16:17], v223
    ds_read_b64_tr_b16 a[18:19], v224 offset:256
    ds_read_b64_tr_b16 a[20:21], v223 offset:1024
    ds_read_b64_tr_b16 a[22:23], v224 offset:1280
    ds_read_b64_tr_b16 a[24:25], v223 offset:2048
    ds_read_b64_tr_b16 a[26:27], v224 offset:2304
    ds_read_b64_tr_b16 a[28:29], v223 offset:3072
    ds_read_b64_tr_b16 a[30:31], v224 offset:3328
    v_cvt_pk_bf16_f32 v180, v32, v33
    v_cvt_pk_bf16_f32 v181, v34, v35
    v_cvt_pk_bf16_f32 v182, v36, v37
    v_cvt_pk_bf16_f32 v183, v38, v39
    v_cvt_pk_bf16_f32 v184, v40, v41
    v_cvt_pk_bf16_f32 v185, v42, v43
    v_cvt_pk_bf16_f32 v186, v44, v45
    v_cvt_pk_bf16_f32 v187, v46, v47
    v_permlane16_swap_b32 v180, v182
    v_permlane16_swap_b32 v181, v183
    v_permlane16_swap_b32 v184, v186
    v_permlane16_swap_b32 v185, v187
    v_mfma_f32_32x32x16_bf16 v[148:163], v[144:147], v[180:183], 0
    s_nop 0
    v_mfma_f32_32x32x16_bf16 v[164:179], v[144:147], v[184:187], 0
    s_waitcnt lgkmcnt(6)
    v_mfma_f32_32x32x16_bf16 a[0:15], a[16:19], v[196:199], a[0:15]
    s_waitcnt lgkmcnt(4)
    v_mfma_f32_32x32x16_bf16 a[0:15], a[20:23], v[200:203], a[0:15]
    s_waitcnt lgkmcnt(2)
    v_mfma_f32_32x32x16_bf16 a[0:15], a[24:27], v[204:207], a[0:15]
    s_waitcnt lgkmcnt(0)
    v_mfma_f32_32x32x16_bf16 a[0:15], a[28:31], v[208:211], a[0:15]
    s_nop 1
    v_max3_f32 v212, v148, v149, v150
    s_nop 0
    v_max3_f32 v214, v164, v165, v166
    v_max3_f32 v212, v212, v151, v152
    v_max3_f32 v214, v214, v167, v168
    v_max3_f32 v212, v212, v153, v154
    v_max3_f32 v214, v214, v169, v170
    v_max3_f32 v212, v212, v155, v156
    v_max3_f32 v214, v214, v171, v172
    v_max3_f32 v212, v212, v157, v158
    v_max3_f32 v214, v214, v173, v174
    v_max3_f32 v212, v212, v159, v160
    v_max3_f32 v214, v214, v175, v176
    v_max3_f32 v212, v212, v161, v162
    v_max3_f32 v214, v214, v177, v178
    v_max_f32 v212, v212, v163
    v_max_f32 v214, v214, v179
    v_mul_f32 v212, s79, v212
    v_mul_f32 v214, s79, v214
    v_pk_fma_f32 v[148:149], v[148:149], s[78:79], v[212:213] op_sel_hi:[1,0,0]
    v_pk_fma_f32 v[164:165], v[164:165], s[78:79], v[214:215] op_sel_hi:[1,0,0]
    v_exp_f32 v148, v148
    v_exp_f32 v149, v149
    v_exp_f32 v164, v164
    v_exp_f32 v165, v165
    buffer_load_dwordx4 v242, s[20:23], s72 offen offset:2048 lds
    v_pk_fma_f32 v[150:151], v[150:151], s[78:79], v[212:213] op_sel_hi:[1,0,0]
    v_pk_fma_f32 v[166:167], v[166:167], s[78:79], v[214:215] op_sel_hi:[1,0,0]
    v_exp_f32 v150, v150
    v_exp_f32 v151, v151
    v_exp_f32 v166, v166
    v_exp_f32 v167, v167
    buffer_load_dwordx4 v243, s[20:23], s72 offen offset:3072 lds
    v_pk_fma_f32 v[152:153], v[152:153], s[78:79], v[212:213] op_sel_hi:[1,0,0]
    v_pk_fma_f32 v[168:169], v[168:169], s[78:79], v[214:215] op_sel_hi:[1,0,0]
    v_exp_f32 v152, v152
    v_exp_f32 v153, v153
    v_exp_f32 v168, v168
    v_exp_f32 v169, v169
    s_waitcnt vmcnt(22)
    ds_read_b64_tr_b16 a[96:97], v232
    ds_read_b64_tr_b16 a[98:99], v232 offset:2048
    ds_read_b64_tr_b16 a[100:101], v233
    ds_read_b64_tr_b16 a[102:103], v233 offset:2048
    v_pk_fma_f32 v[154:155], v[154:155], s[78:79], v[212:213] op_sel_hi:[1,0,0]
    v_pk_fma_f32 v[170:171], v[170:171], s[78:79], v[214:215] op_sel_hi:[1,0,0]
    v_exp_f32 v154, v154
    v_exp_f32 v155, v155
    v_exp_f32 v170, v170
    v_exp_f32 v171, v171
    v_pk_fma_f32 v[156:157], v[156:157], s[78:79], v[212:213] op_sel_hi:[1,0,0]
    v_pk_fma_f32 v[172:173], v[172:173], s[78:79], v[214:215] op_sel_hi:[1,0,0]
    v_exp_f32 v156, v156
    v_exp_f32 v157, v157
    v_exp_f32 v172, v172
    v_exp_f32 v173, v173
    ds_read_b64_tr_b16 a[104:105], v234
    ds_read_b64_tr_b16 a[106:107], v234 offset:2048
    ds_read_b64_tr_b16 a[108:109], v235
    ds_read_b64_tr_b16 a[110:111], v235 offset:2048
    v_pk_fma_f32 v[158:159], v[158:159], s[78:79], v[212:213] op_sel_hi:[1,0,0]
    v_pk_fma_f32 v[174:175], v[174:175], s[78:79], v[214:215] op_sel_hi:[1,0,0]
    v_exp_f32 v158, v158
    v_exp_f32 v159, v159
    v_exp_f32 v174, v174
    v_exp_f32 v175, v175
    s_waitcnt lgkmcnt(0)
    s_add_u32 m0, s4, 0
    s_mov_b32 s72, 131072
    buffer_load_dwordx4 v240, s[20:23], s72 offen lds
    v_pk_fma_f32 v[160:161], v[160:161], s[78:79], v[212:213] op_sel_hi:[1,0,0]
    v_pk_fma_f32 v[176:177], v[176:177], s[78:79], v[214:215] op_sel_hi:[1,0,0]
    v_exp_f32 v160, v160
    v_exp_f32 v161, v161
    v_exp_f32 v176, v176
    v_exp_f32 v177, v177
    buffer_load_dwordx4 v241, s[20:23], s72 offen offset:1024 lds
    v_pk_fma_f32 v[162:163], v[162:163], s[78:79], v[212:213] op_sel_hi:[1,0,0]
    v_pk_fma_f32 v[178:179], v[178:179], s[78:79], v[214:215] op_sel_hi:[1,0,0]
    v_exp_f32 v162, v162
    v_exp_f32 v163, v163
    v_exp_f32 v178, v178
    v_exp_f32 v179, v179
    v_pk_add_f32 v[216:217], v[148:149], v[150:151]
    v_pk_add_f32 v[218:219], v[164:165], v[166:167]
    v_pk_add_f32 v[216:217], v[216:217], v[152:153]
    v_pk_add_f32 v[218:219], v[218:219], v[168:169]
    v_pk_add_f32 v[216:217], v[216:217], v[154:155]
    v_pk_add_f32 v[218:219], v[218:219], v[170:171]
    v_pk_add_f32 v[216:217], v[216:217], v[156:157]
    v_pk_add_f32 v[218:219], v[218:219], v[172:173]
    v_pk_add_f32 v[216:217], v[216:217], v[158:159]
    v_pk_add_f32 v[218:219], v[218:219], v[174:175]
    v_pk_add_f32 v[216:217], v[216:217], v[160:161]
    v_pk_add_f32 v[218:219], v[218:219], v[176:177]
    v_pk_add_f32 v[216:217], v[216:217], v[162:163]
    v_pk_add_f32 v[218:219], v[218:219], v[178:179]
    v_add_f32 v216, v216, v217
    v_add_f32 v218, v218, v219
    v_rcp_f32 v216, v216
    v_rcp_f32 v218, v218
    v_pk_mul_f32 v[148:149], v[148:149], v[216:217] op_sel_hi:[1,0]
    v_pk_mul_f32 v[164:165], v[164:165], v[218:219] op_sel_hi:[1,0]
    v_cvt_pk_bf16_f32 v180, v148, v149
    v_cvt_pk_bf16_f32 v188, v164, v165
    v_pk_mul_f32 v[150:151], v[150:151], v[216:217] op_sel_hi:[1,0]
    v_pk_mul_f32 v[166:167], v[166:167], v[218:219] op_sel_hi:[1,0]
    v_cvt_pk_bf16_f32 v181, v150, v151
    v_cvt_pk_bf16_f32 v189, v166, v167
    v_pk_mul_f32 v[152:153], v[152:153], v[216:217] op_sel_hi:[1,0]
    v_pk_mul_f32 v[168:169], v[168:169], v[218:219] op_sel_hi:[1,0]
    v_cvt_pk_bf16_f32 v182, v152, v153
    v_cvt_pk_bf16_f32 v190, v168, v169
    v_pk_mul_f32 v[154:155], v[154:155], v[216:217] op_sel_hi:[1,0]
    v_pk_mul_f32 v[170:171], v[170:171], v[218:219] op_sel_hi:[1,0]
    v_cvt_pk_bf16_f32 v183, v154, v155
    v_cvt_pk_bf16_f32 v191, v170, v171
    v_pk_mul_f32 v[156:157], v[156:157], v[216:217] op_sel_hi:[1,0]
    v_pk_mul_f32 v[172:173], v[172:173], v[218:219] op_sel_hi:[1,0]
    v_cvt_pk_bf16_f32 v184, v156, v157
    v_cvt_pk_bf16_f32 v192, v172, v173
    v_pk_mul_f32 v[158:159], v[158:159], v[216:217] op_sel_hi:[1,0]
    v_pk_mul_f32 v[174:175], v[174:175], v[218:219] op_sel_hi:[1,0]
    v_cvt_pk_bf16_f32 v185, v158, v159
    v_cvt_pk_bf16_f32 v193, v174, v175
    v_pk_mul_f32 v[160:161], v[160:161], v[216:217] op_sel_hi:[1,0]
    v_pk_mul_f32 v[176:177], v[176:177], v[218:219] op_sel_hi:[1,0]
    v_cvt_pk_bf16_f32 v186, v160, v161
    v_cvt_pk_bf16_f32 v194, v176, v177
    v_pk_mul_f32 v[162:163], v[162:163], v[216:217] op_sel_hi:[1,0]
    v_pk_mul_f32 v[178:179], v[178:179], v[218:219] op_sel_hi:[1,0]
    v_cvt_pk_bf16_f32 v187, v162, v163
    v_cvt_pk_bf16_f32 v195, v178, v179
    ds_write_b128 v221, v[180:183]
    ds_write_b128 v222, v[184:187]
    ds_write_b128 v221, v[188:191] offset:2048
    ds_write_b128 v222, v[192:195] offset:2048
    s_cmp_gt_u32 s3, 8
    s_cselect_b32 s74, 0x3f803f80, 0
    v_cvt_pk_bf16_f32 v196, v80, v81
    v_mov_b32 v198, s74
    v_cvt_pk_bf16_f32 v197, v82, v83
    v_mov_b32 v199, s74
    s_cmp_gt_u32 s3, 9
    s_cselect_b32 s74, 0x3f803f80, 0
    v_cvt_pk_bf16_f32 v200, v84, v85
    v_mov_b32 v202, s74
    v_cvt_pk_bf16_f32 v201, v86, v87
    v_mov_b32 v203, s74
    s_cmp_gt_u32 s3, 10
    s_cselect_b32 s74, 0x3f803f80, 0
    v_cvt_pk_bf16_f32 v204, v88, v89
    v_mov_b32 v206, s74
    v_cvt_pk_bf16_f32 v205, v90, v91
    v_mov_b32 v207, s74
    s_cmp_gt_u32 s3, 11
    s_cselect_b32 s74, 0x3f803f80, 0
    v_cvt_pk_bf16_f32 v208, v92, v93
    v_mov_b32 v210, s74
    v_cvt_pk_bf16_f32 v209, v94, v95
    v_mov_b32 v211, s74
    v_permlane16_swap_b32 v196, v198
    v_permlane16_swap_b32 v197, v199
    v_permlane16_swap_b32 v200, v202
    v_permlane16_swap_b32 v201, v203
    v_permlane16_swap_b32 v204, v206
    v_permlane16_swap_b32 v205, v207
    v_permlane16_swap_b32 v208, v210
    v_permlane16_swap_b32 v209, v211
    ds_read_b64_tr_b16 a[16:17], v223
    ds_read_b64_tr_b16 a[18:19], v224 offset:256
    ds_read_b64_tr_b16 a[20:21], v223 offset:1024
    ds_read_b64_tr_b16 a[22:23], v224 offset:1280
    ds_read_b64_tr_b16 a[24:25], v223 offset:2048
    ds_read_b64_tr_b16 a[26:27], v224 offset:2304
    ds_read_b64_tr_b16 a[28:29], v223 offset:3072
    ds_read_b64_tr_b16 a[30:31], v224 offset:3328
    s_waitcnt lgkmcnt(6)
    v_mfma_f32_32x32x16_bf16 a[0:15], a[16:19], v[196:199], a[0:15]
    s_waitcnt lgkmcnt(4)
    v_mfma_f32_32x32x16_bf16 a[0:15], a[20:23], v[200:203], a[0:15]
    s_waitcnt lgkmcnt(2)
    v_mfma_f32_32x32x16_bf16 a[0:15], a[24:27], v[204:207], a[0:15]
    s_waitcnt lgkmcnt(0)
    v_mfma_f32_32x32x16_bf16 a[0:15], a[28:31], v[208:211], a[0:15]
    v_readfirstlane_b32 s38, v251
    s_nop 0
    s_add_u32 s38, s38, 0x9e3779b9
    s_mul_i32 s74, s65, 1280
    s_nop 7
    v_accvgpr_read_b32 v148, a0
    v_accvgpr_read_b32 v149, a1
    v_accvgpr_read_b32 v150, a2
    v_accvgpr_read_b32 v151, a3
    v_accvgpr_read_b32 v152, a4
    v_accvgpr_read_b32 v153, a5
    v_accvgpr_read_b32 v154, a6
    v_accvgpr_read_b32 v155, a7
    v_accvgpr_read_b32 v156, a8
    v_accvgpr_read_b32 v157, a9
    v_accvgpr_read_b32 v158, a10
    v_accvgpr_read_b32 v159, a11
    v_accvgpr_read_b32 v160, a12
    v_accvgpr_read_b32 v161, a13
    v_accvgpr_read_b32 v162, a14
    v_accvgpr_read_b32 v163, a15
    v_cvt_pk_bf16_f32 v0, v148, v149
    v_cvt_pk_bf16_f32 v1, v150, v151
    v_cvt_pk_bf16_f32 v2, v152, v153
    v_cvt_pk_bf16_f32 v3, v154, v155
    v_cvt_pk_bf16_f32 v4, v156, v157
    v_cvt_pk_bf16_f32 v5, v158, v159
    v_cvt_pk_bf16_f32 v6, v160, v161
    v_cvt_pk_bf16_f32 v7, v162, v163
    s_mov_b32 exec_lo, 0x000fffff
    s_mov_b32 exec_hi, 0x000fffff
    buffer_store_dwordx4 v[0:3], v225, s[16:19], s74 offen sc1
    buffer_store_dwordx4 v[4:7], v225, s[16:19], s74 offen offset:640 sc1
    s_mov_b32 exec_lo, -1
    s_mov_b32 exec_hi, -1
    v_cvt_pk_bf16_f32 v180, v96, v97
    v_cvt_pk_bf16_f32 v181, v98, v99
    v_cvt_pk_bf16_f32 v182, v100, v101
    v_cvt_pk_bf16_f32 v183, v102, v103
    v_cvt_pk_bf16_f32 v184, v104, v105
    v_cvt_pk_bf16_f32 v185, v106, v107
    v_cvt_pk_bf16_f32 v186, v108, v109
    v_cvt_pk_bf16_f32 v187, v110, v111
    v_permlane16_swap_b32 v180, v182
    v_permlane16_swap_b32 v181, v183
    v_permlane16_swap_b32 v184, v186
    v_permlane16_swap_b32 v185, v187
    v_mfma_f32_32x32x16_bf16 v[148:163], v[144:147], v[180:183], 0
    s_nop 0
    v_mfma_f32_32x32x16_bf16 v[164:179], v[144:147], v[184:187], 0
    s_nop 9
    v_max3_f32 v212, v148, v149, v150
    s_nop 0
    v_max3_f32 v214, v164, v165, v166
    v_max3_f32 v212, v212, v151, v152
    v_max3_f32 v214, v214, v167, v168
    v_max3_f32 v212, v212, v153, v154
    v_max3_f32 v214, v214, v169, v170
    v_max3_f32 v212, v212, v155, v156
    v_max3_f32 v214, v214, v171, v172
    v_max3_f32 v212, v212, v157, v158
    v_max3_f32 v214, v214, v173, v174
    v_max3_f32 v212, v212, v159, v160
    v_max3_f32 v214, v214, v175, v176
    v_max3_f32 v212, v212, v161, v162
    v_max3_f32 v214, v214, v177, v178
    v_max_f32 v212, v212, v163
    v_max_f32 v214, v214, v179
    v_mul_f32 v212, s79, v212
    v_mul_f32 v214, s79, v214
    s_add_u32 m0, s4, 147456
    s_mov_b32 s72, 98304
    buffer_load_dwordx4 v244, s[24:27], s72 offen lds
    buffer_load_dwordx4 v245, s[24:27], s72 offen offset:1024 lds
    v_pk_fma_f32 v[148:149], v[148:149], s[78:79], v[212:213] op_sel_hi:[1,0,0]
    v_pk_fma_f32 v[164:165], v[164:165], s[78:79], v[214:215] op_sel_hi:[1,0,0]
    v_exp_f32 v148, v148
    v_exp_f32 v149, v149
    v_exp_f32 v164, v164
    v_exp_f32 v165, v165
    buffer_load_dwordx4 v246, s[24:27], s72 offen offset:2048 lds
    buffer_load_dwordx4 v247, s[24:27], s72 offen offset:3072 lds
    v_pk_fma_f32 v[150:151], v[150:151], s[78:79], v[212:213] op_sel_hi:[1,0,0]
    v_pk_fma_f32 v[166:167], v[166:167], s[78:79], v[214:215] op_sel_hi:[1,0,0]
    v_exp_f32 v150, v150
    v_exp_f32 v151, v151
    v_exp_f32 v166, v166
    v_exp_f32 v167, v167
    s_add_u32 m0, s4, 0
    s_mov_b32 s72, 131072
    buffer_load_dwordx4 v242, s[20:23], s72 offen offset:2048 lds
    buffer_load_dwordx4 v243, s[20:23], s72 offen offset:3072 lds
    v_pk_fma_f32 v[152:153], v[152:153], s[78:79], v[212:213] op_sel_hi:[1,0,0]
    v_pk_fma_f32 v[168:169], v[168:169], s[78:79], v[214:215] op_sel_hi:[1,0,0]
    v_exp_f32 v152, v152
    v_exp_f32 v153, v153
    v_exp_f32 v168, v168
    v_exp_f32 v169, v169
    s_add_u32 m0, s4, 81920
    s_mov_b32 s72, 425984
    buffer_load_dwordx4 v240, s[20:23], s72 offen lds
    buffer_load_dwordx4 v241, s[20:23], s72 offen offset:1024 lds
    v_pk_fma_f32 v[154:155], v[154:155], s[78:79], v[212:213] op_sel_hi:[1,0,0]
    v_pk_fma_f32 v[170:171], v[170:171], s[78:79], v[214:215] op_sel_hi:[1,0,0]
    v_exp_f32 v154, v154
    v_exp_f32 v155, v155
    v_exp_f32 v170, v170
    v_exp_f32 v171, v171
    buffer_load_dwordx4 v242, s[20:23], s72 offen offset:2048 lds
    buffer_load_dwordx4 v243, s[20:23], s72 offen offset:3072 lds
    v_pk_fma_f32 v[156:157], v[156:157], s[78:79], v[212:213] op_sel_hi:[1,0,0]
    v_pk_fma_f32 v[172:173], v[172:173], s[78:79], v[214:215] op_sel_hi:[1,0,0]
    v_exp_f32 v156, v156
    v_exp_f32 v157, v157
    v_exp_f32 v172, v172
    v_exp_f32 v173, v173
    s_waitcnt vmcnt(18)
    ds_read_b64_tr_b16 a[112:113], v232 offset:16384
    ds_read_b64_tr_b16 a[114:115], v232 offset:18432
    ds_read_b64_tr_b16 a[116:117], v233 offset:16384
    ds_read_b64_tr_b16 a[118:119], v233 offset:18432
    ds_read_b64_tr_b16 a[120:121], v234 offset:16384
    ds_read_b64_tr_b16 a[122:123], v234 offset:18432
    ds_read_b64_tr_b16 a[124:125], v235 offset:16384
    ds_read_b64_tr_b16 a[126:127], v235 offset:18432
    v_pk_fma_f32 v[158:159], v[158:159], s[78:79], v[212:213] op_sel_hi:[1,0,0]
    v_pk_fma_f32 v[174:175], v[174:175], s[78:79], v[214:215] op_sel_hi:[1,0,0]
    v_exp_f32 v158, v158
    v_exp_f32 v159, v159
    v_exp_f32 v174, v174
    v_exp_f32 v175, v175
    s_waitcnt lgkmcnt(0)
    s_add_u32 m0, s4, 16384
    s_mov_b32 s72, 163840
    buffer_load_dwordx4 v240, s[20:23], s72 offen lds
    buffer_load_dwordx4 v241, s[20:23], s72 offen offset:1024 lds
    v_pk_fma_f32 v[160:161], v[160:161], s[78:79], v[212:213] op_sel_hi:[1,0,0]
    v_pk_fma_f32 v[176:177], v[176:177], s[78:79], v[214:215] op_sel_hi:[1,0,0]
    v_exp_f32 v160, v160
    v_exp_f32 v161, v161
    v_exp_f32 v176, v176
    v_exp_f32 v177, v177
    buffer_load_dwordx4 v242, s[20:23], s72 offen offset:2048 lds
    buffer_load_dwordx4 v243, s[20:23], s72 offen offset:3072 lds
    v_pk_fma_f32 v[162:163], v[162:163], s[78:79], v[212:213] op_sel_hi:[1,0,0]
    v_pk_fma_f32 v[178:179], v[178:179], s[78:79], v[214:215] op_sel_hi:[1,0,0]
    v_exp_f32 v162, v162
    v_exp_f32 v163, v163
    v_exp_f32 v178, v178
    v_exp_f32 v179, v179
    v_pk_add_f32 v[216:217], v[148:149], v[150:151]
    v_pk_add_f32 v[218:219], v[164:165], v[166:167]
    v_pk_add_f32 v[216:217], v[216:217], v[152:153]
    v_pk_add_f32 v[218:219], v[218:219], v[168:169]
    v_pk_add_f32 v[216:217], v[216:217], v[154:155]
    v_pk_add_f32 v[218:219], v[218:219], v[170:171]
    v_pk_add_f32 v[216:217], v[216:217], v[156:157]
    v_pk_add_f32 v[218:219], v[218:219], v[172:173]
    v_pk_add_f32 v[216:217], v[216:217], v[158:159]
    v_pk_add_f32 v[218:219], v[218:219], v[174:175]
    v_pk_add_f32 v[216:217], v[216:217], v[160:161]
    v_pk_add_f32 v[218:219], v[218:219], v[176:177]
    v_pk_add_f32 v[216:217], v[216:217], v[162:163]
    v_pk_add_f32 v[218:219], v[218:219], v[178:179]
    v_add_f32 v216, v216, v217
    v_add_f32 v218, v218, v219
    v_rcp_f32 v216, v216
    v_rcp_f32 v218, v218
    v_pk_mul_f32 v[148:149], v[148:149], v[216:217] op_sel_hi:[1,0]
    v_pk_mul_f32 v[164:165], v[164:165], v[218:219] op_sel_hi:[1,0]
    v_cvt_pk_bf16_f32 v96, v148, v149
    v_cvt_pk_bf16_f32 v104, v164, v165
    v_pk_mul_f32 v[150:151], v[150:151], v[216:217] op_sel_hi:[1,0]
    v_pk_mul_f32 v[166:167], v[166:167], v[218:219] op_sel_hi:[1,0]
    v_cvt_pk_bf16_f32 v97, v150, v151
    v_cvt_pk_bf16_f32 v105, v166, v167
    v_pk_mul_f32 v[152:153], v[152:153], v[216:217] op_sel_hi:[1,0]
    v_pk_mul_f32 v[168:169], v[168:169], v[218:219] op_sel_hi:[1,0]
    v_cvt_pk_bf16_f32 v98, v152, v153
    v_cvt_pk_bf16_f32 v106, v168, v169
    v_pk_mul_f32 v[154:155], v[154:155], v[216:217] op_sel_hi:[1,0]
    v_pk_mul_f32 v[170:171], v[170:171], v[218:219] op_sel_hi:[1,0]
    v_cvt_pk_bf16_f32 v99, v154, v155
    v_cvt_pk_bf16_f32 v107, v170, v171
    v_pk_mul_f32 v[156:157], v[156:157], v[216:217] op_sel_hi:[1,0]
    v_pk_mul_f32 v[172:173], v[172:173], v[218:219] op_sel_hi:[1,0]
    v_cvt_pk_bf16_f32 v100, v156, v157
    v_cvt_pk_bf16_f32 v108, v172, v173
    v_pk_mul_f32 v[158:159], v[158:159], v[216:217] op_sel_hi:[1,0]
    v_pk_mul_f32 v[174:175], v[174:175], v[218:219] op_sel_hi:[1,0]
    v_cvt_pk_bf16_f32 v101, v158, v159
    v_cvt_pk_bf16_f32 v109, v174, v175
    v_pk_mul_f32 v[160:161], v[160:161], v[216:217] op_sel_hi:[1,0]
    v_pk_mul_f32 v[176:177], v[176:177], v[218:219] op_sel_hi:[1,0]
    v_cvt_pk_bf16_f32 v102, v160, v161
    v_cvt_pk_bf16_f32 v110, v176, v177
    v_pk_mul_f32 v[162:163], v[162:163], v[216:217] op_sel_hi:[1,0]
    v_pk_mul_f32 v[178:179], v[178:179], v[218:219] op_sel_hi:[1,0]
    v_cvt_pk_bf16_f32 v103, v162, v163
    v_cvt_pk_bf16_f32 v111, v178, v179
    s_waitcnt vmcnt(14)
    s_barrier
    s_cmp_lg_u32 s64, 0
    s_cbranch_scc1 L_skip_8
    v_mov_b32 v252, s38
    s_mov_b32 exec_lo, 1
    s_mov_b32 exec_hi, 0
    buffer_store_dword v252, off, s[16:19], s76 sc1
    s_mov_b32 exec_lo, -1
    s_mov_b32 exec_hi, -1
L_skip_8:
    v_cvt_pk_bf16_f32 v180, v112, v113
    v_cvt_pk_bf16_f32 v181, v114, v115
    v_cvt_pk_bf16_f32 v182, v116, v117
    v_cvt_pk_bf16_f32 v183, v118, v119
    v_cvt_pk_bf16_f32 v184, v120, v121
    v_cvt_pk_bf16_f32 v185, v122, v123
    v_cvt_pk_bf16_f32 v186, v124, v125
    v_cvt_pk_bf16_f32 v187, v126, v127
    v_permlane16_swap_b32 v180, v182
    v_permlane16_swap_b32 v181, v183
    v_permlane16_swap_b32 v184, v186
    v_permlane16_swap_b32 v185, v187
    v_mfma_f32_32x32x16_bf16 v[148:163], v[144:147], v[180:183], 0
    s_nop 0
    v_mfma_f32_32x32x16_bf16 v[164:179], v[144:147], v[184:187], 0
    s_nop 9
    v_max3_f32 v212, v148, v149, v150
    s_nop 0
    v_max3_f32 v214, v164, v165, v166
    v_max3_f32 v212, v212, v151, v152
    v_max3_f32 v214, v214, v167, v168
    v_max3_f32 v212, v212, v153, v154
    v_max3_f32 v214, v214, v169, v170
    v_max3_f32 v212, v212, v155, v156
    v_max3_f32 v214, v214, v171, v172
    v_max3_f32 v212, v212, v157, v158
    v_max3_f32 v214, v214, v173, v174
    v_max3_f32 v212, v212, v159, v160
    v_max3_f32 v214, v214, v175, v176
    v_max3_f32 v212, v212, v161, v162
    v_max3_f32 v214, v214, v177, v178
    v_max_f32 v212, v212, v163
    v_max_f32 v214, v214, v179
    v_mul_f32 v212, s79, v212
    v_mul_f32 v214, s79, v214
    ds_read_b64_tr_b16 a[128:129], v232 offset:32768
    ds_read_b64_tr_b16 a[130:131], v232 offset:34816
    ds_read_b64_tr_b16 a[132:133], v233 offset:32768
    ds_read_b64_tr_b16 a[134:135], v233 offset:34816
    ds_read_b64_tr_b16 a[136:137], v234 offset:32768
    ds_read_b64_tr_b16 a[138:139], v234 offset:34816
    ds_read_b64_tr_b16 a[140:141], v235 offset:32768
    ds_read_b64_tr_b16 a[142:143], v235 offset:34816
    v_pk_fma_f32 v[148:149], v[148:149], s[78:79], v[212:213] op_sel_hi:[1,0,0]
    v_pk_fma_f32 v[164:165], v[164:165], s[78:79], v[214:215] op_sel_hi:[1,0,0]
    v_exp_f32 v148, v148
    v_exp_f32 v149, v149
    v_exp_f32 v164, v164
    v_exp_f32 v165, v165
    s_waitcnt lgkmcnt(0)
    s_add_u32 m0, s4, 32768
    s_mov_b32 s72, 196608
    buffer_load_dwordx4 v240, s[20:23], s72 offen lds
    buffer_load_dwordx4 v241, s[20:23], s72 offen offset:1024 lds
    v_pk_fma_f32 v[150:151], v[150:151], s[78:79], v[212:213] op_sel_hi:[1,0,0]
    v_pk_fma_f32 v[166:167], v[166:167], s[78:79], v[214:215] op_sel_hi:[1,0,0]
    v_exp_f32 v150, v150
    v_exp_f32 v151, v151
    v_exp_f32 v166, v166
    v_exp_f32 v167, v167
    buffer_load_dwordx4 v242, s[20:23], s72 offen offset:2048 lds
    buffer_load_dwordx4 v243, s[20:23], s72 offen offset:3072 lds
    v_pk_fma_f32 v[152:153], v[152:153], s[78:79], v[212:213] op_sel_hi:[1,0,0]
    v_pk_fma_f32 v[168:169], v[168:169], s[78:79], v[214:215] op_sel_hi:[1,0,0]
    v_exp_f32 v152, v152
    v_exp_f32 v153, v153
    v_exp_f32 v168, v168
    v_exp_f32 v169, v169
    ds_read_b64_tr_b16 a[208:209], v232 offset:49152
    ds_read_b64_tr_b16 a[210:211], v232 offset:51200
    ds_read_b64_tr_b16 a[212:213], v233 offset:49152
    ds_read_b64_tr_b16 a[214:215], v233 offset:51200
    ds_read_b64_tr_b16 a[216:217], v234 offset:49152
    ds_read_b64_tr_b16 a[218:219], v234 offset:51200
    ds_read_b64_tr_b16 a[220:221], v235 offset:49152
    ds_read_b64_tr_b16 a[222:223], v235 offset:51200
    v_pk_fma_f32 v[154:155], v[154:155], s[78:79], v[212:213] op_sel_hi:[1,0,0]
    v_pk_fma_f32 v[170:171], v[170:171], s[78:79], v[214:215] op_sel_hi:[1,0,0]
    v_exp_f32 v154, v154
    v_exp_f32 v155, v155
    v_exp_f32 v170, v170
    v_exp_f32 v171, v171
    s_add_u32 m0, s4, 98304
    s_mov_b32 s72, 0
    buffer_load_dwordx4 v244, s[24:27], s72 offen lds
    buffer_load_dwordx4 v245, s[24:27], s72 offen offset:1024 lds
    v_pk_fma_f32 v[156:157], v[156:157], s[78:79], v[212:213] op_sel_hi:[1,0,0]
    v_pk_fma_f32 v[172:173], v[172:173], s[78:79], v[214:215] op_sel_hi:[1,0,0]
    v_exp_f32 v156, v156
    v_exp_f32 v157, v157
    v_exp_f32 v172, v172
    v_exp_f32 v173, v173
    buffer_load_dwordx4 v246, s[24:27], s72 offen offset:2048 lds
    buffer_load_dwordx4 v247, s[24:27], s72 offen offset:3072 lds
    v_pk_fma_f32 v[158:159], v[158:159], s[78:79], v[212:213] op_sel_hi:[1,0,0]
    v_pk_fma_f32 v[174:175], v[174:175], s[78:79], v[214:215] op_sel_hi:[1,0,0]
    v_exp_f32 v158, v158
    v_exp_f32 v159, v159
    v_exp_f32 v174, v174
    v_exp_f32 v175, v175
    s_waitcnt vmcnt(16)
    ds_read_b64_tr_b16 a[160:161], v232
    ds_read_b64_tr_b16 a[162:163], v232 offset:2048
    ds_read_b64_tr_b16 a[164:165], v233
    ds_read_b64_tr_b16 a[166:167], v233 offset:2048
    ds_read_b64_tr_b16 a[168:169], v234
    ds_read_b64_tr_b16 a[170:171], v234 offset:2048
    ds_read_b64_tr_b16 a[172:173], v235
    s_waitcnt lgkmcnt(14)
    ds_read_b64_tr_b16 a[174:175], v235 offset:2048
    v_pk_fma_f32 v[160:161], v[160:161], s[78:79], v[212:213] op_sel_hi:[1,0,0]
    v_pk_fma_f32 v[176:177], v[176:177], s[78:79], v[214:215] op_sel_hi:[1,0,0]
    v_exp_f32 v160, v160
    v_exp_f32 v161, v161
    v_exp_f32 v176, v176
    v_exp_f32 v177, v177
    s_add_u32 m0, s4, 131072
    s_mov_b32 s72, 65536
    buffer_load_dwordx4 v244, s[24:27], s72 offen lds
    buffer_load_dwordx4 v245, s[24:27], s72 offen offset:1024 lds
    v_pk_fma_f32 v[162:163], v[162:163], s[78:79], v[212:213] op_sel_hi:[1,0,0]
    v_pk_fma_f32 v[178:179], v[178:179], s[78:79], v[214:215] op_sel_hi:[1,0,0]
    v_exp_f32 v162, v162
    v_exp_f32 v163, v163
    v_exp_f32 v178, v178
    v_exp_f32 v179, v179
    v_pk_add_f32 v[216:217], v[148:149], v[150:151]
    v_pk_add_f32 v[218:219], v[164:165], v[166:167]
    v_pk_add_f32 v[216:217], v[216:217], v[152:153]
    v_pk_add_f32 v[218:219], v[218:219], v[168:169]
    v_pk_add_f32 v[216:217], v[216:217], v[154:155]
    v_pk_add_f32 v[218:219], v[218:219], v[170:171]
    v_pk_add_f32 v[216:217], v[216:217], v[156:157]
    v_pk_add_f32 v[218:219], v[218:219], v[172:173]
    v_pk_add_f32 v[216:217], v[216:217], v[158:159]
    v_pk_add_f32 v[218:219], v[218:219], v[174:175]
    v_pk_add_f32 v[216:217], v[216:217], v[160:161]
    v_pk_add_f32 v[218:219], v[218:219], v[176:177]
    v_pk_add_f32 v[216:217], v[216:217], v[162:163]
    v_pk_add_f32 v[218:219], v[218:219], v[178:179]
    v_add_f32 v216, v216, v217
    v_add_f32 v218, v218, v219
    v_rcp_f32 v216, v216
    v_rcp_f32 v218, v218
    v_pk_mul_f32 v[148:149], v[148:149], v[216:217] op_sel_hi:[1,0]
    v_pk_mul_f32 v[164:165], v[164:165], v[218:219] op_sel_hi:[1,0]
    v_cvt_pk_bf16_f32 v112, v148, v149
    v_cvt_pk_bf16_f32 v120, v164, v165
    v_pk_mul_f32 v[150:151], v[150:151], v[216:217] op_sel_hi:[1,0]
    v_pk_mul_f32 v[166:167], v[166:167], v[218:219] op_sel_hi:[1,0]
    v_cvt_pk_bf16_f32 v113, v150, v151
    v_cvt_pk_bf16_f32 v121, v166, v167
    v_pk_mul_f32 v[152:153], v[152:153], v[216:217] op_sel_hi:[1,0]
    v_pk_mul_f32 v[168:169], v[168:169], v[218:219] op_sel_hi:[1,0]
    v_cvt_pk_bf16_f32 v114, v152, v153
    v_cvt_pk_bf16_f32 v122, v168, v169
    v_pk_mul_f32 v[154:155], v[154:155], v[216:217] op_sel_hi:[1,0]
    v_pk_mul_f32 v[170:171], v[170:171], v[218:219] op_sel_hi:[1,0]
    v_cvt_pk_bf16_f32 v115, v154, v155
    v_cvt_pk_bf16_f32 v123, v170, v171
    v_pk_mul_f32 v[156:157], v[156:157], v[216:217] op_sel_hi:[1,0]
    v_pk_mul_f32 v[172:173], v[172:173], v[218:219] op_sel_hi:[1,0]
    v_cvt_pk_bf16_f32 v116, v156, v157
    v_cvt_pk_bf16_f32 v124, v172, v173
    v_pk_mul_f32 v[158:159], v[158:159], v[216:217] op_sel_hi:[1,0]
    v_pk_mul_f32 v[174:175], v[174:175], v[218:219] op_sel_hi:[1,0]
    v_cvt_pk_bf16_f32 v117, v158, v159
    v_cvt_pk_bf16_f32 v125, v174, v175
    v_pk_mul_f32 v[160:161], v[160:161], v[216:217] op_sel_hi:[1,0]
    v_pk_mul_f32 v[176:177], v[176:177], v[218:219] op_sel_hi:[1,0]
    v_cvt_pk_bf16_f32 v118, v160, v161
    v_cvt_pk_bf16_f32 v126, v176, v177
    v_pk_mul_f32 v[162:163], v[162:163], v[216:217] op_sel_hi:[1,0]
    v_pk_mul_f32 v[178:179], v[178:179], v[218:219] op_sel_hi:[1,0]
    v_cvt_pk_bf16_f32 v119, v162, v163
    v_cvt_pk_bf16_f32 v127, v178, v179
    v_cvt_pk_bf16_f32 v180, v128, v129
    v_cvt_pk_bf16_f32 v181, v130, v131
    v_cvt_pk_bf16_f32 v182, v132, v133
    v_cvt_pk_bf16_f32 v183, v134, v135
    v_cvt_pk_bf16_f32 v184, v136, v137
    v_cvt_pk_bf16_f32 v185, v138, v139
    v_cvt_pk_bf16_f32 v186, v140, v141
    v_cvt_pk_bf16_f32 v187, v142, v143
    v_permlane16_swap_b32 v180, v182
    v_permlane16_swap_b32 v181, v183
    v_permlane16_swap_b32 v184, v186
    v_permlane16_swap_b32 v185, v187
    v_mfma_f32_32x32x16_bf16 v[148:163], v[144:147], v[180:183], 0
    s_nop 0
    v_mfma_f32_32x32x16_bf16 v[164:179], v[144:147], v[184:187], 0
    s_nop 9
    v_max3_f32 v212, v148, v149, v150
    s_nop 0
    v_max3_f32 v214, v164, v165, v166
    v_max3_f32 v212, v212, v151, v152
    v_max3_f32 v214, v214, v167, v168
    v_max3_f32 v212, v212, v153, v154
    v_max3_f32 v214, v214, v169, v170
    v_max3_f32 v212, v212, v155, v156
    v_max3_f32 v214, v214, v171, v172
    v_max3_f32 v212, v212, v157, v158
    v_max3_f32 v214, v214, v173, v174
    v_max3_f32 v212, v212, v159, v160
    v_max3_f32 v214, v214, v175, v176
    v_max3_f32 v212, v212, v161, v162
    v_max3_f32 v214, v214, v177, v178
    v_max_f32 v212, v212, v163
    v_max_f32 v214, v214, v179
    v_mul_f32 v212, s79, v212
    v_mul_f32 v214, s79, v214
    buffer_load_dwordx4 v246, s[24:27], s72 offen offset:2048 lds
    buffer_load_dwordx4 v247, s[24:27], s72 offen offset:3072 lds
    v_pk_fma_f32 v[148:149], v[148:149], s[78:79], v[212:213] op_sel_hi:[1,0,0]
    v_pk_fma_f32 v[164:165], v[164:165], s[78:79], v[214:215] op_sel_hi:[1,0,0]
    v_exp_f32 v148, v148
    v_exp_f32 v149, v149
    v_exp_f32 v164, v164
    v_exp_f32 v165, v165
    s_waitcnt lgkmcnt(8)
    s_add_u32 m0, s4, 49152
    s_mov_b32 s72, 360448
    buffer_load_dwordx4 v240, s[20:23], s72 offen lds
    buffer_load_dwordx4 v241, s[20:23], s72 offen offset:1024 lds
    v_pk_fma_f32 v[150:151], v[150:151], s[78:79], v[212:213] op_sel_hi:[1,0,0]
    v_pk_fma_f32 v[166:167], v[166:167], s[78:79], v[214:215] op_sel_hi:[1,0,0]
    v_exp_f32 v150, v150
    v_exp_f32 v151, v151
    v_exp_f32 v166, v166
    v_exp_f32 v167, v167
    buffer_load_dwordx4 v242, s[20:23], s72 offen offset:2048 lds
    buffer_load_dwordx4 v243, s[20:23], s72 offen offset:3072 lds
    v_pk_fma_f32 v[152:153], v[152:153], s[78:79], v[212:213] op_sel_hi:[1,0,0]
    v_pk_fma_f32 v[168:169], v[168:169], s[78:79], v[214:215] op_sel_hi:[1,0,0]
    v_exp_f32 v152, v152
    v_exp_f32 v153, v153
    v_exp_f32 v168, v168
    v_exp_f32 v169, v169
    s_waitcnt vmcnt(16)
    ds_read_b64_tr_b16 a[176:177], v232 offset:16384
    ds_read_b64_tr_b16 a[178:179], v232 offset:18432
    ds_read_b64_tr_b16 a[180:181], v233 offset:16384
    ds_read_b64_tr_b16 a[182:183], v233 offset:18432
    ds_read_b64_tr_b16 a[184:185], v234 offset:16384
    ds_read_b64_tr_b16 a[186:187], v234 offset:18432
    ds_read_b64_tr_b16 a[188:189], v235 offset:16384
    s_waitcnt lgkmcnt(14)
    ds_read_b64_tr_b16 a[190:191], v235 offset:18432
    v_pk_fma_f32 v[154:155], v[154:155], s[78:79], v[212:213] op_sel_hi:[1,0,0]
    v_pk_fma_f32 v[170:171], v[170:171], s[78:79], v[214:215] op_sel_hi:[1,0,0]
    v_exp_f32 v154, v154
    v_exp_f32 v155, v155
    v_exp_f32 v170, v170
    v_exp_f32 v171, v171
    s_waitcnt lgkmcnt(8)
    s_add_u32 m0, s4, 0
    s_mov_b32 s72, 262144
    buffer_load_dwordx4 v240, s[20:23], s72 offen lds
    buffer_load_dwordx4 v241, s[20:23], s72 offen offset:1024 lds
    v_pk_fma_f32 v[156:157], v[156:157], s[78:79], v[212:213] op_sel_hi:[1,0,0]
    v_pk_fma_f32 v[172:173], v[172:173], s[78:79], v[214:215] op_sel_hi:[1,0,0]
    v_exp_f32 v156, v156
    v_exp_f32 v157, v157
    v_exp_f32 v172, v172
    v_exp_f32 v173, v173
    buffer_load_dwordx4 v242, s[20:23], s72 offen offset:2048 lds
    buffer_load_dwordx4 v243, s[20:23], s72 offen offset:3072 lds
    v_pk_fma_f32 v[158:159], v[158:159], s[78:79], v[212:213] op_sel_hi:[1,0,0]
    v_pk_fma_f32 v[174:175], v[174:175], s[78:79], v[214:215] op_sel_hi:[1,0,0]
    v_exp_f32 v158, v158
    v_exp_f32 v159, v159
    v_exp_f32 v174, v174
    v_exp_f32 v175, v175
    s_waitcnt vmcnt(16)
    ds_read_b64_tr_b16 a[192:193], v232 offset:32768
    ds_read_b64_tr_b16 a[194:195], v232 offset:34816
    ds_read_b64_tr_b16 a[196:197], v233 offset:32768
    ds_read_b64_tr_b16 a[198:199], v233 offset:34816
    ds_read_b64_tr_b16 a[200:201], v234 offset:32768
    ds_read_b64_tr_b16 a[202:203], v234 offset:34816
    ds_read_b64_tr_b16 a[204:205], v235 offset:32768
    s_waitcnt lgkmcnt(14)
    ds_read_b64_tr_b16 a[206:207], v235 offset:34816
    v_pk_fma_f32 v[160:161], v[160:161], s[78:79], v[212:213] op_sel_hi:[1,0,0]
    v_pk_fma_f32 v[176:177], v[176:177], s[78:79], v[214:215] op_sel_hi:[1,0,0]
    v_exp_f32 v160, v160
    v_exp_f32 v161, v161
    v_exp_f32 v176, v176
    v_exp_f32 v177, v177
    s_waitcnt lgkmcnt(8)
    s_add_u32 m0, s4, 16384
    s_mov_b32 s72, 294912
    buffer_load_dwordx4 v240, s[20:23], s72 offen lds
    buffer_load_dwordx4 v241, s[20:23], s72 offen offset:1024 lds
    v_pk_fma_f32 v[162:163], v[162:163], s[78:79], v[212:213] op_sel_hi:[1,0,0]
    v_pk_fma_f32 v[178:179], v[178:179], s[78:79], v[214:215] op_sel_hi:[1,0,0]
    v_exp_f32 v162, v162
    v_exp_f32 v163, v163
    v_exp_f32 v178, v178
    v_exp_f32 v179, v179
    v_pk_add_f32 v[216:217], v[148:149], v[150:151]
    v_pk_add_f32 v[218:219], v[164:165], v[166:167]
    v_pk_add_f32 v[216:217], v[216:217], v[152:153]
    v_pk_add_f32 v[218:219], v[218:219], v[168:169]
    v_pk_add_f32 v[216:217], v[216:217], v[154:155]
    v_pk_add_f32 v[218:219], v[218:219], v[170:171]
    v_pk_add_f32 v[216:217], v[216:217], v[156:157]
    v_pk_add_f32 v[218:219], v[218:219], v[172:173]
    v_pk_add_f32 v[216:217], v[216:217], v[158:159]
    v_pk_add_f32 v[218:219], v[218:219], v[174:175]
    v_pk_add_f32 v[216:217], v[216:217], v[160:161]
    v_pk_add_f32 v[218:219], v[218:219], v[176:177]
    v_pk_add_f32 v[216:217], v[216:217], v[162:163]
    v_pk_add_f32 v[218:219], v[218:219], v[178:179]
    v_add_f32 v216, v216, v217
    v_add_f32 v218, v218, v219
    v_rcp_f32 v216, v216
    v_rcp_f32 v218, v218
    v_pk_mul_f32 v[148:149], v[148:149], v[216:217] op_sel_hi:[1,0]
    v_pk_mul_f32 v[164:165], v[164:165], v[218:219] op_sel_hi:[1,0]
    v_cvt_pk_bf16_f32 v128, v148, v149
    v_cvt_pk_bf16_f32 v136, v164, v165
    v_pk_mul_f32 v[150:151], v[150:151], v[216:217] op_sel_hi:[1,0]
    v_pk_mul_f32 v[166:167], v[166:167], v[218:219] op_sel_hi:[1,0]
    v_cvt_pk_bf16_f32 v129, v150, v151
    v_cvt_pk_bf16_f32 v137, v166, v167
    v_pk_mul_f32 v[152:153], v[152:153], v[216:217] op_sel_hi:[1,0]
    v_pk_mul_f32 v[168:169], v[168:169], v[218:219] op_sel_hi:[1,0]
    v_cvt_pk_bf16_f32 v130, v152, v153
    v_cvt_pk_bf16_f32 v138, v168, v169
    v_pk_mul_f32 v[154:155], v[154:155], v[216:217] op_sel_hi:[1,0]
    v_pk_mul_f32 v[170:171], v[170:171], v[218:219] op_sel_hi:[1,0]
    v_cvt_pk_bf16_f32 v131, v154, v155
    v_cvt_pk_bf16_f32 v139, v170, v171
    v_pk_mul_f32 v[156:157], v[156:157], v[216:217] op_sel_hi:[1,0]
    v_pk_mul_f32 v[172:173], v[172:173], v[218:219] op_sel_hi:[1,0]
    v_cvt_pk_bf16_f32 v132, v156, v157
    v_cvt_pk_bf16_f32 v140, v172, v173
    v_pk_mul_f32 v[158:159], v[158:159], v[216:217] op_sel_hi:[1,0]
    v_pk_mul_f32 v[174:175], v[174:175], v[218:219] op_sel_hi:[1,0]
    v_cvt_pk_bf16_f32 v133, v158, v159
    v_cvt_pk_bf16_f32 v141, v174, v175
    v_pk_mul_f32 v[160:161], v[160:161], v[216:217] op_sel_hi:[1,0]
    v_pk_mul_f32 v[176:177], v[176:177], v[218:219] op_sel_hi:[1,0]
    v_cvt_pk_bf16_f32 v134, v160, v161
    v_cvt_pk_bf16_f32 v142, v176, v177
    v_pk_mul_f32 v[162:163], v[162:163], v[216:217] op_sel_hi:[1,0]
    v_pk_mul_f32 v[178:179], v[178:179], v[218:219] op_sel_hi:[1,0]
    v_cvt_pk_bf16_f32 v135, v162, v163
    v_cvt_pk_bf16_f32 v143, v178, v179
    buffer_load_dwordx4 v242, s[20:23], s72 offen offset:2048 lds
    buffer_load_dwordx4 v243, s[20:23], s72 offen offset:3072 lds
    s_waitcnt lgkmcnt(0)
    s_add_u32 m0, s4, 32768
    s_mov_b32 s72, 327680
    buffer_load_dwordx4 v240, s[20:23], s72 offen lds
    buffer_load_dwordx4 v241, s[20:23], s72 offen offset:1024 lds
    buffer_load_dwordx4 v242, s[20:23], s72 offen offset:2048 lds
    buffer_load_dwordx4 v243, s[20:23], s72 offen offset:3072 lds
    s_lshl_b32 s74, s66, 7
    s_add_u32 s74, s74, 13639680
    s_mov_b32 s80, 0xfff
    s_mov_b32 s81, 0
    s_mov_b32 s5, 0
L_kvpoll_9:
    buffer_load_dword v221, v226, s[16:19], s74 offen sc1
    s_waitcnt vmcnt(0)
    v_cmp_eq_u32 vcc, s38, v221
    s_nop 0
    s_and_b64 s[82:83], vcc, s[80:81]
    s_cmp_eq_u64 s[82:83], s[80:81]
    s_cbranch_scc1 L_kvpoll_ok_10
    s_add_u32 s5, s5, 1
    s_cmp_lt_u32 s5, 131072
    s_cbranch_scc1 L_kvpoll_9
L_kvpoll_ok_10:
    s_mov_b32 s75, 0
    buffer_load_dwordx4 v[0:3], v225, s[16:19], s75 offen
    buffer_load_dwordx4 v[4:7], v225, s[16:19], s75 offen offset:640
    s_mov_b32 s75, 1280
    buffer_load_dwordx4 v[8:11], v225, s[16:19], s75 offen
    buffer_load_dwordx4 v[12:15], v225, s[16:19], s75 offen offset:640
    s_mov_b32 s75, 2560
    buffer_load_dwordx4 v[16:19], v225, s[16:19], s75 offen
    buffer_load_dwordx4 v[20:23], v225, s[16:19], s75 offen offset:640
    s_mov_b32 s75, 3840
    buffer_load_dwordx4 v[24:27], v225, s[16:19], s75 offen
    buffer_load_dwordx4 v[28:31], v225, s[16:19], s75 offen offset:640
    s_mov_b32 s75, 5120
    buffer_load_dwordx4 v[32:35], v225, s[16:19], s75 offen
    buffer_load_dwordx4 v[36:39], v225, s[16:19], s75 offen offset:640
    s_mov_b32 s75, 6400
    buffer_load_dwordx4 v[40:43], v225, s[16:19], s75 offen
    buffer_load_dwordx4 v[44:47], v225, s[16:19], s75 offen offset:640
    s_mov_b32 s75, 7680
    buffer_load_dwordx4 v[48:51], v225, s[16:19], s75 offen
    buffer_load_dwordx4 v[52:55], v225, s[16:19], s75 offen offset:640
    s_mov_b32 s75, 8960
    buffer_load_dwordx4 v[56:59], v225, s[16:19], s75 offen
    buffer_load_dwordx4 v[60:63], v225, s[16:19], s75 offen offset:640
    s_mov_b32 s75, 10240
    buffer_load_dwordx4 v[64:67], v225, s[16:19], s75 offen
    buffer_load_dwordx4 v[68:71], v225, s[16:19], s75 offen offset:640
    s_mov_b32 s75, 11520
    buffer_load_dwordx4 v[72:75], v225, s[16:19], s75 offen
    buffer_load_dwordx4 v[76:79], v225, s[16:19], s75 offen offset:640
    s_mov_b32 s75, 12800
    buffer_load_dwordx4 v[80:83], v225, s[16:19], s75 offen
    buffer_load_dwordx4 v[84:87], v225, s[16:19], s75 offen offset:640
    s_mov_b32 s75, 14080
    buffer_load_dwordx4 v[88:91], v225, s[16:19], s75 offen
    buffer_load_dwordx4 v[92:95], v225, s[16:19], s75 offen offset:640
    s_mul_i32 s74, s65, 176
    s_lshl_b32 s75, s66, 1
    s_add_u32 s74, s74, s75
    s_lshr_b32 s75, s64, 1
    s_add_u32 s74, s74, s75
    s_lshl_b32 s74, s74, 10
    s_and_b32 s75, s64, 1
    s_lshl_b32 s75, s75, 9
    s_add_u32 s74, s74, s75
    s_add_u32 s74, s74, 8388608
    v_bfe_u32 v214, v254, 4, 1
    v_lshlrev_b32 v214, 14, v214
    v_lshrrev_b32 v215, 5, v254
    v_lshl_add_u32 v214, v215, 8, v214
    v_and_b32 v215, 15, v254
    v_lshl_add_u32 v214, v215, 4, v214
    v_add_u32 v216, s74, v214
    v_lshlrev_b32 v184, 4, v254
    v_add_u32 v185, 57344, v184
    v_add_u32 v186, 114688, v184
    v_add_u32 v187, 172032, v184
    s_lshl_b32 s74, s67, 6
    s_mul_hi_u32 s75, s74, 0x1555556
    s_add_u32 s73, s74, 63
    s_mul_hi_u32 s73, s73, 0x1555556
    s_lshl_b32 s75, s75, 7
    s_lshl_b32 s73, s73, 7
    v_mov_b32 v212, s75
    v_mov_b32 v213, s73
    s_mov_b32 s80, 0xffff0000
    s_mov_b32 s81, 0
    v_cndmask_b32 v188, v212, v213, s[80:81]
    s_mul_hi_u32 s75, s74, 0x1745d18
    s_add_u32 s73, s74, 63
    s_mul_hi_u32 s73, s73, 0x1745d18
    s_lshl_b32 s75, s75, 7
    s_lshl_b32 s73, s73, 7
    s_add_u32 s75, s75, 4096
    s_add_u32 s73, s73, 4096
    v_mov_b32 v212, s75
    v_mov_b32 v213, s73
    s_mov_b32 s80, 0
    s_mov_b32 s81, 0x0000ffff
    v_cndmask_b32 v188, v188, v212, s[80:81]
    s_mov_b32 s81, 0xffff0000
    v_cndmask_b32 v188, v188, v213, s[80:81]
    v_and_b32 v212, 15, v254
    v_lshl_add_u32 v188, v212, 2, v188
    v_add_u32 v188, 13631488, v188
    s_mul_i32 s69, s67, 224
    s_mul_i32 s74, s64, 14
    s_add_u32 s69, s69, s74
    s_lshl_b32 s69, s69, 10
    s_lshl_b32 s70, s67, 6
    s_lshl_b32 s74, s64, 2
    s_add_u32 s70, s70, s74
    s_lshl_b32 s70, s70, 10
    s_add_u32 s70, s70, 8388608
    buffer_load_dword v189, v188, s[16:19], 0 offen sc1
    s_mov_b32 s80, 0x00003f80
    s_mov_b32 s81, 0x3f800000
    s_waitcnt vmcnt(24)
    v_dot2_f32_bf16 v196, v0, s80, 0
    v_dot2_f32_bf16 v197, v0, s81, 0
    v_dot2_f32_bf16 v198, v1, s80, 0
    v_dot2_f32_bf16 v199, v1, s81, 0
    v_dot2_f32_bf16 v200, v2, s80, 0
    v_dot2_f32_bf16 v201, v2, s81, 0
    v_dot2_f32_bf16 v202, v3, s80, 0
    v_dot2_f32_bf16 v203, v3, s81, 0
    s_waitcnt vmcnt(23)
    v_dot2_f32_bf16 v204, v4, s80, 0
    v_dot2_f32_bf16 v205, v4, s81, 0
    v_dot2_f32_bf16 v206, v5, s80, 0
    v_dot2_f32_bf16 v207, v5, s81, 0
    v_dot2_f32_bf16 v208, v6, s80, 0
    v_dot2_f32_bf16 v209, v6, s81, 0
    v_dot2_f32_bf16 v210, v7, s80, 0
    v_dot2_f32_bf16 v211, v7, s81, 0
    s_waitcnt vmcnt(22)
    v_dot2_f32_bf16 v196, v8, s80, v196
    v_dot2_f32_bf16 v197, v8, s81, v197
    v_dot2_f32_bf16 v198, v9, s80, v198
    v_dot2_f32_bf16 v199, v9, s81, v199
    v_dot2_f32_bf16 v200, v10, s80, v200
    v_dot2_f32_bf16 v201, v10, s81, v201
    v_dot2_f32_bf16 v202, v11, s80, v202
    v_dot2_f32_bf16 v203, v11, s81, v203
    s_waitcnt vmcnt(21)
    v_dot2_f32_bf16 v204, v12, s80, v204
    v_dot2_f32_bf16 v205, v12, s81, v205
    v_dot2_f32_bf16 v206, v13, s80, v206
    v_dot2_f32_bf16 v207, v13, s81, v207
    v_dot2_f32_bf16 v208, v14, s80, v208
    v_dot2_f32_bf16 v209, v14, s81, v209
    v_dot2_f32_bf16 v210, v15, s80, v210
    v_dot2_f32_bf16 v211, v15, s81, v211
    s_waitcnt vmcnt(20)
    v_dot2_f32_bf16 v196, v16, s80, v196
    v_dot2_f32_bf16 v197, v16, s81, v197
    v_dot2_f32_bf16 v198, v17, s80, v198
    v_dot2_f32_bf16 v199, v17, s81, v199
    v_dot2_f32_bf16 v200, v18, s80, v200
    v_dot2_f32_bf16 v201, v18, s81, v201
    v_dot2_f32_bf16 v202, v19, s80, v202
    v_dot2_f32_bf16 v203, v19, s81, v203
    s_waitcnt vmcnt(19)
    v_dot2_f32_bf16 v204, v20, s80, v204
    v_dot2_f32_bf16 v205, v20, s81, v205
    v_dot2_f32_bf16 v206, v21, s80, v206
    v_dot2_f32_bf16 v207, v21, s81, v207
    v_dot2_f32_bf16 v208, v22, s80, v208
    v_dot2_f32_bf16 v209, v22, s81, v209
    v_dot2_f32_bf16 v210, v23, s80, v210
    v_dot2_f32_bf16 v211, v23, s81, v211
    s_waitcnt vmcnt(18)
    v_dot2_f32_bf16 v196, v24, s80, v196
    v_dot2_f32_bf16 v197, v24, s81, v197
    v_dot2_f32_bf16 v198, v25, s80, v198
    v_dot2_f32_bf16 v199, v25, s81, v199
    v_dot2_f32_bf16 v200, v26, s80, v200
    v_dot2_f32_bf16 v201, v26, s81, v201
    v_dot2_f32_bf16 v202, v27, s80, v202
    v_dot2_f32_bf16 v203, v27, s81, v203
    s_waitcnt vmcnt(17)
    v_dot2_f32_bf16 v204, v28, s80, v204
    v_dot2_f32_bf16 v205, v28, s81, v205
    v_dot2_f32_bf16 v206, v29, s80, v206
    v_dot2_f32_bf16 v207, v29, s81, v207
    v_dot2_f32_bf16 v208, v30, s80, v208
    v_dot2_f32_bf16 v209, v30, s81, v209
    v_dot2_f32_bf16 v210, v31, s80, v210
    v_dot2_f32_bf16 v211, v31, s81, v211
    s_waitcnt vmcnt(16)
    v_dot2_f32_bf16 v196, v32, s80, v196
    v_dot2_f32_bf16 v197, v32, s81, v197
    v_dot2_f32_bf16 v198, v33, s80, v198
    v_dot2_f32_bf16 v199, v33, s81, v199
    v_dot2_f32_bf16 v200, v34, s80, v200
    v_dot2_f32_bf16 v201, v34, s81, v201
    v_dot2_f32_bf16 v202, v35, s80, v202
    v_dot2_f32_bf16 v203, v35, s81, v203
    s_waitcnt vmcnt(15)
    v_dot2_f32_bf16 v204, v36, s80, v204
    v_dot2_f32_bf16 v205, v36, s81, v205
    v_dot2_f32_bf16 v206, v37, s80, v206
    v_dot2_f32_bf16 v207, v37, s81, v207
    v_dot2_f32_bf16 v208, v38, s80, v208
    v_dot2_f32_bf16 v209, v38, s81, v209
    v_dot2_f32_bf16 v210, v39, s80, v210
    v_dot2_f32_bf16 v211, v39, s81, v211
    s_waitcnt vmcnt(14)
    v_dot2_f32_bf16 v196, v40, s80, v196
    v_dot2_f32_bf16 v197, v40, s81, v197
    v_dot2_f32_bf16 v198, v41, s80, v198
    v_dot2_f32_bf16 v199, v41, s81, v199
    v_dot2_f32_bf16 v200, v42, s80, v200
    v_dot2_f32_bf16 v201, v42, s81, v201
    v_dot2_f32_bf16 v202, v43, s80, v202
    v_dot2_f32_bf16 v203, v43, s81, v203
    s_waitcnt vmcnt(13)
    v_dot2_f32_bf16 v204, v44, s80, v204
    v_dot2_f32_bf16 v205, v44, s81, v205
    v_dot2_f32_bf16 v206, v45, s80, v206
    v_dot2_f32_bf16 v207, v45, s81, v207
    v_dot2_f32_bf16 v208, v46, s80, v208
    v_dot2_f32_bf16 v209, v46, s81, v209
    v_dot2_f32_bf16 v210, v47, s80, v210
    v_dot2_f32_bf16 v211, v47, s81, v211
    s_waitcnt vmcnt(12)
    v_dot2_f32_bf16 v196, v48, s80, v196
    v_dot2_f32_bf16 v197, v48, s81, v197
    v_dot2_f32_bf16 v198, v49, s80, v198
    v_dot2_f32_bf16 v199, v49, s81, v199
    v_dot2_f32_bf16 v200, v50, s80, v200
    v_dot2_f32_bf16 v201, v50, s81, v201
    v_dot2_f32_bf16 v202, v51, s80, v202
    v_dot2_f32_bf16 v203, v51, s81, v203
    s_waitcnt vmcnt(11)
    v_dot2_f32_bf16 v204, v52, s80, v204
    v_dot2_f32_bf16 v205, v52, s81, v205
    v_dot2_f32_bf16 v206, v53, s80, v206
    v_dot2_f32_bf16 v207, v53, s81, v207
    v_dot2_f32_bf16 v208, v54, s80, v208
    v_dot2_f32_bf16 v209, v54, s81, v209
    v_dot2_f32_bf16 v210, v55, s80, v210
    v_dot2_f32_bf16 v211, v55, s81, v211
    s_waitcnt vmcnt(10)
    v_dot2_f32_bf16 v196, v56, s80, v196
    v_dot2_f32_bf16 v197, v56, s81, v197
    v_dot2_f32_bf16 v198, v57, s80, v198
    v_dot2_f32_bf16 v199, v57, s81, v199
    v_dot2_f32_bf16 v200, v58, s80, v200
    v_dot2_f32_bf16 v201, v58, s81, v201
    v_dot2_f32_bf16 v202, v59, s80, v202
    v_dot2_f32_bf16 v203, v59, s81, v203
    s_waitcnt vmcnt(9)
    v_dot2_f32_bf16 v204, v60, s80, v204
    v_dot2_f32_bf16 v205, v60, s81, v205
    v_dot2_f32_bf16 v206, v61, s80, v206
    v_dot2_f32_bf16 v207, v61, s81, v207
    v_dot2_f32_bf16 v208, v62, s80, v208
    v_dot2_f32_bf16 v209, v62, s81, v209
    v_dot2_f32_bf16 v210, v63, s80, v210
    v_dot2_f32_bf16 v211, v63, s81, v211
    s_waitcnt vmcnt(8)
    v_dot2_f32_bf16 v196, v64, s80, v196
    v_dot2_f32_bf16 v197, v64, s81, v197
    v_dot2_f32_bf16 v198, v65, s80, v198
    v_dot2_f32_bf16 v199, v65, s81, v199
    v_dot2_f32_bf16 v200, v66, s80, v200
    v_dot2_f32_bf16 v201, v66, s81, v201
    v_dot2_f32_bf16 v202, v67, s80, v202
    v_dot2_f32_bf16 v203, v67, s81, v203
    s_waitcnt vmcnt(7)
    v_dot2_f32_bf16 v204, v68, s80, v204
    v_dot2_f32_bf16 v205, v68, s81, v205
    v_dot2_f32_bf16 v206, v69, s80, v206
    v_dot2_f32_bf16 v207, v69, s81, v207
    v_dot2_f32_bf16 v208, v70, s80, v208
    v_dot2_f32_bf16 v209, v70, s81, v209
    v_dot2_f32_bf16 v210, v71, s80, v210
    v_dot2_f32_bf16 v211, v71, s81, v211
    s_waitcnt vmcnt(6)
    v_dot2_f32_bf16 v196, v72, s80, v196
    v_dot2_f32_bf16 v197, v72, s81, v197
    v_dot2_f32_bf16 v198, v73, s80, v198
    v_dot2_f32_bf16 v199, v73, s81, v199
    v_dot2_f32_bf16 v200, v74, s80, v200
    v_dot2_f32_bf16 v201, v74, s81, v201
    v_dot2_f32_bf16 v202, v75, s80, v202
    v_dot2_f32_bf16 v203, v75, s81, v203
    s_waitcnt vmcnt(5)
    v_dot2_f32_bf16 v204, v76, s80, v204
    v_dot2_f32_bf16 v205, v76, s81, v205
    v_dot2_f32_bf16 v206, v77, s80, v206
    v_dot2_f32_bf16 v207, v77, s81, v207
    v_dot2_f32_bf16 v208, v78, s80, v208
    v_dot2_f32_bf16 v209, v78, s81, v209
    v_dot2_f32_bf16 v210, v79, s80, v210
    v_dot2_f32_bf16 v211, v79, s81, v211
    s_waitcnt vmcnt(4)
    v_dot2_f32_bf16 v196, v80, s80, v196
    v_dot2_f32_bf16 v197, v80, s81, v197
    v_dot2_f32_bf16 v198, v81, s80, v198
    v_dot2_f32_bf16 v199, v81, s81, v199
    v_dot2_f32_bf16 v200, v82, s80, v200
    v_dot2_f32_bf16 v201, v82, s81, v201
    v_dot2_f32_bf16 v202, v83, s80, v202
    v_dot2_f32_bf16 v203, v83, s81, v203
    s_waitcnt vmcnt(3)
    v_dot2_f32_bf16 v204, v84, s80, v204
    v_dot2_f32_bf16 v205, v84, s81, v205
    v_dot2_f32_bf16 v206, v85, s80, v206
    v_dot2_f32_bf16 v207, v85, s81, v207
    v_dot2_f32_bf16 v208, v86, s80, v208
    v_dot2_f32_bf16 v209, v86, s81, v209
    v_dot2_f32_bf16 v210, v87, s80, v210
    v_dot2_f32_bf16 v211, v87, s81, v211
    s_waitcnt vmcnt(2)
    v_dot2_f32_bf16 v196, v88, s80, v196
    v_dot2_f32_bf16 v197, v88, s81, v197
    v_dot2_f32_bf16 v198, v89, s80, v198
    v_dot2_f32_bf16 v199, v89, s81, v199
    v_dot2_f32_bf16 v200, v90, s80, v200
    v_dot2_f32_bf16 v201, v90, s81, v201
    v_dot2_f32_bf16 v202, v91, s80, v202
    v_dot2_f32_bf16 v203, v91, s81, v203
    s_waitcnt vmcnt(1)
    v_dot2_f32_bf16 v204, v92, s80, v204
    v_dot2_f32_bf16 v205, v92, s81, v205
    v_dot2_f32_bf16 v206, v93, s80, v206
    v_dot2_f32_bf16 v207, v93, s81, v207
    v_dot2_f32_bf16 v208, v94, s80, v208
    v_dot2_f32_bf16 v209, v94, s81, v209
    v_dot2_f32_bf16 v210, v95, s80, v210
    v_dot2_f32_bf16 v211, v95, s81, v211
    s_mul_i32 s74, s64, 7
    s_lshr_b32 s74, s74, 1
    s_lshl_b32 s80, 0x000f000f, s74
    s_mov_b32 s81, 0
    s_waitcnt vmcnt(0)
    v_cmp_eq_u32 vcc, s38, v189
    s_nop 0
    s_and_b64 s[82:83], vcc, s[80:81]
    s_cmp_eq_u64 s[82:83], s[80:81]
    s_cbranch_scc1 L_hpoll_ok_12
    s_mov_b32 s5, 0
L_hpoll_11:
    buffer_load_dword v189, v188, s[16:19], 0 offen sc1
    s_waitcnt vmcnt(0)
    v_cmp_eq_u32 vcc, s38, v189
    s_nop 0
    s_and_b64 s[82:83], vcc, s[80:81]
    s_cmp_eq_u64 s[82:83], s[80:81]
    s_cbranch_scc1 L_hpoll_ok_12
    s_add_u32 s5, s5, 1
    s_cmp_lt_u32 s5, 131072
    s_cbranch_scc1 L_hpoll_11
L_hpoll_ok_12:
    s_add_u32 s71, s69, 0
    buffer_load_dwordx4 a[0:3], v184, s[16:19], s71 offen
    buffer_load_dwordx4 a[4:7], v185, s[16:19], s71 offen
    buffer_load_dwordx4 a[8:11], v186, s[16:19], s71 offen
    buffer_load_dwordx4 a[12:15], v187, s[16:19], s71 offen
    buffer_load_dwordx4 a[16:19], v184, s[16:19], s71 offen offset:1024
    buffer_load_dwordx4 a[20:23], v185, s[16:19], s71 offen offset:1024
    buffer_load_dwordx4 a[24:27], v186, s[16:19], s71 offen offset:1024
    buffer_load_dwordx4 a[28:31], v187, s[16:19], s71 offen offset:1024
    buffer_load_dwordx4 a[32:35], v184, s[16:19], s71 offen offset:2048
    buffer_load_dwordx4 a[36:39], v185, s[16:19], s71 offen offset:2048
    buffer_load_dwordx4 a[40:43], v186, s[16:19], s71 offen offset:2048
    buffer_load_dwordx4 a[44:47], v187, s[16:19], s71 offen offset:2048
    v_cvt_pk_bf16_f32 v88, v196, v197
    v_cvt_pk_bf16_f32 v89, v198, v199
    v_cvt_pk_bf16_f32 v90, v200, v201
    v_cvt_pk_bf16_f32 v91, v202, v203
    v_cvt_pk_bf16_f32 v92, v204, v205
    v_cvt_pk_bf16_f32 v93, v206, v207
    v_cvt_pk_bf16_f32 v94, v208, v209
    v_cvt_pk_bf16_f32 v95, v210, v211
    s_mov_b32 s73, 0x358637bd
    v_mfma_f32_32x32x16_bf16 v[148:163], v[88:91], v[96:99], 0
    v_mfma_f32_32x32x16_bf16 v[148:163], v[92:95], v[100:103], v[148:163]
    v_mfma_f32_32x32x16_bf16 v[164:179], v[88:91], v[104:107], 0
    v_mfma_f32_32x32x16_bf16 v[164:179], v[92:95], v[108:111], v[164:179]
    v_mfma_f32_32x32x16_bf16 v[0:15], v[88:91], v[112:115], 0
    v_mfma_f32_32x32x16_bf16 v[0:15], v[92:95], v[116:119], v[0:15]
    v_mfma_f32_32x32x16_bf16 v[16:31], v[88:91], v[120:123], 0
    v_mfma_f32_32x32x16_bf16 v[16:31], v[92:95], v[124:127], v[16:31]
    s_nop 5
    v_add_f32 v218, s73, v156
    s_nop 0
    v_add_f32 v212, s73, v172
    v_rcp_f32 v218, v218
    v_rcp_f32 v212, v212
    v_pk_mul_f32 v[148:149], v[148:149], v[218:219] op_sel_hi:[1,0]
    v_pk_mul_f32 v[150:151], v[150:151], v[218:219] op_sel_hi:[1,0]
    v_pk_mul_f32 v[152:153], v[152:153], v[218:219] op_sel_hi:[1,0]
    v_pk_mul_f32 v[154:155], v[154:155], v[218:219] op_sel_hi:[1,0]
    v_cvt_pk_bf16_f32 v32, v148, v149
    v_cvt_pk_bf16_f32 v33, v150, v151
    v_cvt_pk_bf16_f32 v34, v152, v153
    v_cvt_pk_bf16_f32 v35, v154, v155
    s_mov_b32 s74, 0
    buffer_store_dwordx4 v[32:35], v216, s[16:19], s74 offen sc1
    v_pk_mul_f32 v[164:165], v[164:165], v[212:213] op_sel_hi:[1,0]
    v_pk_mul_f32 v[166:167], v[166:167], v[212:213] op_sel_hi:[1,0]
    v_pk_mul_f32 v[168:169], v[168:169], v[212:213] op_sel_hi:[1,0]
    v_pk_mul_f32 v[170:171], v[170:171], v[212:213] op_sel_hi:[1,0]
    v_cvt_pk_bf16_f32 v36, v164, v165
    v_cvt_pk_bf16_f32 v37, v166, v167
    v_cvt_pk_bf16_f32 v38, v168, v169
    v_cvt_pk_bf16_f32 v39, v170, v171
    s_mov_b32 s74, 32768
    buffer_store_dwordx4 v[36:39], v216, s[16:19], s74 offen sc1
    v_mfma_f32_32x32x16_bf16 v[148:163], v[88:91], v[128:131], 0
    v_mfma_f32_32x32x16_bf16 v[148:163], v[92:95], v[132:135], v[148:163]
    v_mfma_f32_32x32x16_bf16 v[164:179], v[88:91], v[136:139], 0
    v_mfma_f32_32x32x16_bf16 v[164:179], v[92:95], v[140:143], v[164:179]
    v_add_f32 v218, s73, v8
    v_add_f32 v212, s73, v24
    v_rcp_f32 v218, v218
    v_rcp_f32 v212, v212
    v_pk_mul_f32 v[0:1], v[0:1], v[218:219] op_sel_hi:[1,0]
    v_pk_mul_f32 v[2:3], v[2:3], v[218:219] op_sel_hi:[1,0]
    v_pk_mul_f32 v[4:5], v[4:5], v[218:219] op_sel_hi:[1,0]
    v_pk_mul_f32 v[6:7], v[6:7], v[218:219] op_sel_hi:[1,0]
    v_cvt_pk_bf16_f32 v40, v0, v1
    v_cvt_pk_bf16_f32 v41, v2, v3
    v_cvt_pk_bf16_f32 v42, v4, v5
    v_cvt_pk_bf16_f32 v43, v6, v7
    s_mov_b32 s74, 65536
    buffer_store_dwordx4 v[40:43], v216, s[16:19], s74 offen sc1
    v_pk_mul_f32 v[16:17], v[16:17], v[212:213] op_sel_hi:[1,0]
    v_pk_mul_f32 v[18:19], v[18:19], v[212:213] op_sel_hi:[1,0]
    v_pk_mul_f32 v[20:21], v[20:21], v[212:213] op_sel_hi:[1,0]
    v_pk_mul_f32 v[22:23], v[22:23], v[212:213] op_sel_hi:[1,0]
    v_cvt_pk_bf16_f32 v44, v16, v17
    v_cvt_pk_bf16_f32 v45, v18, v19
    v_cvt_pk_bf16_f32 v46, v20, v21
    v_cvt_pk_bf16_f32 v47, v22, v23
    s_mov_b32 s74, 98304
    buffer_store_dwordx4 v[44:47], v216, s[16:19], s74 offen sc1
    v_add_f32 v218, s73, v156
    v_add_f32 v212, s73, v172
    v_rcp_f32 v218, v218
    v_rcp_f32 v212, v212
    v_pk_mul_f32 v[148:149], v[148:149], v[218:219] op_sel_hi:[1,0]
    v_pk_mul_f32 v[150:151], v[150:151], v[218:219] op_sel_hi:[1,0]
    v_pk_mul_f32 v[152:153], v[152:153], v[218:219] op_sel_hi:[1,0]
    v_pk_mul_f32 v[154:155], v[154:155], v[218:219] op_sel_hi:[1,0]
    v_cvt_pk_bf16_f32 v48, v148, v149
    v_cvt_pk_bf16_f32 v49, v150, v151
    v_cvt_pk_bf16_f32 v50, v152, v153
    v_cvt_pk_bf16_f32 v51, v154, v155
    s_mov_b32 s74, 131072
    buffer_store_dwordx4 v[48:51], v216, s[16:19], s74 offen sc1
    v_pk_mul_f32 v[164:165], v[164:165], v[212:213] op_sel_hi:[1,0]
    v_pk_mul_f32 v[166:167], v[166:167], v[212:213] op_sel_hi:[1,0]
    v_pk_mul_f32 v[168:169], v[168:169], v[212:213] op_sel_hi:[1,0]
    v_pk_mul_f32 v[170:171], v[170:171], v[212:213] op_sel_hi:[1,0]
    v_cvt_pk_bf16_f32 v52, v164, v165
    v_cvt_pk_bf16_f32 v53, v166, v167
    v_cvt_pk_bf16_f32 v54, v168, v169
    v_cvt_pk_bf16_f32 v55, v170, v171
    s_mov_b32 s74, 163840
    s_mov_b32 exec_lo, 0x0000ffff
    s_mov_b32 exec_hi, 0x0000ffff
    buffer_store_dwordx4 v[52:55], v216, s[16:19], s74 offen sc1
    s_mov_b32 exec_lo, -1
    s_mov_b32 exec_hi, -1
    v_writelane_b32 v238, s86, 0
L_phase2:
    s_nop 3
    s_lshl_b32 s6, s67, 6
    s_mov_b32 s7, 5958
    v_add_u32 v164, 65536, v232
    s_waitcnt vmcnt(11)
    v_mfma_f32_16x16x32_bf16 v[0:3], a[96:99], a[0:3], 0
    v_add_u32 v168, 131072, v232
    buffer_load_dwordx4 a[48:51], v184, s[16:19], s71 offen offset:3072
    v_mfma_f32_16x16x32_bf16 v[4:7], a[100:103], a[0:3], 0
    v_add_u32 v165, 65536, v233
    v_mfma_f32_16x16x32_bf16 v[8:11], a[104:107], a[0:3], 0
    v_add_u32 v169, 131072, v233
    v_mfma_f32_16x16x32_bf16 v[12:15], a[108:111], a[0:3], 0
    v_add_u32 v166, 65536, v234
    s_waitcnt vmcnt(11)
    v_mfma_f32_16x16x32_bf16 v[16:19], a[96:99], a[4:7], 0
    v_add_u32 v170, 131072, v234
    buffer_load_dwordx4 a[52:55], v185, s[16:19], s71 offen offset:3072
    v_mfma_f32_16x16x32_bf16 v[20:23], a[100:103], a[4:7], 0
    v_add_u32 v167, 65536, v235
    v_mfma_f32_16x16x32_bf16 v[24:27], a[104:107], a[4:7], 0
    v_add_u32 v171, 131072, v235
    v_mfma_f32_16x16x32_bf16 v[28:31], a[108:111], a[4:7], 0
    v_add_u32 v190, 16384, v184
    s_waitcnt vmcnt(11)
    v_mfma_f32_16x16x32_bf16 v[32:35], a[96:99], a[8:11], 0
    v_add_u32 v191, 32768, v184
    buffer_load_dwordx4 a[56:59], v186, s[16:19], s71 offen offset:3072
    v_mfma_f32_16x16x32_bf16 v[36:39], a[100:103], a[8:11], 0
    v_add_u32 v192, 49152, v184
    v_mfma_f32_16x16x32_bf16 v[40:43], a[104:107], a[8:11], 0
    v_and_b32 v140, 15, v254
    v_mfma_f32_16x16x32_bf16 v[44:47], a[108:111], a[8:11], 0
    v_add_u32 v140, s6, v140
    s_waitcnt vmcnt(11)
    v_mfma_f32_16x16x32_bf16 v[48:51], a[96:99], a[12:15], 0
    v_mul_lo_u32 v141, v140, s7
    buffer_load_dwordx4 a[60:63], v187, s[16:19], s71 offen offset:3072
    v_mfma_f32_16x16x32_bf16 v[52:55], a[100:103], a[12:15], 0
    v_lshrrev_b32 v141, 20, v141
    v_mfma_f32_16x16x32_bf16 v[56:59], a[104:107], a[12:15], 0
    v_mul_u32_u24 v142, 176, v141
    v_mfma_f32_16x16x32_bf16 v[60:63], a[108:111], a[12:15], 0
    v_sub_u32 v142, v140, v142
    s_waitcnt vmcnt(11)
    v_mfma_f32_16x16x32_bf16 v[0:3], a[112:115], a[16:19], v[0:3]
    v_mul_u32_u24 v143, 2979, v142
    s_add_u32 s71, s69, 4096
    buffer_load_dwordx4 a[0:3], v184, s[16:19], s71 offen
    v_mfma_f32_16x16x32_bf16 v[4:7], a[116:119], a[16:19], v[4:7]
    v_lshrrev_b32 v143, 16, v143
    v_mfma_f32_16x16x32_bf16 v[8:11], a[120:123], a[16:19], v[8:11]
    v_lshl_add_u32 v141, v141, 3, v143
    v_mfma_f32_16x16x32_bf16 v[12:15], a[124:127], a[16:19], v[12:15]
    v_mul_u32_u24 v143, 22, v143
    s_waitcnt vmcnt(11)
    v_mfma_f32_16x16x32_bf16 v[16:19], a[112:115], a[20:23], v[16:19]
    v_sub_u32 v142, v142, v143
    buffer_load_dwordx4 a[4:7], v185, s[16:19], s71 offen
    v_mfma_f32_16x16x32_bf16 v[20:23], a[116:119], a[20:23], v[20:23]
    v_mul_u32_u24 v143, 43, v142
    v_mfma_f32_16x16x32_bf16 v[24:27], a[120:123], a[20:23], v[24:27]
    v_lshrrev_b32 v143, 8, v143
    v_mfma_f32_16x16x32_bf16 v[28:31], a[124:127], a[20:23], v[28:31]
    v_lshl_add_u32 v141, v141, 2, v143
    s_waitcnt vmcnt(11)
    v_mfma_f32_16x16x32_bf16 v[32:35], a[112:115], a[24:27], v[32:35]
    v_mul_u32_u24 v143, 6, v143
    buffer_load_dwordx4 a[8:11], v186, s[16:19], s71 offen
    v_mfma_f32_16x16x32_bf16 v[36:39], a[116:119], a[24:27], v[36:39]
    v_min_u32 v143, 16, v143
    v_mfma_f32_16x16x32_bf16 v[40:43], a[120:123], a[24:27], v[40:43]
    v_sub_u32 v142, v142, v143
    v_mfma_f32_16x16x32_bf16 v[44:47], a[124:127], a[24:27], v[44:47]
    v_lshlrev_b32 v141, 8, v141
    s_waitcnt vmcnt(11)
    v_mfma_f32_16x16x32_bf16 v[48:51], a[112:115], a[28:31], v[48:51]
    v_and_b32 v143, 1, v142
    buffer_load_dwordx4 a[12:15], v187, s[16:19], s71 offen
    v_mfma_f32_16x16x32_bf16 v[52:55], a[116:119], a[28:31], v[52:55]
    v_lshl_add_u32 v141, v143, 7, v141
    v_mfma_f32_16x16x32_bf16 v[56:59], a[120:123], a[28:31], v[56:59]
    v_bfe_u32 v143, v142, 1, 1
    v_mfma_f32_16x16x32_bf16 v[60:63], a[124:127], a[28:31], v[60:63]
    v_lshl_add_u32 v141, v143, 6, v141
    s_waitcnt vmcnt(11)
    v_mfma_f32_16x16x32_bf16 v[0:3], a[128:131], a[32:35], v[0:3]
    v_lshrrev_b32 v143, 2, v142
    buffer_load_dwordx4 a[16:19], v184, s[16:19], s71 offen offset:1024
    v_mfma_f32_16x16x32_bf16 v[4:7], a[132:135], a[32:35], v[4:7]
    v_lshl_add_u32 v141, v143, 2, v141
    v_mfma_f32_16x16x32_bf16 v[8:11], a[136:139], a[32:35], v[8:11]
    v_add_u32 v156, 11534336, v141
    v_mfma_f32_16x16x32_bf16 v[12:15], a[140:143], a[32:35], v[12:15]
    v_add_u32 v140, 16, v140
    s_waitcnt vmcnt(11)
    v_mfma_f32_16x16x32_bf16 v[16:19], a[128:131], a[36:39], v[16:19]
    v_mul_lo_u32 v141, v140, s7
    buffer_load_dwordx4 a[20:23], v185, s[16:19], s71 offen offset:1024
    v_mfma_f32_16x16x32_bf16 v[20:23], a[132:135], a[36:39], v[20:23]
    v_lshrrev_b32 v141, 20, v141
    v_mfma_f32_16x16x32_bf16 v[24:27], a[136:139], a[36:39], v[24:27]
    v_mul_u32_u24 v142, 176, v141
    v_mfma_f32_16x16x32_bf16 v[28:31], a[140:143], a[36:39], v[28:31]
    v_sub_u32 v142, v140, v142
    s_waitcnt vmcnt(11)
    v_mfma_f32_16x16x32_bf16 v[32:35], a[128:131], a[40:43], v[32:35]
    v_mul_u32_u24 v143, 2979, v142
    buffer_load_dwordx4 a[24:27], v186, s[16:19], s71 offen offset:1024
    v_mfma_f32_16x16x32_bf16 v[36:39], a[132:135], a[40:43], v[36:39]
    v_lshrrev_b32 v143, 16, v143
    v_mfma_f32_16x16x32_bf16 v[40:43], a[136:139], a[40:43], v[40:43]
    v_lshl_add_u32 v141, v141, 3, v143
    v_mfma_f32_16x16x32_bf16 v[44:47], a[140:143], a[40:43], v[44:47]
    v_mul_u32_u24 v143, 22, v143
    s_waitcnt vmcnt(11)
    v_mfma_f32_16x16x32_bf16 v[48:51], a[128:131], a[44:47], v[48:51]
    v_sub_u32 v142, v142, v143
    buffer_load_dwordx4 a[28:31], v187, s[16:19], s71 offen offset:1024
    v_mfma_f32_16x16x32_bf16 v[52:55], a[132:135], a[44:47], v[52:55]
    v_mul_u32_u24 v143, 43, v142
    v_mfma_f32_16x16x32_bf16 v[56:59], a[136:139], a[44:47], v[56:59]
    v_lshrrev_b32 v143, 8, v143
    v_mfma_f32_16x16x32_bf16 v[60:63], a[140:143], a[44:47], v[60:63]
    v_lshl_add_u32 v141, v141, 2, v143
    s_waitcnt vmcnt(11)
    v_mfma_f32_16x16x32_bf16 v[0:3], a[144:147], a[48:51], v[0:3]
    v_mul_u32_u24 v143, 6, v143
    buffer_load_dwordx4 a[32:35], v184, s[16:19], s71 offen offset:2048
    s_barrier
    s_cmp_eq_u32 s77, 0
    s_cbranch_scc1 L_nofl_13
    s_cmp_lg_u32 s64, 0
    s_cbranch_scc1 L_skip_14
    v_mov_b32 v252, s38
    s_mov_b32 exec_lo, 1
    s_mov_b32 exec_hi, 0
    buffer_store_dword v252, off, s[16:19], s77 sc1
    s_mov_b32 exec_lo, -1
    s_mov_b32 exec_hi, -1
L_skip_14:
L_nofl_13:
    v_mfma_f32_16x16x32_bf16 v[4:7], a[148:151], a[48:51], v[4:7]
    v_min_u32 v143, 16, v143
    v_mfma_f32_16x16x32_bf16 v[8:11], a[152:155], a[48:51], v[8:11]
    v_sub_u32 v142, v142, v143
    v_mfma_f32_16x16x32_bf16 v[12:15], a[156:159], a[48:51], v[12:15]
    v_lshlrev_b32 v141, 8, v141
    s_waitcnt vmcnt(11)
    v_mfma_f32_16x16x32_bf16 v[16:19], a[144:147], a[52:55], v[16:19]
    v_and_b32 v143, 1, v142
    buffer_load_dwordx4 a[36:39], v185, s[16:19], s71 offen offset:2048
    v_mfma_f32_16x16x32_bf16 v[20:23], a[148:151], a[52:55], v[20:23]
    v_lshl_add_u32 v141, v143, 7, v141
    v_mfma_f32_16x16x32_bf16 v[24:27], a[152:155], a[52:55], v[24:27]
    v_bfe_u32 v143, v142, 1, 1
    v_mfma_f32_16x16x32_bf16 v[28:31], a[156:159], a[52:55], v[28:31]
    v_lshl_add_u32 v141, v143, 6, v141
    s_waitcnt vmcnt(11)
    v_mfma_f32_16x16x32_bf16 v[32:35], a[144:147], a[56:59], v[32:35]
    v_lshrrev_b32 v143, 2, v142
    buffer_load_dwordx4 a[40:43], v186, s[16:19], s71 offen offset:2048
    v_mfma_f32_16x16x32_bf16 v[36:39], a[148:151], a[56:59], v[36:39]
    v_lshl_add_u32 v141, v143, 2, v141
    v_mfma_f32_16x16x32_bf16 v[40:43], a[152:155], a[56:59], v[40:43]
    v_add_u32 v157, 11534336, v141
    v_mfma_f32_16x16x32_bf16 v[44:47], a[156:159], a[56:59], v[44:47]
    v_add_u32 v140, 16, v140
    s_waitcnt vmcnt(11)
    v_mfma_f32_16x16x32_bf16 v[48:51], a[144:147], a[60:63], v[48:51]
    v_mul_lo_u32 v141, v140, s7
    buffer_load_dwordx4 a[44:47], v187, s[16:19], s71 offen offset:2048
    v_mfma_f32_16x16x32_bf16 v[52:55], a[148:151], a[60:63], v[52:55]
    v_lshrrev_b32 v141, 20, v141
    v_mfma_f32_16x16x32_bf16 v[56:59], a[152:155], a[60:63], v[56:59]
    v_mul_u32_u24 v142, 176, v141
    v_mfma_f32_16x16x32_bf16 v[60:63], a[156:159], a[60:63], v[60:63]
    v_sub_u32 v142, v140, v142
    s_waitcnt vmcnt(11)
    v_mfma_f32_16x16x32_bf16 v[0:3], a[160:163], a[0:3], v[0:3]
    v_mul_u32_u24 v143, 2979, v142
    buffer_load_dwordx4 a[48:51], v184, s[16:19], s71 offen offset:3072
    v_mfma_f32_16x16x32_bf16 v[4:7], a[164:167], a[0:3], v[4:7]
    v_lshrrev_b32 v143, 16, v143
    v_mfma_f32_16x16x32_bf16 v[8:11], a[168:171], a[0:3], v[8:11]
    v_lshl_add_u32 v141, v141, 3, v143
    v_mfma_f32_16x16x32_bf16 v[12:15], a[172:175], a[0:3], v[12:15]
    v_mul_u32_u24 v143, 22, v143
    s_waitcnt vmcnt(11)
    v_mfma_f32_16x16x32_bf16 v[16:19], a[160:163], a[4:7], v[16:19]
    v_sub_u32 v142, v142, v143
    buffer_load_dwordx4 a[52:55], v185, s[16:19], s71 offen offset:3072
    v_mfma_f32_16x16x32_bf16 v[20:23], a[164:167], a[4:7], v[20:23]
    v_mul_u32_u24 v143, 43, v142
    v_mfma_f32_16x16x32_bf16 v[24:27], a[168:171], a[4:7], v[24:27]
    v_lshrrev_b32 v143, 8, v143
    v_mfma_f32_16x16x32_bf16 v[28:31], a[172:175], a[4:7], v[28:31]
    v_lshl_add_u32 v141, v141, 2, v143
    s_waitcnt vmcnt(11)
    v_mfma_f32_16x16x32_bf16 v[32:35], a[160:163], a[8:11], v[32:35]
    v_mul_u32_u24 v143, 6, v143
    buffer_load_dwordx4 a[56:59], v186, s[16:19], s71 offen offset:3072
    v_mfma_f32_16x16x32_bf16 v[36:39], a[164:167], a[8:11], v[36:39]
    v_min_u32 v143, 16, v143
    v_mfma_f32_16x16x32_bf16 v[40:43], a[168:171], a[8:11], v[40:43]
    v_sub_u32 v142, v142, v143
    v_mfma_f32_16x16x32_bf16 v[44:47], a[172:175], a[8:11], v[44:47]
    v_lshlrev_b32 v141, 8, v141
    s_waitcnt vmcnt(11)
    v_mfma_f32_16x16x32_bf16 v[48:51], a[160:163], a[12:15], v[48:51]
    v_and_b32 v143, 1, v142
    buffer_load_dwordx4 a[60:63], v187, s[16:19], s71 offen offset:3072
    v_mfma_f32_16x16x32_bf16 v[52:55], a[164:167], a[12:15], v[52:55]
    v_lshl_add_u32 v141, v143, 7, v141
    v_mfma_f32_16x16x32_bf16 v[56:59], a[168:171], a[12:15], v[56:59]
    v_bfe_u32 v143, v142, 1, 1
    v_mfma_f32_16x16x32_bf16 v[60:63], a[172:175], a[12:15], v[60:63]
    v_lshl_add_u32 v141, v143, 6, v141
    s_waitcnt vmcnt(11)
    v_mfma_f32_16x16x32_bf16 v[0:3], a[176:179], a[16:19], v[0:3]
    v_lshrrev_b32 v143, 2, v142
    s_add_u32 s71, s69, 8192
    buffer_load_dwordx4 a[0:3], v184, s[16:19], s71 offen
    v_mfma_f32_16x16x32_bf16 v[4:7], a[180:183], a[16:19], v[4:7]
    v_lshl_add_u32 v141, v143, 2, v141
    v_mfma_f32_16x16x32_bf16 v[8:11], a[184:187], a[16:19], v[8:11]
    v_add_u32 v158, 11534336, v141
    v_mfma_f32_16x16x32_bf16 v[12:15], a[188:191], a[16:19], v[12:15]
    v_add_u32 v140, 16, v140
    s_waitcnt vmcnt(11)
    v_mfma_f32_16x16x32_bf16 v[16:19], a[176:179], a[20:23], v[16:19]
    v_mul_lo_u32 v141, v140, s7
    buffer_load_dwordx4 a[4:7], v185, s[16:19], s71 offen
    v_mfma_f32_16x16x32_bf16 v[20:23], a[180:183], a[20:23], v[20:23]
    v_lshrrev_b32 v141, 20, v141
    v_mfma_f32_16x16x32_bf16 v[24:27], a[184:187], a[20:23], v[24:27]
    v_mul_u32_u24 v142, 176, v141
    v_mfma_f32_16x16x32_bf16 v[28:31], a[188:191], a[20:23], v[28:31]
    v_sub_u32 v142, v140, v142
    s_waitcnt vmcnt(11)
    v_mfma_f32_16x16x32_bf16 v[32:35], a[176:179], a[24:27], v[32:35]
    v_mul_u32_u24 v143, 2979, v142
    buffer_load_dwordx4 a[8:11], v186, s[16:19], s71 offen
    v_mfma_f32_16x16x32_bf16 v[36:39], a[180:183], a[24:27], v[36:39]
    v_lshrrev_b32 v143, 16, v143
    v_mfma_f32_16x16x32_bf16 v[40:43], a[184:187], a[24:27], v[40:43]
    v_lshl_add_u32 v141, v141, 3, v143
    v_mfma_f32_16x16x32_bf16 v[44:47], a[188:191], a[24:27], v[44:47]
    v_mul_u32_u24 v143, 22, v143
    s_waitcnt vmcnt(11)
    v_mfma_f32_16x16x32_bf16 v[48:51], a[176:179], a[28:31], v[48:51]
    v_sub_u32 v142, v142, v143
    buffer_load_dwordx4 a[12:15], v187, s[16:19], s71 offen
    v_mfma_f32_16x16x32_bf16 v[52:55], a[180:183], a[28:31], v[52:55]
    v_mul_u32_u24 v143, 43, v142
    v_mfma_f32_16x16x32_bf16 v[56:59], a[184:187], a[28:31], v[56:59]
    v_lshrrev_b32 v143, 8, v143
    v_mfma_f32_16x16x32_bf16 v[60:63], a[188:191], a[28:31], v[60:63]
    v_lshl_add_u32 v141, v141, 2, v143
    s_waitcnt vmcnt(11)
    v_mfma_f32_16x16x32_bf16 v[0:3], a[192:195], a[32:35], v[0:3]
    v_mul_u32_u24 v143, 6, v143
    buffer_load_dwordx4 a[16:19], v184, s[16:19], s71 offen offset:1024
    v_mfma_f32_16x16x32_bf16 v[4:7], a[196:199], a[32:35], v[4:7]
    v_min_u32 v143, 16, v143
    v_mfma_f32_16x16x32_bf16 v[8:11], a[200:203], a[32:35], v[8:11]
    v_sub_u32 v142, v142, v143
    v_mfma_f32_16x16x32_bf16 v[12:15], a[204:207], a[32:35], v[12:15]
    v_lshlrev_b32 v141, 8, v141
    s_waitcnt vmcnt(11)
    v_mfma_f32_16x16x32_bf16 v[16:19], a[192:195], a[36:39], v[16:19]
    v_and_b32 v143, 1, v142
    buffer_load_dwordx4 a[20:23], v185, s[16:19], s71 offen offset:1024
    v_mfma_f32_16x16x32_bf16 v[20:23], a[196:199], a[36:39], v[20:23]
    v_lshl_add_u32 v141, v143, 7, v141
    v_mfma_f32_16x16x32_bf16 v[24:27], a[200:203], a[36:39], v[24:27]
    v_bfe_u32 v143, v142, 1, 1
    v_mfma_f32_16x16x32_bf16 v[28:31], a[204:207], a[36:39], v[28:31]
    v_lshl_add_u32 v141, v143, 6, v141
    s_waitcnt vmcnt(11)
    v_mfma_f32_16x16x32_bf16 v[32:35], a[192:195], a[40:43], v[32:35]
    v_lshrrev_b32 v143, 2, v142
    buffer_load_dwordx4 a[24:27], v186, s[16:19], s71 offen offset:1024
    v_mfma_f32_16x16x32_bf16 v[36:39], a[196:199], a[40:43], v[36:39]
    v_lshl_add_u32 v141, v143, 2, v141
    v_mfma_f32_16x16x32_bf16 v[40:43], a[200:203], a[40:43], v[40:43]
    v_add_u32 v159, 11534336, v141
    v_mfma_f32_16x16x32_bf16 v[44:47], a[204:207], a[40:43], v[44:47]
    s_waitcnt vmcnt(11)
    v_mfma_f32_16x16x32_bf16 v[48:51], a[192:195], a[44:47], v[48:51]
    buffer_load_dwordx4 a[28:31], v187, s[16:19], s71 offen offset:1024
    v_mfma_f32_16x16x32_bf16 v[52:55], a[196:199], a[44:47], v[52:55]
    v_mfma_f32_16x16x32_bf16 v[56:59], a[200:203], a[44:47], v[56:59]
    v_mfma_f32_16x16x32_bf16 v[60:63], a[204:207], a[44:47], v[60:63]
    s_waitcnt vmcnt(11)
    v_mfma_f32_16x16x32_bf16 v[0:3], a[208:211], a[48:51], v[0:3]
    buffer_load_dwordx4 a[32:35], v184, s[16:19], s71 offen offset:2048
    v_mfma_f32_16x16x32_bf16 v[4:7], a[212:215], a[48:51], v[4:7]
    v_mfma_f32_16x16x32_bf16 v[8:11], a[216:219], a[48:51], v[8:11]
    v_mfma_f32_16x16x32_bf16 v[12:15], a[220:223], a[48:51], v[12:15]
    ds_read_b64_tr_b16 a[224:225], v232
    s_waitcnt vmcnt(11)
    v_mfma_f32_16x16x32_bf16 v[16:19], a[208:211], a[52:55], v[16:19]
    ds_read_b64_tr_b16 a[226:227], v232 offset:2048
    buffer_load_dwordx4 a[36:39], v185, s[16:19], s71 offen offset:2048
    v_mfma_f32_16x16x32_bf16 v[20:23], a[212:215], a[52:55], v[20:23]
    ds_read_b64_tr_b16 a[228:229], v233
    v_mfma_f32_16x16x32_bf16 v[24:27], a[216:219], a[52:55], v[24:27]
    ds_read_b64_tr_b16 a[230:231], v233 offset:2048
    v_mfma_f32_16x16x32_bf16 v[28:31], a[220:223], a[52:55], v[28:31]
    ds_read_b64_tr_b16 a[232:233], v234
    s_waitcnt vmcnt(11)
    v_mfma_f32_16x16x32_bf16 v[32:35], a[208:211], a[56:59], v[32:35]
    ds_read_b64_tr_b16 a[234:235], v234 offset:2048
    buffer_load_dwordx4 a[40:43], v186, s[16:19], s71 offen offset:2048
    v_mfma_f32_16x16x32_bf16 v[36:39], a[212:215], a[56:59], v[36:39]
    ds_read_b64_tr_b16 a[236:237], v235
    v_mfma_f32_16x16x32_bf16 v[40:43], a[216:219], a[56:59], v[40:43]
    ds_read_b64_tr_b16 a[238:239], v235 offset:2048
    v_mfma_f32_16x16x32_bf16 v[44:47], a[220:223], a[56:59], v[44:47]
    s_waitcnt vmcnt(11)
    v_mfma_f32_16x16x32_bf16 v[48:51], a[208:211], a[60:63], v[48:51]
    buffer_load_dwordx4 a[44:47], v187, s[16:19], s71 offen offset:2048
    v_mfma_f32_16x16x32_bf16 v[52:55], a[212:215], a[60:63], v[52:55]
    v_mfma_f32_16x16x32_bf16 v[56:59], a[216:219], a[60:63], v[56:59]
    v_mfma_f32_16x16x32_bf16 v[60:63], a[220:223], a[60:63], v[60:63]
    s_waitcnt lgkmcnt(6)
    s_waitcnt vmcnt(11)
    v_mfma_f32_16x16x32_bf16 v[0:3], a[224:227], a[0:3], v[0:3]
    buffer_load_dword v189, v188, s[16:19], 0 offen sc1
    buffer_load_dwordx4 a[48:51], v184, s[16:19], s71 offen offset:3072
    s_waitcnt lgkmcnt(4)
    v_mfma_f32_16x16x32_bf16 v[4:7], a[228:231], a[0:3], v[4:7]
    s_waitcnt lgkmcnt(2)
    v_mfma_f32_16x16x32_bf16 v[8:11], a[232:235], a[0:3], v[8:11]
    s_waitcnt lgkmcnt(0)
    v_mfma_f32_16x16x32_bf16 v[12:15], a[236:239], a[0:3], v[12:15]
    ds_read_b64_tr_b16 a[240:241], v232 offset:16384
    s_waitcnt vmcnt(12)
    v_mfma_f32_16x16x32_bf16 v[16:19], a[224:227], a[4:7], v[16:19]
    ds_read_b64_tr_b16 a[242:243], v232 offset:18432
    buffer_load_dwordx4 a[52:55], v185, s[16:19], s71 offen offset:3072
    v_mfma_f32_16x16x32_bf16 v[20:23], a[228:231], a[4:7], v[20:23]
    ds_read_b64_tr_b16 a[244:245], v233 offset:16384
    v_mfma_f32_16x16x32_bf16 v[24:27], a[232:235], a[4:7], v[24:27]
    ds_read_b64_tr_b16 a[246:247], v233 offset:18432
    v_mfma_f32_16x16x32_bf16 v[28:31], a[236:239], a[4:7], v[28:31]
    ds_read_b64_tr_b16 a[248:249], v234 offset:16384
    s_waitcnt vmcnt(12)
    v_mfma_f32_16x16x32_bf16 v[32:35], a[224:227], a[8:11], v[32:35]
    ds_read_b64_tr_b16 a[250:251], v234 offset:18432
    buffer_load_dwordx4 a[56:59], v186, s[16:19], s71 offen offset:3072
    v_mfma_f32_16x16x32_bf16 v[36:39], a[228:231], a[8:11], v[36:39]
    ds_read_b64_tr_b16 a[252:253], v235 offset:16384
    v_mfma_f32_16x16x32_bf16 v[40:43], a[232:235], a[8:11], v[40:43]
    ds_read_b64_tr_b16 a[254:255], v235 offset:18432
    v_mfma_f32_16x16x32_bf16 v[44:47], a[236:239], a[8:11], v[44:47]
    s_waitcnt vmcnt(12)
    v_mfma_f32_16x16x32_bf16 v[48:51], a[224:227], a[12:15], v[48:51]
    buffer_load_dwordx4 a[60:63], v187, s[16:19], s71 offen offset:3072
    v_mfma_f32_16x16x32_bf16 v[52:55], a[228:231], a[12:15], v[52:55]
    v_mfma_f32_16x16x32_bf16 v[56:59], a[232:235], a[12:15], v[56:59]
    v_mfma_f32_16x16x32_bf16 v[60:63], a[236:239], a[12:15], v[60:63]
    s_waitcnt lgkmcnt(6)
    s_waitcnt vmcnt(12)
    v_mfma_f32_16x16x32_bf16 v[0:3], a[240:243], a[16:19], v[0:3]
    s_add_u32 s71, s69, 12288
    buffer_load_dwordx4 a[0:3], v184, s[16:19], s71 offen
    s_waitcnt lgkmcnt(4)
    v_mfma_f32_16x16x32_bf16 v[4:7], a[244:247], a[16:19], v[4:7]
    s_waitcnt lgkmcnt(2)
    v_mfma_f32_16x16x32_bf16 v[8:11], a[248:251], a[16:19], v[8:11]
    s_waitcnt lgkmcnt(0)
    v_mfma_f32_16x16x32_bf16 v[12:15], a[252:255], a[16:19], v[12:15]
    ds_read_b64_tr_b16 a[224:225], v232 offset:32768
    s_waitcnt vmcnt(12)
    v_mfma_f32_16x16x32_bf16 v[16:19], a[240:243], a[20:23], v[16:19]
    ds_read_b64_tr_b16 a[226:227], v232 offset:34816
    buffer_load_dwordx4 a[4:7], v185, s[16:19], s71 offen
    v_mfma_f32_16x16x32_bf16 v[20:23], a[244:247], a[20:23], v[20:23]
    ds_read_b64_tr_b16 a[228:229], v233 offset:32768
    v_mfma_f32_16x16x32_bf16 v[24:27], a[248:251], a[20:23], v[24:27]
    ds_read_b64_tr_b16 a[230:231], v233 offset:34816
    v_mfma_f32_16x16x32_bf16 v[28:31], a[252:255], a[20:23], v[28:31]
    ds_read_b64_tr_b16 a[232:233], v234 offset:32768
    s_waitcnt vmcnt(12)
    v_mfma_f32_16x16x32_bf16 v[32:35], a[240:243], a[24:27], v[32:35]
    ds_read_b64_tr_b16 a[234:235], v234 offset:34816
    buffer_load_dwordx4 a[8:11], v186, s[16:19], s71 offen
    v_mfma_f32_16x16x32_bf16 v[36:39], a[244:247], a[24:27], v[36:39]
    ds_read_b64_tr_b16 a[236:237], v235 offset:32768
    v_mfma_f32_16x16x32_bf16 v[40:43], a[248:251], a[24:27], v[40:43]
    ds_read_b64_tr_b16 a[238:239], v235 offset:34816
    v_mfma_f32_16x16x32_bf16 v[44:47], a[252:255], a[24:27], v[44:47]
    s_waitcnt vmcnt(12)
    v_mfma_f32_16x16x32_bf16 v[48:51], a[240:243], a[28:31], v[48:51]
    buffer_load_dwordx4 a[12:15], v187, s[16:19], s71 offen
    v_mfma_f32_16x16x32_bf16 v[52:55], a[244:247], a[28:31], v[52:55]
    v_mfma_f32_16x16x32_bf16 v[56:59], a[248:251], a[28:31], v[56:59]
    v_mfma_f32_16x16x32_bf16 v[60:63], a[252:255], a[28:31], v[60:63]
    s_waitcnt lgkmcnt(6)
    s_waitcnt vmcnt(12)
    v_mfma_f32_16x16x32_bf16 v[0:3], a[224:227], a[32:35], v[0:3]
    buffer_load_dwordx4 a[16:19], v184, s[16:19], s71 offen offset:1024
    s_waitcnt lgkmcnt(4)
    v_mfma_f32_16x16x32_bf16 v[4:7], a[228:231], a[32:35], v[4:7]
    s_waitcnt lgkmcnt(2)
    v_mfma_f32_16x16x32_bf16 v[8:11], a[232:235], a[32:35], v[8:11]
    s_waitcnt lgkmcnt(0)
    v_mfma_f32_16x16x32_bf16 v[12:15], a[236:239], a[32:35], v[12:15]
    ds_read_b64_tr_b16 a[240:241], v232 offset:49152
    s_waitcnt vmcnt(12)
    v_mfma_f32_16x16x32_bf16 v[16:19], a[224:227], a[36:39], v[16:19]
    ds_read_b64_tr_b16 a[242:243], v232 offset:51200
    buffer_load_dwordx4 a[20:23], v185, s[16:19], s71 offen offset:1024
    v_mfma_f32_16x16x32_bf16 v[20:23], a[228:231], a[36:39], v[20:23]
    ds_read_b64_tr_b16 a[244:245], v233 offset:49152
    v_mfma_f32_16x16x32_bf16 v[24:27], a[232:235], a[36:39], v[24:27]
    ds_read_b64_tr_b16 a[246:247], v233 offset:51200
    v_mfma_f32_16x16x32_bf16 v[28:31], a[236:239], a[36:39], v[28:31]
    ds_read_b64_tr_b16 a[248:249], v234 offset:49152
    s_waitcnt vmcnt(12)
    v_mfma_f32_16x16x32_bf16 v[32:35], a[224:227], a[40:43], v[32:35]
    ds_read_b64_tr_b16 a[250:251], v234 offset:51200
    buffer_load_dwordx4 a[24:27], v186, s[16:19], s71 offen offset:1024
    v_mfma_f32_16x16x32_bf16 v[36:39], a[228:231], a[40:43], v[36:39]
    ds_read_b64_tr_b16 a[252:253], v235 offset:49152
    v_mfma_f32_16x16x32_bf16 v[40:43], a[232:235], a[40:43], v[40:43]
    ds_read_b64_tr_b16 a[254:255], v235 offset:51200
    v_mfma_f32_16x16x32_bf16 v[44:47], a[236:239], a[40:43], v[44:47]
    s_waitcnt vmcnt(12)
    v_mfma_f32_16x16x32_bf16 v[48:51], a[224:227], a[44:47], v[48:51]
    buffer_load_dwordx4 a[28:31], v187, s[16:19], s71 offen offset:1024
    v_mfma_f32_16x16x32_bf16 v[52:55], a[228:231], a[44:47], v[52:55]
    v_mfma_f32_16x16x32_bf16 v[56:59], a[232:235], a[44:47], v[56:59]
    v_mfma_f32_16x16x32_bf16 v[60:63], a[236:239], a[44:47], v[60:63]
    s_mov_b32 s80, 0
    s_mov_b32 s81, 0x00ff00ff
    s_waitcnt vmcnt(12)
    v_cmp_eq_u32 vcc, s38, v189
    s_nop 0
    s_and_b64 s[82:83], vcc, s[80:81]
    s_cmp_eq_u64 s[82:83], s[80:81]
    s_cbranch_scc1 L_opoll_ok_16
    s_mov_b32 s5, 0
L_opoll_15:
    buffer_load_dword v189, v188, s[16:19], 0 offen sc1
    s_waitcnt vmcnt(0)
    v_cmp_eq_u32 vcc, s38, v189
    s_nop 0
    s_and_b64 s[82:83], vcc, s[80:81]
    s_cmp_eq_u64 s[82:83], s[80:81]
    s_cbranch_scc1 L_opoll_ok_16
    s_add_u32 s5, s5, 1
    s_cmp_lt_u32 s5, 131072
    s_cbranch_scc1 L_opoll_15
L_opoll_ok_16:
    buffer_load_dword v134, v156, s[16:19], 0 offen
    buffer_load_dword v135, v157, s[16:19], 0 offen
    buffer_load_dword v136, v158, s[16:19], 0 offen
    buffer_load_dword v137, v159, s[16:19], 0 offen
    s_waitcnt lgkmcnt(6)
    s_waitcnt vmcnt(15)
    v_mfma_f32_16x16x32_bf16 v[0:3], a[240:243], a[48:51], v[0:3]
    buffer_load_dwordx4 a[32:35], v184, s[16:19], s70 offen
    s_waitcnt lgkmcnt(4)
    v_mfma_f32_16x16x32_bf16 v[4:7], a[244:247], a[48:51], v[4:7]
    s_waitcnt lgkmcnt(2)
    v_mfma_f32_16x16x32_bf16 v[8:11], a[248:251], a[48:51], v[8:11]
    s_waitcnt lgkmcnt(0)
    v_mfma_f32_16x16x32_bf16 v[12:15], a[252:255], a[48:51], v[12:15]
    ds_read_b64_tr_b16 a[224:225], v164
    s_waitcnt vmcnt(15)
    v_mfma_f32_16x16x32_bf16 v[16:19], a[240:243], a[52:55], v[16:19]
    ds_read_b64_tr_b16 a[226:227], v164 offset:2048
    buffer_load_dwordx4 a[36:39], v190, s[16:19], s70 offen
    v_mfma_f32_16x16x32_bf16 v[20:23], a[244:247], a[52:55], v[20:23]
    ds_read_b64_tr_b16 a[228:229], v165
    v_mfma_f32_16x16x32_bf16 v[24:27], a[248:251], a[52:55], v[24:27]
    ds_read_b64_tr_b16 a[230:231], v165 offset:2048
    v_mfma_f32_16x16x32_bf16 v[28:31], a[252:255], a[52:55], v[28:31]
    ds_read_b64_tr_b16 a[232:233], v166
    s_waitcnt vmcnt(15)
    v_mfma_f32_16x16x32_bf16 v[32:35], a[240:243], a[56:59], v[32:35]
    ds_read_b64_tr_b16 a[234:235], v166 offset:2048
    buffer_load_dwordx4 a[40:43], v191, s[16:19], s70 offen
    v_mfma_f32_16x16x32_bf16 v[36:39], a[244:247], a[56:59], v[36:39]
    ds_read_b64_tr_b16 a[236:237], v167
    v_mfma_f32_16x16x32_bf16 v[40:43], a[248:251], a[56:59], v[40:43]
    ds_read_b64_tr_b16 a[238:239], v167 offset:2048
    v_mfma_f32_16x16x32_bf16 v[44:47], a[252:255], a[56:59], v[44:47]
    s_waitcnt vmcnt(15)
    v_mfma_f32_16x16x32_bf16 v[48:51], a[240:243], a[60:63], v[48:51]
    buffer_load_dwordx4 a[44:47], v192, s[16:19], s70 offen
    v_mfma_f32_16x16x32_bf16 v[52:55], a[244:247], a[60:63], v[52:55]
    v_mfma_f32_16x16x32_bf16 v[56:59], a[248:251], a[60:63], v[56:59]
    v_mfma_f32_16x16x32_bf16 v[60:63], a[252:255], a[60:63], v[60:63]
    s_waitcnt lgkmcnt(6)
    s_waitcnt vmcnt(15)
    v_mfma_f32_16x16x32_bf16 v[0:3], a[224:227], a[0:3], v[0:3]
    buffer_load_dwordx4 a[48:51], v184, s[16:19], s70 offen offset:1024
    s_waitcnt lgkmcnt(4)
    v_mfma_f32_16x16x32_bf16 v[4:7], a[228:231], a[0:3], v[4:7]
    s_waitcnt lgkmcnt(2)
    v_mfma_f32_16x16x32_bf16 v[8:11], a[232:235], a[0:3], v[8:11]
    s_waitcnt lgkmcnt(0)
    v_mfma_f32_16x16x32_bf16 v[12:15], a[236:239], a[0:3], v[12:15]
    ds_read_b64_tr_b16 a[240:241], v164 offset:16384
    s_waitcnt vmcnt(15)
    v_mfma_f32_16x16x32_bf16 v[16:19], a[224:227], a[4:7], v[16:19]
    ds_read_b64_tr_b16 a[242:243], v164 offset:18432
    buffer_load_dwordx4 a[52:55], v190, s[16:19], s70 offen offset:1024
    v_mfma_f32_16x16x32_bf16 v[20:23], a[228:231], a[4:7], v[20:23]
    ds_read_b64_tr_b16 a[244:245], v165 offset:16384
    v_mfma_f32_16x16x32_bf16 v[24:27], a[232:235], a[4:7], v[24:27]
    ds_read_b64_tr_b16 a[246:247], v165 offset:18432
    v_mfma_f32_16x16x32_bf16 v[28:31], a[236:239], a[4:7], v[28:31]
    ds_read_b64_tr_b16 a[248:249], v166 offset:16384
    s_waitcnt vmcnt(15)
    v_mfma_f32_16x16x32_bf16 v[32:35], a[224:227], a[8:11], v[32:35]
    ds_read_b64_tr_b16 a[250:251], v166 offset:18432
    buffer_load_dwordx4 a[56:59], v191, s[16:19], s70 offen offset:1024
    v_mfma_f32_16x16x32_bf16 v[36:39], a[228:231], a[8:11], v[36:39]
    ds_read_b64_tr_b16 a[252:253], v167 offset:16384
    v_mfma_f32_16x16x32_bf16 v[40:43], a[232:235], a[8:11], v[40:43]
    ds_read_b64_tr_b16 a[254:255], v167 offset:18432
    v_mfma_f32_16x16x32_bf16 v[44:47], a[236:239], a[8:11], v[44:47]
    s_waitcnt vmcnt(15)
    v_mfma_f32_16x16x32_bf16 v[48:51], a[224:227], a[12:15], v[48:51]
    buffer_load_dwordx4 a[60:63], v192, s[16:19], s70 offen offset:1024
    v_mfma_f32_16x16x32_bf16 v[52:55], a[228:231], a[12:15], v[52:55]
    v_mfma_f32_16x16x32_bf16 v[56:59], a[232:235], a[12:15], v[56:59]
    v_mfma_f32_16x16x32_bf16 v[60:63], a[236:239], a[12:15], v[60:63]
    s_waitcnt lgkmcnt(6)
    s_waitcnt vmcnt(15)
    v_mfma_f32_16x16x32_bf16 v[0:3], a[240:243], a[16:19], v[0:3]
    buffer_load_dwordx4 a[0:3], v184, s[16:19], s70 offen offset:2048
    s_waitcnt lgkmcnt(4)
    v_mfma_f32_16x16x32_bf16 v[4:7], a[244:247], a[16:19], v[4:7]
    s_waitcnt lgkmcnt(2)
    v_mfma_f32_16x16x32_bf16 v[8:11], a[248:251], a[16:19], v[8:11]
    s_waitcnt lgkmcnt(0)
    v_mfma_f32_16x16x32_bf16 v[12:15], a[252:255], a[16:19], v[12:15]
    ds_read_b64_tr_b16 a[224:225], v164 offset:32768
    s_waitcnt vmcnt(15)
    v_mfma_f32_16x16x32_bf16 v[16:19], a[240:243], a[20:23], v[16:19]
    ds_read_b64_tr_b16 a[226:227], v164 offset:34816
    buffer_load_dwordx4 a[4:7], v190, s[16:19], s70 offen offset:2048
    v_mfma_f32_16x16x32_bf16 v[20:23], a[244:247], a[20:23], v[20:23]
    ds_read_b64_tr_b16 a[228:229], v165 offset:32768
    v_mfma_f32_16x16x32_bf16 v[24:27], a[248:251], a[20:23], v[24:27]
    ds_read_b64_tr_b16 a[230:231], v165 offset:34816
    v_mfma_f32_16x16x32_bf16 v[28:31], a[252:255], a[20:23], v[28:31]
    ds_read_b64_tr_b16 a[232:233], v166 offset:32768
    s_waitcnt vmcnt(15)
    v_mfma_f32_16x16x32_bf16 v[32:35], a[240:243], a[24:27], v[32:35]
    ds_read_b64_tr_b16 a[234:235], v166 offset:34816
    buffer_load_dwordx4 a[8:11], v191, s[16:19], s70 offen offset:2048
    v_mfma_f32_16x16x32_bf16 v[36:39], a[244:247], a[24:27], v[36:39]
    ds_read_b64_tr_b16 a[236:237], v167 offset:32768
    v_mfma_f32_16x16x32_bf16 v[40:43], a[248:251], a[24:27], v[40:43]
    ds_read_b64_tr_b16 a[238:239], v167 offset:34816
    v_mfma_f32_16x16x32_bf16 v[44:47], a[252:255], a[24:27], v[44:47]
    s_waitcnt vmcnt(15)
    v_mfma_f32_16x16x32_bf16 v[48:51], a[240:243], a[28:31], v[48:51]
    buffer_load_dwordx4 a[12:15], v192, s[16:19], s70 offen offset:2048
    v_mfma_f32_16x16x32_bf16 v[52:55], a[244:247], a[28:31], v[52:55]
    v_mfma_f32_16x16x32_bf16 v[56:59], a[248:251], a[28:31], v[56:59]
    v_mfma_f32_16x16x32_bf16 v[60:63], a[252:255], a[28:31], v[60:63]
    s_waitcnt lgkmcnt(6)
    s_waitcnt vmcnt(11)
    v_mfma_f32_16x16x32_bf16 v[64:67], a[224:227], a[32:35], 0
    buffer_load_dwordx4 a[16:19], v184, s[16:19], s70 offen offset:3072
    s_waitcnt lgkmcnt(4)
    v_mfma_f32_16x16x32_bf16 v[68:71], a[228:231], a[32:35], 0
    s_waitcnt lgkmcnt(2)
    v_mfma_f32_16x16x32_bf16 v[72:75], a[232:235], a[32:35], 0
    s_waitcnt lgkmcnt(0)
    v_mfma_f32_16x16x32_bf16 v[76:79], a[236:239], a[32:35], 0
    ds_read_b64_tr_b16 a[240:241], v164 offset:49152
    s_waitcnt vmcnt(11)
    v_mfma_f32_16x16x32_bf16 v[80:83], a[224:227], a[36:39], 0
    ds_read_b64_tr_b16 a[242:243], v164 offset:51200
    buffer_load_dwordx4 a[20:23], v190, s[16:19], s70 offen offset:3072
    v_mfma_f32_16x16x32_bf16 v[84:87], a[228:231], a[36:39], 0
    ds_read_b64_tr_b16 a[244:245], v165 offset:49152
    v_mfma_f32_16x16x32_bf16 v[88:91], a[232:235], a[36:39], 0
    ds_read_b64_tr_b16 a[246:247], v165 offset:51200
    v_mfma_f32_16x16x32_bf16 v[92:95], a[236:239], a[36:39], 0
    ds_read_b64_tr_b16 a[248:249], v166 offset:49152
    s_waitcnt vmcnt(11)
    v_mfma_f32_16x16x32_bf16 v[96:99], a[224:227], a[40:43], 0
    ds_read_b64_tr_b16 a[250:251], v166 offset:51200
    buffer_load_dwordx4 a[24:27], v191, s[16:19], s70 offen offset:3072
    v_mfma_f32_16x16x32_bf16 v[100:103], a[228:231], a[40:43], 0
    ds_read_b64_tr_b16 a[252:253], v167 offset:49152
    v_mfma_f32_16x16x32_bf16 v[104:107], a[232:235], a[40:43], 0
    ds_read_b64_tr_b16 a[254:255], v167 offset:51200
    v_mfma_f32_16x16x32_bf16 v[108:111], a[236:239], a[40:43], 0
    s_waitcnt vmcnt(11)
    v_mfma_f32_16x16x32_bf16 v[112:115], a[224:227], a[44:47], 0
    buffer_load_dwordx4 a[28:31], v192, s[16:19], s70 offen offset:3072
    v_mfma_f32_16x16x32_bf16 v[116:119], a[228:231], a[44:47], 0
    v_mfma_f32_16x16x32_bf16 v[120:123], a[232:235], a[44:47], 0
    v_mfma_f32_16x16x32_bf16 v[124:127], a[236:239], a[44:47], 0
    v_sub_f32 v160, 1.0, v134
    v_sub_f32 v161, 1.0, v135
    s_waitcnt lgkmcnt(6)
    s_waitcnt vmcnt(11)
    v_mfma_f32_16x16x32_bf16 v[64:67], a[240:243], a[48:51], v[64:67]
    v_sub_f32 v162, 1.0, v136
    v_sub_f32 v163, 1.0, v137
    s_waitcnt lgkmcnt(4)
    v_mfma_f32_16x16x32_bf16 v[68:71], a[244:247], a[48:51], v[68:71]
    v_mul_f32 v0, v160, v0
    v_mul_f32 v1, v160, v1
    s_waitcnt lgkmcnt(2)
    v_mfma_f32_16x16x32_bf16 v[72:75], a[248:251], a[48:51], v[72:75]
    v_mul_f32 v2, v160, v2
    v_mul_f32 v3, v160, v3
    s_waitcnt lgkmcnt(0)
    v_mfma_f32_16x16x32_bf16 v[76:79], a[252:255], a[48:51], v[76:79]
    ds_read_b64_tr_b16 a[224:225], v168
    v_mul_f32 v4, v160, v4
    v_mul_f32 v5, v160, v5
    s_waitcnt vmcnt(10)
    v_mfma_f32_16x16x32_bf16 v[80:83], a[240:243], a[52:55], v[80:83]
    ds_read_b64_tr_b16 a[226:227], v168 offset:2048
    v_mul_f32 v6, v160, v6
    v_mul_f32 v7, v160, v7
    v_mfma_f32_16x16x32_bf16 v[84:87], a[244:247], a[52:55], v[84:87]
    ds_read_b64_tr_b16 a[228:229], v169
    v_mul_f32 v8, v160, v8
    v_mul_f32 v9, v160, v9
    v_mfma_f32_16x16x32_bf16 v[88:91], a[248:251], a[52:55], v[88:91]
    ds_read_b64_tr_b16 a[230:231], v169 offset:2048
    v_mul_f32 v10, v160, v10
    v_mul_f32 v11, v160, v11
    v_mfma_f32_16x16x32_bf16 v[92:95], a[252:255], a[52:55], v[92:95]
    ds_read_b64_tr_b16 a[232:233], v170
    v_mul_f32 v12, v160, v12
    v_mul_f32 v13, v160, v13
    s_waitcnt vmcnt(9)
    v_mfma_f32_16x16x32_bf16 v[96:99], a[240:243], a[56:59], v[96:99]
    ds_read_b64_tr_b16 a[234:235], v170 offset:2048
    v_mul_f32 v14, v160, v14
    v_mul_f32 v15, v160, v15
    v_mfma_f32_16x16x32_bf16 v[100:103], a[244:247], a[56:59], v[100:103]
    ds_read_b64_tr_b16 a[236:237], v171
    v_mul_f32 v16, v161, v16
    v_mul_f32 v17, v161, v17
    v_mfma_f32_16x16x32_bf16 v[104:107], a[248:251], a[56:59], v[104:107]
    ds_read_b64_tr_b16 a[238:239], v171 offset:2048
    v_mul_f32 v18, v161, v18
    v_mul_f32 v19, v161, v19
    v_mfma_f32_16x16x32_bf16 v[108:111], a[252:255], a[56:59], v[108:111]
    v_mul_f32 v20, v161, v20
    v_mul_f32 v21, v161, v21
    s_waitcnt vmcnt(8)
    v_mfma_f32_16x16x32_bf16 v[112:115], a[240:243], a[60:63], v[112:115]
    v_mul_f32 v22, v161, v22
    v_mul_f32 v23, v161, v23
    v_mfma_f32_16x16x32_bf16 v[116:119], a[244:247], a[60:63], v[116:119]
    v_mul_f32 v24, v161, v24
    v_mul_f32 v25, v161, v25
    v_mfma_f32_16x16x32_bf16 v[120:123], a[248:251], a[60:63], v[120:123]
    v_mul_f32 v26, v161, v26
    v_mul_f32 v27, v161, v27
    v_mfma_f32_16x16x32_bf16 v[124:127], a[252:255], a[60:63], v[124:127]
    v_mul_f32 v28, v161, v28
    v_mul_f32 v29, v161, v29
    s_waitcnt lgkmcnt(6)
    s_waitcnt vmcnt(7)
    v_mfma_f32_16x16x32_bf16 v[64:67], a[224:227], a[0:3], v[64:67]
    v_mul_f32 v30, v161, v30
    v_mul_f32 v31, v161, v31
    s_waitcnt lgkmcnt(4)
    v_mfma_f32_16x16x32_bf16 v[68:71], a[228:231], a[0:3], v[68:71]
    v_mul_f32 v32, v162, v32
    v_mul_f32 v33, v162, v33
    s_waitcnt lgkmcnt(2)
    v_mfma_f32_16x16x32_bf16 v[72:75], a[232:235], a[0:3], v[72:75]
    v_mul_f32 v34, v162, v34
    v_mul_f32 v35, v162, v35
    s_waitcnt lgkmcnt(0)
    v_mfma_f32_16x16x32_bf16 v[76:79], a[236:239], a[0:3], v[76:79]
    ds_read_b64_tr_b16 a[240:241], v168 offset:16384
    v_mul_f32 v36, v162, v36
    v_mul_f32 v37, v162, v37
    s_waitcnt vmcnt(6)
    v_mfma_f32_16x16x32_bf16 v[80:83], a[224:227], a[4:7], v[80:83]
    ds_read_b64_tr_b16 a[242:243], v168 offset:18432
    v_mul_f32 v38, v162, v38
    v_mul_f32 v39, v162, v39
    v_mfma_f32_16x16x32_bf16 v[84:87], a[228:231], a[4:7], v[84:87]
    ds_read_b64_tr_b16 a[244:245], v169 offset:16384
    v_mul_f32 v40, v162, v40
    v_mul_f32 v41, v162, v41
    v_mfma_f32_16x16x32_bf16 v[88:91], a[232:235], a[4:7], v[88:91]
    ds_read_b64_tr_b16 a[246:247], v169 offset:18432
    v_mul_f32 v42, v162, v42
    v_mul_f32 v43, v162, v43
    v_mfma_f32_16x16x32_bf16 v[92:95], a[236:239], a[4:7], v[92:95]
    ds_read_b64_tr_b16 a[248:249], v170 offset:16384
    s_xor_b32 s74, s2, 210
    s_or_b32 s74, s74, s64
    s_cmp_lg_u32 s74, 0
    s_cbranch_scc1 L_eld_17
    v_lshrrev_b32 v193, 4, v254
    v_lshlrev_b32 v193, 7, v193
    v_and_b32 v194, 15, v254
    v_lshl_add_u32 v193, v194, 2, v193
    v_add_u32 v193, 13631488, v193
    s_mov_b32 s75, 0
    buffer_load_dword v194, v193, s[16:19], s75 offen sc1
    s_mov_b32 s75, 512
    buffer_load_dword v195, v193, s[16:19], s75 offen sc1
    s_mov_b32 s75, 1024
    buffer_load_dword v196, v193, s[16:19], s75 offen sc1
    s_mov_b32 s75, 4096
    buffer_load_dword v197, v193, s[16:19], s75 offen sc1
    s_mov_b32 s75, 4608
    buffer_load_dword v198, v193, s[16:19], s75 offen sc1
    s_mov_b32 s75, 5120
    buffer_load_dword v199, v193, s[16:19], s75 offen sc1
L_eld_17:
    v_mul_f32 v44, v162, v44
    v_mul_f32 v45, v162, v45
    s_waitcnt vmcnt(5)
    v_mfma_f32_16x16x32_bf16 v[96:99], a[224:227], a[8:11], v[96:99]
    ds_read_b64_tr_b16 a[250:251], v170 offset:18432
    v_mul_f32 v46, v162, v46
    v_mul_f32 v47, v162, v47
    v_mfma_f32_16x16x32_bf16 v[100:103], a[228:231], a[8:11], v[100:103]
    ds_read_b64_tr_b16 a[252:253], v171 offset:16384
    v_mul_f32 v48, v163, v48
    v_mul_f32 v49, v163, v49
    v_mfma_f32_16x16x32_bf16 v[104:107], a[232:235], a[8:11], v[104:107]
    ds_read_b64_tr_b16 a[254:255], v171 offset:18432
    v_mul_f32 v50, v163, v50
    v_mul_f32 v51, v163, v51
    v_mfma_f32_16x16x32_bf16 v[108:111], a[236:239], a[8:11], v[108:111]
    v_mul_f32 v52, v163, v52
    v_mul_f32 v53, v163, v53
    s_waitcnt vmcnt(4)
    v_mfma_f32_16x16x32_bf16 v[112:115], a[224:227], a[12:15], v[112:115]
    v_mul_f32 v54, v163, v54
    v_mul_f32 v55, v163, v55
    v_mfma_f32_16x16x32_bf16 v[116:119], a[228:231], a[12:15], v[116:119]
    v_mul_f32 v56, v163, v56
    v_mul_f32 v57, v163, v57
    v_mfma_f32_16x16x32_bf16 v[120:123], a[232:235], a[12:15], v[120:123]
    v_mul_f32 v58, v163, v58
    v_mul_f32 v59, v163, v59
    v_mfma_f32_16x16x32_bf16 v[124:127], a[236:239], a[12:15], v[124:127]
    v_mul_f32 v60, v163, v60
    v_mul_f32 v61, v163, v61
    s_waitcnt lgkmcnt(6)
    s_waitcnt vmcnt(3)
    v_mfma_f32_16x16x32_bf16 v[64:67], a[240:243], a[16:19], v[64:67]
    v_mul_f32 v62, v163, v62
    v_mul_f32 v63, v163, v63
    s_waitcnt lgkmcnt(4)
    v_mfma_f32_16x16x32_bf16 v[68:71], a[244:247], a[16:19], v[68:71]
    v_lshlrev_b32 v148, 4, v254
    v_add_u32 v149, s4, v148
    s_waitcnt lgkmcnt(2)
    v_mfma_f32_16x16x32_bf16 v[72:75], a[248:251], a[16:19], v[72:75]
    s_waitcnt lgkmcnt(0)
    v_mfma_f32_16x16x32_bf16 v[76:79], a[252:255], a[16:19], v[76:79]
    s_waitcnt vmcnt(2)
    v_mfma_f32_16x16x32_bf16 v[80:83], a[240:243], a[20:23], v[80:83]
    v_mfma_f32_16x16x32_bf16 v[84:87], a[244:247], a[20:23], v[84:87]
    v_mfma_f32_16x16x32_bf16 v[88:91], a[248:251], a[20:23], v[88:91]
    v_mfma_f32_16x16x32_bf16 v[92:95], a[252:255], a[20:23], v[92:95]
    s_waitcnt vmcnt(1)
    v_mfma_f32_16x16x32_bf16 v[96:99], a[240:243], a[24:27], v[96:99]
    v_mfma_f32_16x16x32_bf16 v[100:103], a[244:247], a[24:27], v[100:103]
    v_mfma_f32_16x16x32_bf16 v[104:107], a[248:251], a[24:27], v[104:107]
    v_mfma_f32_16x16x32_bf16 v[108:111], a[252:255], a[24:27], v[108:111]
    s_waitcnt vmcnt(0)
    v_mfma_f32_16x16x32_bf16 v[112:115], a[240:243], a[28:31], v[112:115]
    v_mfma_f32_16x16x32_bf16 v[116:119], a[244:247], a[28:31], v[116:119]
    v_mfma_f32_16x16x32_bf16 v[120:123], a[248:251], a[28:31], v[120:123]
    v_mfma_f32_16x16x32_bf16 v[124:127], a[252:255], a[28:31], v[124:127]
    v_pk_fma_f32 v[0:1], v[64:65], v[134:135], v[0:1] op_sel:[0,0,0] op_sel_hi:[1,0,1]
    v_pk_fma_f32 v[2:3], v[66:67], v[134:135], v[2:3] op_sel:[0,0,0] op_sel_hi:[1,0,1]
    v_pk_fma_f32 v[4:5], v[68:69], v[134:135], v[4:5] op_sel:[0,0,0] op_sel_hi:[1,0,1]
    v_pk_fma_f32 v[6:7], v[70:71], v[134:135], v[6:7] op_sel:[0,0,0] op_sel_hi:[1,0,1]
    v_pk_fma_f32 v[8:9], v[72:73], v[134:135], v[8:9] op_sel:[0,0,0] op_sel_hi:[1,0,1]
    v_pk_fma_f32 v[10:11], v[74:75], v[134:135], v[10:11] op_sel:[0,0,0] op_sel_hi:[1,0,1]
    v_pk_fma_f32 v[12:13], v[76:77], v[134:135], v[12:13] op_sel:[0,0,0] op_sel_hi:[1,0,1]
    v_pk_fma_f32 v[14:15], v[78:79], v[134:135], v[14:15] op_sel:[0,0,0] op_sel_hi:[1,0,1]
    s_cmp_eq_u32 s64, 0
    s_cbranch_scc1 L_own_18
    s_sub_u32 s74, 3, s64
    s_and_b32 s74, s74, 3
    s_lshl_b32 s74, s74, 14
    v_add_u32 v150, s74, v149
    ds_write_b128 v150, v[0:3]
    ds_write_b128 v150, v[4:7] offset:1024
    ds_write_b128 v150, v[8:11] offset:2048
    ds_write_b128 v150, v[12:15] offset:3072
    s_branch L_ownj_19
L_own_18:
    v_pk_mul_f32 v[64:65], v[0:1], 1.0 op_sel_hi:[1,0]
    v_pk_mul_f32 v[66:67], v[2:3], 1.0 op_sel_hi:[1,0]
    v_pk_mul_f32 v[68:69], v[4:5], 1.0 op_sel_hi:[1,0]
    v_pk_mul_f32 v[70:71], v[6:7], 1.0 op_sel_hi:[1,0]
    v_pk_mul_f32 v[72:73], v[8:9], 1.0 op_sel_hi:[1,0]
    v_pk_mul_f32 v[74:75], v[10:11], 1.0 op_sel_hi:[1,0]
    v_pk_mul_f32 v[76:77], v[12:13], 1.0 op_sel_hi:[1,0]
    v_pk_mul_f32 v[78:79], v[14:15], 1.0 op_sel_hi:[1,0]
L_ownj_19:
    v_pk_fma_f32 v[16:17], v[80:81], v[134:135], v[16:17] op_sel:[0,1,0] op_sel_hi:[1,1,1]
    v_pk_fma_f32 v[18:19], v[82:83], v[134:135], v[18:19] op_sel:[0,1,0] op_sel_hi:[1,1,1]
    v_pk_fma_f32 v[20:21], v[84:85], v[134:135], v[20:21] op_sel:[0,1,0] op_sel_hi:[1,1,1]
    v_pk_fma_f32 v[22:23], v[86:87], v[134:135], v[22:23] op_sel:[0,1,0] op_sel_hi:[1,1,1]
    v_pk_fma_f32 v[24:25], v[88:89], v[134:135], v[24:25] op_sel:[0,1,0] op_sel_hi:[1,1,1]
    v_pk_fma_f32 v[26:27], v[90:91], v[134:135], v[26:27] op_sel:[0,1,0] op_sel_hi:[1,1,1]
    v_pk_fma_f32 v[28:29], v[92:93], v[134:135], v[28:29] op_sel:[0,1,0] op_sel_hi:[1,1,1]
    v_pk_fma_f32 v[30:31], v[94:95], v[134:135], v[30:31] op_sel:[0,1,0] op_sel_hi:[1,1,1]
    s_cmp_eq_u32 s64, 1
    s_cbranch_scc1 L_own_20
    s_sub_u32 s74, 4, s64
    s_and_b32 s74, s74, 3
    s_lshl_b32 s74, s74, 14
    v_add_u32 v150, s74, v149
    ds_write_b128 v150, v[16:19]
    ds_write_b128 v150, v[20:23] offset:1024
    ds_write_b128 v150, v[24:27] offset:2048
    ds_write_b128 v150, v[28:31] offset:3072
    s_branch L_ownj_21
L_own_20:
    v_pk_mul_f32 v[64:65], v[16:17], 1.0 op_sel_hi:[1,0]
    v_pk_mul_f32 v[66:67], v[18:19], 1.0 op_sel_hi:[1,0]
    v_pk_mul_f32 v[68:69], v[20:21], 1.0 op_sel_hi:[1,0]
    v_pk_mul_f32 v[70:71], v[22:23], 1.0 op_sel_hi:[1,0]
    v_pk_mul_f32 v[72:73], v[24:25], 1.0 op_sel_hi:[1,0]
    v_pk_mul_f32 v[74:75], v[26:27], 1.0 op_sel_hi:[1,0]
    v_pk_mul_f32 v[76:77], v[28:29], 1.0 op_sel_hi:[1,0]
    v_pk_mul_f32 v[78:79], v[30:31], 1.0 op_sel_hi:[1,0]
L_ownj_21:
    v_pk_fma_f32 v[32:33], v[96:97], v[136:137], v[32:33] op_sel:[0,0,0] op_sel_hi:[1,0,1]
    v_pk_fma_f32 v[34:35], v[98:99], v[136:137], v[34:35] op_sel:[0,0,0] op_sel_hi:[1,0,1]
    v_pk_fma_f32 v[36:37], v[100:101], v[136:137], v[36:37] op_sel:[0,0,0] op_sel_hi:[1,0,1]
    v_pk_fma_f32 v[38:39], v[102:103], v[136:137], v[38:39] op_sel:[0,0,0] op_sel_hi:[1,0,1]
    v_pk_fma_f32 v[40:41], v[104:105], v[136:137], v[40:41] op_sel:[0,0,0] op_sel_hi:[1,0,1]
    v_pk_fma_f32 v[42:43], v[106:107], v[136:137], v[42:43] op_sel:[0,0,0] op_sel_hi:[1,0,1]
    v_pk_fma_f32 v[44:45], v[108:109], v[136:137], v[44:45] op_sel:[0,0,0] op_sel_hi:[1,0,1]
    v_pk_fma_f32 v[46:47], v[110:111], v[136:137], v[46:47] op_sel:[0,0,0] op_sel_hi:[1,0,1]
    s_cmp_eq_u32 s64, 2
    s_cbranch_scc1 L_own_22
    s_sub_u32 s74, 5, s64
    s_and_b32 s74, s74, 3
    s_lshl_b32 s74, s74, 14
    v_add_u32 v150, s74, v149
    ds_write_b128 v150, v[32:35]
    ds_write_b128 v150, v[36:39] offset:1024
    ds_write_b128 v150, v[40:43] offset:2048
    ds_write_b128 v150, v[44:47] offset:3072
    s_branch L_ownj_23
L_own_22:
    v_pk_mul_f32 v[64:65], v[32:33], 1.0 op_sel_hi:[1,0]
    v_pk_mul_f32 v[66:67], v[34:35], 1.0 op_sel_hi:[1,0]
    v_pk_mul_f32 v[68:69], v[36:37], 1.0 op_sel_hi:[1,0]
    v_pk_mul_f32 v[70:71], v[38:39], 1.0 op_sel_hi:[1,0]
    v_pk_mul_f32 v[72:73], v[40:41], 1.0 op_sel_hi:[1,0]
    v_pk_mul_f32 v[74:75], v[42:43], 1.0 op_sel_hi:[1,0]
    v_pk_mul_f32 v[76:77], v[44:45], 1.0 op_sel_hi:[1,0]
    v_pk_mul_f32 v[78:79], v[46:47], 1.0 op_sel_hi:[1,0]
L_ownj_23:
    v_pk_fma_f32 v[48:49], v[112:113], v[136:137], v[48:49] op_sel:[0,1,0] op_sel_hi:[1,1,1]
    v_pk_fma_f32 v[50:51], v[114:115], v[136:137], v[50:51] op_sel:[0,1,0] op_sel_hi:[1,1,1]
    v_pk_fma_f32 v[52:53], v[116:117], v[136:137], v[52:53] op_sel:[0,1,0] op_sel_hi:[1,1,1]
    v_pk_fma_f32 v[54:55], v[118:119], v[136:137], v[54:55] op_sel:[0,1,0] op_sel_hi:[1,1,1]
    v_pk_fma_f32 v[56:57], v[120:121], v[136:137], v[56:57] op_sel:[0,1,0] op_sel_hi:[1,1,1]
    v_pk_fma_f32 v[58:59], v[122:123], v[136:137], v[58:59] op_sel:[0,1,0] op_sel_hi:[1,1,1]
    v_pk_fma_f32 v[60:61], v[124:125], v[136:137], v[60:61] op_sel:[0,1,0] op_sel_hi:[1,1,1]
    v_pk_fma_f32 v[62:63], v[126:127], v[136:137], v[62:63] op_sel:[0,1,0] op_sel_hi:[1,1,1]
    s_cmp_eq_u32 s64, 3
    s_cbranch_scc1 L_own_24
    s_sub_u32 s74, 6, s64
    s_and_b32 s74, s74, 3
    s_lshl_b32 s74, s74, 14
    v_add_u32 v150, s74, v149
    ds_write_b128 v150, v[48:51]
    ds_write_b128 v150, v[52:55] offset:1024
    ds_write_b128 v150, v[56:59] offset:2048
    s_waitcnt lgkmcnt(14)
    ds_write_b128 v150, v[60:63] offset:3072
    s_branch L_ownj_25
L_own_24:
    v_pk_mul_f32 v[64:65], v[48:49], 1.0 op_sel_hi:[1,0]
    v_pk_mul_f32 v[66:67], v[50:51], 1.0 op_sel_hi:[1,0]
    v_pk_mul_f32 v[68:69], v[52:53], 1.0 op_sel_hi:[1,0]
    v_pk_mul_f32 v[70:71], v[54:55], 1.0 op_sel_hi:[1,0]
    v_pk_mul_f32 v[72:73], v[56:57], 1.0 op_sel_hi:[1,0]
    v_pk_mul_f32 v[74:75], v[58:59], 1.0 op_sel_hi:[1,0]
    v_pk_mul_f32 v[76:77], v[60:61], 1.0 op_sel_hi:[1,0]
    v_pk_mul_f32 v[78:79], v[62:63], 1.0 op_sel_hi:[1,0]
L_ownj_25:
    s_waitcnt lgkmcnt(0)
    s_barrier
    s_add_u32 s74, s64, 1
    s_and_b32 s74, s74, 3
    s_lshl_b32 s74, s74, 12
    v_add_u32 v151, s74, v148
    s_add_u32 s74, s64, 2
    s_and_b32 s74, s74, 3
    s_lshl_b32 s74, s74, 12
    v_add_u32 v152, s74, v148
    s_add_u32 s74, s64, 3
    s_and_b32 s74, s74, 3
    s_lshl_b32 s74, s74, 12
    v_add_u32 v153, s74, v148
    ds_read_b128 v[4:7], v151 offset:32768
    ds_read_b128 v[8:11], v152 offset:16384
    ds_read_b128 v[12:15], v153
    ds_read_b128 v[20:23], v151 offset:33792
    ds_read_b128 v[24:27], v152 offset:17408
    ds_read_b128 v[28:31], v153 offset:1024
    ds_read_b128 v[36:39], v151 offset:34816
    ds_read_b128 v[40:43], v152 offset:18432
    ds_read_b128 v[44:47], v153 offset:2048
    ds_read_b128 v[52:55], v151 offset:35840
    ds_read_b128 v[56:59], v152 offset:19456
    ds_read_b128 v[60:63], v153 offset:3072
    s_lshl_b32 s74, s67, 2
    s_add_u32 s74, s74, s64
    s_lshl_b32 s74, s74, 14
    s_lshl_b32 s75, s68, 7
    s_add_u32 s74, s74, s75
    v_and_b32 v140, 15, v254
    v_lshlrev_b32 v140, 10, v140
    v_lshrrev_b32 v141, 4, v254
    v_lshl_add_u32 v140, v141, 5, v140
    s_waitcnt lgkmcnt(11)
    v_pk_add_f32 v[0:1], v[64:65], v[4:5]
    v_pk_add_f32 v[2:3], v[66:67], v[6:7]
    s_waitcnt lgkmcnt(9)
    v_pk_add_f32 v[8:9], v[8:9], v[12:13]
    v_pk_add_f32 v[10:11], v[10:11], v[14:15]
    v_pk_add_f32 v[0:1], v[0:1], v[8:9]
    v_pk_add_f32 v[2:3], v[2:3], v[10:11]
    v_cvt_pk_bf16_f32 v80, v0, v1
    v_cvt_pk_bf16_f32 v81, v2, v3
    s_waitcnt lgkmcnt(8)
    v_pk_add_f32 v[16:17], v[68:69], v[20:21]
    v_pk_add_f32 v[18:19], v[70:71], v[22:23]
    s_waitcnt lgkmcnt(6)
    v_pk_add_f32 v[24:25], v[24:25], v[28:29]
    v_pk_add_f32 v[26:27], v[26:27], v[30:31]
    v_pk_add_f32 v[16:17], v[16:17], v[24:25]
    v_pk_add_f32 v[18:19], v[18:19], v[26:27]
    v_cvt_pk_bf16_f32 v82, v16, v17
    v_cvt_pk_bf16_f32 v83, v18, v19
    s_waitcnt lgkmcnt(5)
    v_pk_add_f32 v[32:33], v[72:73], v[36:37]
    v_pk_add_f32 v[34:35], v[74:75], v[38:39]
    s_waitcnt lgkmcnt(3)
    v_pk_add_f32 v[40:41], v[40:41], v[44:45]
    v_pk_add_f32 v[42:43], v[42:43], v[46:47]
    v_pk_add_f32 v[32:33], v[32:33], v[40:41]
    v_pk_add_f32 v[34:35], v[34:35], v[42:43]
    v_cvt_pk_bf16_f32 v84, v32, v33
    v_cvt_pk_bf16_f32 v85, v34, v35
    s_waitcnt lgkmcnt(2)
    v_pk_add_f32 v[48:49], v[76:77], v[52:53]
    v_pk_add_f32 v[50:51], v[78:79], v[54:55]
    s_waitcnt lgkmcnt(0)
    v_pk_add_f32 v[56:57], v[56:57], v[60:61]
    v_pk_add_f32 v[58:59], v[58:59], v[62:63]
    v_pk_add_f32 v[48:49], v[48:49], v[56:57]
    v_pk_add_f32 v[50:51], v[50:51], v[58:59]
    v_cvt_pk_bf16_f32 v86, v48, v49
    v_cvt_pk_bf16_f32 v87, v50, v51
    v_permlane32_swap_b32 v80, v84
    v_permlane32_swap_b32 v82, v86
    v_permlane32_swap_b32 v81, v85
    v_permlane32_swap_b32 v83, v87
    v_permlane16_swap_b32 v80, v82
    v_permlane16_swap_b32 v84, v86
    v_permlane16_swap_b32 v81, v83
    v_permlane16_swap_b32 v85, v87
    buffer_store_dwordx4 v[80:83], v140, s[28:31], s74 offen
    buffer_store_dwordx4 v[84:87], v140, s[28:31], s74 offen offset:16
    s_xor_b32 s74, s2, 210
    s_or_b32 s74, s74, s64
    s_cmp_lg_u32 s74, 0
    s_cbranch_scc1 L_epoch_26
    s_waitcnt vmcnt(2)
    s_mov_b64 s[82:83], -1
    v_cmp_eq_u32 vcc, s38, v194
    s_mov_b32 s80, 0x3fff3fff
    s_mov_b32 s81, 0x3fff3fff
    s_orn2_b64 s[80:81], vcc, s[80:81]
    s_and_b64 s[82:83], s[82:83], s[80:81]
    v_cmp_eq_u32 vcc, s38, v195
    s_mov_b32 s80, 0x3fff3fff
    s_mov_b32 s81, 0x3fff3fff
    s_orn2_b64 s[80:81], vcc, s[80:81]
    s_and_b64 s[82:83], s[82:83], s[80:81]
    v_cmp_eq_u32 vcc, s38, v196
    s_mov_b32 s80, 0x3fff3fff
    s_mov_b32 s81, 0x003f3fff
    s_orn2_b64 s[80:81], vcc, s[80:81]
    s_and_b64 s[82:83], s[82:83], s[80:81]
    v_cmp_eq_u32 vcc, s38, v197
    s_mov_b32 s80, 0x00ff00ff
    s_mov_b32 s81, 0x00ff00ff
    s_orn2_b64 s[80:81], vcc, s[80:81]
    s_and_b64 s[82:83], s[82:83], s[80:81]
    v_cmp_eq_u32 vcc, s38, v198
    s_mov_b32 s80, 0x00ff00ff
    s_mov_b32 s81, 0x00ff00ff
    s_orn2_b64 s[80:81], vcc, s[80:81]
    s_and_b64 s[82:83], s[82:83], s[80:81]
    v_cmp_eq_u32 vcc, s38, v199
    s_mov_b32 s80, 0x00ff00ff
    s_mov_b32 s81, 0x00ff00ff
    s_orn2_b64 s[80:81], vcc, s[80:81]
    s_and_b64 s[82:83], s[82:83], s[80:81]
    s_cmp_eq_u64 s[82:83], -1
    s_cbranch_scc1 L_epoch_ok_27
    v_lshrrev_b32 v193, 4, v254
    v_lshlrev_b32 v193, 7, v193
    v_and_b32 v194, 15, v254
    v_lshl_add_u32 v193, v194, 2, v193
    v_add_u32 v193, 13631488, v193
    s_mov_b32 s80, 0x3fff3fff
    s_mov_b32 s81, 0x3fff3fff
    s_mov_b32 s75, 0
    s_mov_b32 s5, 0
L_all_28:
    buffer_load_dword v189, v193, s[16:19], s75 offen sc1
    s_waitcnt vmcnt(0)
    v_cmp_eq_u32 vcc, s38, v189
    s_nop 0
    s_and_b64 s[82:83], vcc, s[80:81]
    s_cmp_eq_u64 s[82:83], s[80:81]
    s_cbranch_scc1 L_all_ok_29
    s_add_u32 s5, s5, 1
    s_cmp_lt_u32 s5, 131072
    s_cbranch_scc1 L_all_28
L_all_ok_29:
    s_mov_b32 s80, 0x3fff3fff
    s_mov_b32 s81, 0x3fff3fff
    s_mov_b32 s75, 512
    s_mov_b32 s5, 0
L_all_30:
    buffer_load_dword v189, v193, s[16:19], s75 offen sc1
    s_waitcnt vmcnt(0)
    v_cmp_eq_u32 vcc, s38, v189
    s_nop 0
    s_and_b64 s[82:83], vcc, s[80:81]
    s_cmp_eq_u64 s[82:83], s[80:81]
    s_cbranch_scc1 L_all_ok_31
    s_add_u32 s5, s5, 1
    s_cmp_lt_u32 s5, 131072
    s_cbranch_scc1 L_all_30
L_all_ok_31:
    s_mov_b32 s80, 0x3fff3fff
    s_mov_b32 s81, 0x003f3fff
    s_mov_b32 s75, 1024
    s_mov_b32 s5, 0
L_all_32:
    buffer_load_dword v189, v193, s[16:19], s75 offen sc1
    s_waitcnt vmcnt(0)
    v_cmp_eq_u32 vcc, s38, v189
    s_nop 0
    s_and_b64 s[82:83], vcc, s[80:81]
    s_cmp_eq_u64 s[82:83], s[80:81]
    s_cbranch_scc1 L_all_ok_33
    s_add_u32 s5, s5, 1
    s_cmp_lt_u32 s5, 131072
    s_cbranch_scc1 L_all_32
L_all_ok_33:
    s_mov_b32 s80, 0x00ff00ff
    s_mov_b32 s81, 0x00ff00ff
    s_mov_b32 s75, 4096
    s_mov_b32 s5, 0
L_all_34:
    buffer_load_dword v189, v193, s[16:19], s75 offen sc1
    s_waitcnt vmcnt(0)
    v_cmp_eq_u32 vcc, s38, v189
    s_nop 0
    s_and_b64 s[82:83], vcc, s[80:81]
    s_cmp_eq_u64 s[82:83], s[80:81]
    s_cbranch_scc1 L_all_ok_35
    s_add_u32 s5, s5, 1
    s_cmp_lt_u32 s5, 131072
    s_cbranch_scc1 L_all_34
L_all_ok_35:
    s_mov_b32 s80, 0x00ff00ff
    s_mov_b32 s81, 0x00ff00ff
    s_mov_b32 s75, 4608
    s_mov_b32 s5, 0
L_all_36:
    buffer_load_dword v189, v193, s[16:19], s75 offen sc1
    s_waitcnt vmcnt(0)
    v_cmp_eq_u32 vcc, s38, v189
    s_nop 0
    s_and_b64 s[82:83], vcc, s[80:81]
    s_cmp_eq_u64 s[82:83], s[80:81]
    s_cbranch_scc1 L_all_ok_37
    s_add_u32 s5, s5, 1
    s_cmp_lt_u32 s5, 131072
    s_cbranch_scc1 L_all_36
L_all_ok_37:
    s_mov_b32 s80, 0x00ff00ff
    s_mov_b32 s81, 0x00ff00ff
    s_mov_b32 s75, 5120
    s_mov_b32 s5, 0
L_all_38:
    buffer_load_dword v189, v193, s[16:19], s75 offen sc1
    s_waitcnt vmcnt(0)
    v_cmp_eq_u32 vcc, s38, v189
    s_nop 0
    s_and_b64 s[82:83], vcc, s[80:81]
    s_cmp_eq_u64 s[82:83], s[80:81]
    s_cbranch_scc1 L_all_ok_39
    s_add_u32 s5, s5, 1
    s_cmp_lt_u32 s5, 131072
    s_cbranch_scc1 L_all_38
L_all_ok_39:
L_epoch_ok_27:
    s_mov_b32 s75, 13643776
    v_mov_b32 v189, s38
    s_mov_b32 exec_lo, 1
    s_mov_b32 exec_hi, 0
    buffer_store_dword v189, off, s[16:19], s75 sc1
    s_mov_b32 exec_lo, -1
    s_mov_b32 exec_hi, -1
L_epoch_26:
L_end:
    s_endpgm
    .fill (gated_mix__linear_kernel_hedgehog__glu_gated_swiglu__prompt_kernel + 53312 - .)/4, 4, 0xbf810000
.section .rodata,"a"
.p2align 6
.amdhsa_kernel gated_mix__linear_kernel_hedgehog__glu_gated_swiglu__prompt_kernel
  .amdhsa_next_free_vgpr 512
  .amdhsa_next_free_sgpr 102
  .amdhsa_accum_offset 256
  .amdhsa_group_segment_fixed_size 0
  .amdhsa_kernarg_size 96
  .amdhsa_user_sgpr_count 2
  .amdhsa_user_sgpr_kernarg_segment_ptr 1
  .amdhsa_system_sgpr_workgroup_id_x 1
  .amdhsa_float_denorm_mode_32 3
.end_amdhsa_kernel
```
